```python
import torch

def _softmax(x, axis=-1):
    return torch.softmax(x, dim=axis)

def _gelu(x):
    return torch.nn.functional.gelu(x, approximate='tanh')

def _silu(x):
    return torch.nn.functional.silu(x)

def _sigmoid(x):
    return torch.sigmoid(x)

def _layernorm(x, axis=-1, eps=1e-05):
    m = x.mean(dim=axis, keepdim=True)
    v = x.var(dim=axis, keepdim=True, unbiased=False)
    return (x - m) / torch.sqrt(v + eps)

def _scatter_add(tgt, idx, src, axis=0):
    return tgt.clone().index_add_(axis, idx, src)

def _segment_sum(src, seg, n):
    out = torch.zeros((n,) + src.shape[1:], dtype=src.dtype)
    return out.index_add_(0, seg, src)

def _pad(x, pw):
    flat = tuple((v for pair in reversed(pw) for v in pair))
    return torch.nn.functional.pad(x, flat)
kernel_name = 'adaLN_cond__ssm_conv_s4__glu_gated_bilinear__prompt'

def setup_inputs():

    _w = lambda a: (lambda t: t.to(torch.bfloat16) if t.is_floating_point() else t)(torch.as_tensor(a))

    def _A_setup():
        B, L, D, N = (1, 2048, 576, 128)
        A_re = -(lambda _x: torch.exp(torch.as_tensor(_x)))((lambda *s: torch.randn(*s, dtype=torch.bfloat16) * 3.2)(D, N))
        A_im = torch.pi * (lambda *s: torch.randn(*s, dtype=torch.bfloat16) * 0.05)(D, N)
        B_re = (lambda *s: torch.randn(*s, dtype=torch.bfloat16) * 0.1)(D, N)
        B_im = (lambda *s: torch.randn(*s, dtype=torch.bfloat16) * 0.1)(D, N)
        C_re = (lambda *s: torch.randn(*s, dtype=torch.bfloat16) * 0.1)(D, N)
        C_im = (lambda *s: torch.randn(*s, dtype=torch.bfloat16) * 0.1)(D, N)
        log_dt = (lambda *s: torch.randn(*s, dtype=torch.bfloat16) * 0.05)(D) * 0.5 - 4.0
        Dskip = (lambda *s: torch.randn(*s, dtype=torch.bfloat16) * 0.05)(D)
        return {'u': _w((lambda *s: torch.randn(*s, dtype=torch.bfloat16) * 0.05)(B, L, D)), 'A_re': _w(A_re), 'A_im': _w(A_im), 'B_re': _w(B_re), 'B_im': _w(B_im), 'C_re': _w(C_re), 'C_im': _w(C_im), 'log_dt': _w(log_dt), 'Dskip': _w(Dskip)}
    _A_in = _A_setup()

    def _B_setup():
        B, S, D, F = (1, 2048, 576, 4608)
        return {'x': _w((lambda *s: torch.randn(*s, dtype=torch.bfloat16) * 0.05)(B, S, D)), 'w_gate': _w((lambda *s: torch.randn(*s, dtype=torch.bfloat16) * 0.8)(D, F) * D ** (-0.5)), 'w_up': _w((lambda *s: torch.randn(*s, dtype=torch.bfloat16) * 0.8)(D, F) * D ** (-0.5)), 'w_down': _w((lambda *s: torch.randn(*s, dtype=torch.bfloat16) * 0.8)(F, D) * F ** (-0.5))}
    _B_in = _B_setup()
    return {'A_u': _A_in['u'], 'A_A_re': _A_in['A_re'], 'A_A_im': _A_in['A_im'], 'A_B_re': _A_in['B_re'], 'A_B_im': _A_in['B_im'], 'A_C_re': _A_in['C_re'], 'A_C_im': _A_in['C_im'], 'A_log_dt': _A_in['log_dt'], 'A_Dskip': _A_in['Dskip'], 'B_x': _B_in['x'], 'B_w_gate': _B_in['w_gate'], 'B_w_up': _B_in['w_up'], 'B_w_down': _B_in['w_down'], 'c': _w((lambda *s: torch.randn(*s, dtype=torch.bfloat16) * 0.2)(1, 576) * 8.0), 'w_mod': _w((lambda *s: torch.randn(*s, dtype=torch.bfloat16) * 0.2)(576, 6 * 576) * 576 ** (-0.5) * 8.0)}

def reference(A_u, A_A_re, A_A_im, A_B_re, A_B_im, A_C_re, A_C_im, A_log_dt, A_Dskip, B_x, B_w_gate, B_w_up, B_w_down, c, w_mod):

    def _A_ref(u, A_re, A_im, B_re, B_im, C_re, C_im, log_dt, Dskip):
        Bsz, L, D = u.shape
        dt = torch.exp(log_dt)[:, None]
        A = A_re + 1j * A_im
        Bc = B_re + 1j * B_im
        Cc = C_re + 1j * C_im
        logdA = dt * A
        dB = dt * Bc
        l = (lambda x, dt: x.to(dt))(torch.arange(L), A_re.dtype)
        P = torch.exp(logdA[:, :, None] * l[None, None, :])
        K = torch.einsum('dn,dnl,dn->dl', Cc, P, dB).real
        L2 = 2 * L
        Kp = _pad(K, ((0, 0), (0, L)))
        up = (lambda x, *d: x.permute(*d))(u, 0, 2, 1)
        up = _pad(up, ((0, 0), (0, 0), (0, L)))
        Kf = (lambda x, axes=(-2, -1): torch.fft.rfft2(x.float(), dim=axes))(Kp[:, None, :], axes=(-2, -1))
        Uf = (lambda x, axes=(-2, -1): torch.fft.rfft2(x.float(), dim=axes))(up[:, :, None, :], axes=(-2, -1))
        Yf = Uf * Kf[None, :, :, :]
        y = (lambda x, s, axes=(-2, -1): torch.fft.irfft2(x, s=s, dim=axes).to(torch.bfloat16))(Yf, (1, L2), axes=(-2, -1))[:, :, 0, :L]
        y = (lambda x, *d: x.permute(*d))(y, 0, 2, 1) + u * Dskip[None, None, :]
        return y

    def _B_ref(x, w_gate, w_up, w_down):
        g = torch.einsum('bsd,df->bsf', x, w_gate)
        u = torch.einsum('bsd,df->bsf', x, w_up)
        h = g * u
        return torch.einsum('bsf,fd->bsd', h, w_down)
    x = A_u
    mod = (_silu(c) @ w_mod).reshape(c.shape[0], 6, 1, -1)
    sa, ca, ga, sb, cb, gb = (mod[:, 0].clone(), mod[:, 1].clone(), mod[:, 2].clone(), mod[:, 3].clone(), mod[:, 4].clone(), mod[:, 5].clone())
    h = _layernorm(x, axis=-1) * (1 + ca) + sa
    x = x + ga * _A_ref(h, A_A_re, A_A_im, A_B_re, A_B_im, A_C_re, A_C_im, A_log_dt, A_Dskip)
    h = _layernorm(x, axis=-1) * (1 + cb) + sb
    x = x + gb * _B_ref(h, B_w_gate, B_w_up, B_w_down)
    return x
```

```asm
; @launch kernel=pre_kernel grid=(415,1,1) block=(256,1,1) lds=78144
; @launch kernel=conv_kernel grid=(704,1,1) block=(256,1,1) lds=39424
; @launch kernel=gemm1_kernel grid=(256,1,1) block=(256,1,1) lds=163840
.amdgcn_target "amdgcn-amd-amdhsa--gfx950"
.text
.globl pre_kernel
.p2align 8
.type pre_kernel,@function
pre_kernel:
    s_sub_u32 s3, s2, 0
    s_cmp_lt_u32 s2, 8
    s_cbranch_scc1 prekernel_role_2
    s_sub_u32 s3, s2, 8
    s_cmp_lt_u32 s2, 72
    s_cbranch_scc1 prekernel_role_3
    s_sub_u32 s3, s2, 72
    s_cmp_lt_u32 s2, 216
    s_cbranch_scc1 prekernel_role_4
    s_sub_u32 s3, s2, 216
    s_cmp_lt_u32 s2, 270
    s_cbranch_scc1 prekernel_role_5
    s_sub_u32 s3, s2, 270
    s_cmp_lt_u32 s2, 414
    s_cbranch_scc1 prekernel_role_6
    s_sub_u32 s3, s2, 414
    s_cmp_lt_u32 s2, 415
    s_cbranch_scc1 prekernel_role_7
prekernel_end_1:
    s_endpgm
prekernel_role_2:
    s_getpc_b64 s[4:5]
prekernel_pc_8:
    s_add_u32 s4, s4, conv_kernel-prekernel_pc_8
    s_addc_u32 s5, s5, 0
    s_mov_b32 s6, code_end_label-conv_kernel
    s_mov_b32 s7, 0x00020000
    v_lshlrev_b32 v1, 7, v0
    s_mov_b32 s8, 0
    buffer_load_dword v2, v1, s[4:7], s8 offen
    s_mov_b32 s8, 32768
    buffer_load_dword v3, v1, s[4:7], s8 offen
    s_mov_b32 s8, 65536
    buffer_load_dword v4, v1, s[4:7], s8 offen
    s_waitcnt vmcnt(0)
    s_endpgm
prekernel_role_3:
    s_load_dwordx2 s[4:5], s[0:1], 0
    s_load_dwordx2 s[6:7], s[0:1], 136
    v_lshrrev_b32 v1, 3, v0
    v_and_b32 v2, 7, v0
    v_mul_u32_u24 v3, 1152, v1
    v_lshl_add_u32 v3, v2, 4, v3
    s_mul_i32 s16, s3, 36864
    s_waitcnt lgkmcnt(0)
    s_mov_b32 s8, s4
    s_mov_b32 s9, s5
    s_mov_b32 s10, 0x240000
    s_mov_b32 s11, 0x00020000
    s_add_u32 s12, s6, 0x10000
    s_addc_u32 s13, s7, 0
    s_mov_b32 s14, 0x240000
    s_mov_b32 s15, 0x00020000
    buffer_load_dwordx4 v[8:11], v3, s[8:11], s16 offen offset:0
    buffer_load_dwordx4 v[12:15], v3, s[8:11], s16 offen offset:128
    buffer_load_dwordx4 v[16:19], v3, s[8:11], s16 offen offset:256
    buffer_load_dwordx4 v[20:23], v3, s[8:11], s16 offen offset:384
    buffer_load_dwordx4 v[24:27], v3, s[8:11], s16 offen offset:512
    buffer_load_dwordx4 v[28:31], v3, s[8:11], s16 offen offset:640
    buffer_load_dwordx4 v[32:35], v3, s[8:11], s16 offen offset:768
    buffer_load_dwordx4 v[36:39], v3, s[8:11], s16 offen offset:896
    buffer_load_dwordx4 v[40:43], v3, s[8:11], s16 offen offset:1024
    v_mov_b32 v4, 0
    v_mov_b32 v5, 0
    s_waitcnt vmcnt(8)
    v_lshlrev_b32 v44, 16, v8
    v_and_b32 v45, 0xffff0000, v8
    v_pk_add_f32 v[4:5], v[4:5], v[44:45]
    v_lshlrev_b32 v46, 16, v9
    v_and_b32 v47, 0xffff0000, v9
    v_pk_add_f32 v[4:5], v[4:5], v[46:47]
    v_lshlrev_b32 v48, 16, v10
    v_and_b32 v49, 0xffff0000, v10
    v_pk_add_f32 v[4:5], v[4:5], v[48:49]
    v_lshlrev_b32 v50, 16, v11
    v_and_b32 v51, 0xffff0000, v11
    v_pk_add_f32 v[4:5], v[4:5], v[50:51]
    s_waitcnt vmcnt(7)
    v_lshlrev_b32 v52, 16, v12
    v_and_b32 v53, 0xffff0000, v12
    v_pk_add_f32 v[4:5], v[4:5], v[52:53]
    v_lshlrev_b32 v54, 16, v13
    v_and_b32 v55, 0xffff0000, v13
    v_pk_add_f32 v[4:5], v[4:5], v[54:55]
    v_lshlrev_b32 v56, 16, v14
    v_and_b32 v57, 0xffff0000, v14
    v_pk_add_f32 v[4:5], v[4:5], v[56:57]
    v_lshlrev_b32 v58, 16, v15
    v_and_b32 v59, 0xffff0000, v15
    v_pk_add_f32 v[4:5], v[4:5], v[58:59]
    s_waitcnt vmcnt(6)
    v_lshlrev_b32 v60, 16, v16
    v_and_b32 v61, 0xffff0000, v16
    v_pk_add_f32 v[4:5], v[4:5], v[60:61]
    v_lshlrev_b32 v62, 16, v17
    v_and_b32 v63, 0xffff0000, v17
    v_pk_add_f32 v[4:5], v[4:5], v[62:63]
    v_lshlrev_b32 v64, 16, v18
    v_and_b32 v65, 0xffff0000, v18
    v_pk_add_f32 v[4:5], v[4:5], v[64:65]
    v_lshlrev_b32 v66, 16, v19
    v_and_b32 v67, 0xffff0000, v19
    v_pk_add_f32 v[4:5], v[4:5], v[66:67]
    s_waitcnt vmcnt(5)
    v_lshlrev_b32 v68, 16, v20
    v_and_b32 v69, 0xffff0000, v20
    v_pk_add_f32 v[4:5], v[4:5], v[68:69]
    v_lshlrev_b32 v70, 16, v21
    v_and_b32 v71, 0xffff0000, v21
    v_pk_add_f32 v[4:5], v[4:5], v[70:71]
    v_lshlrev_b32 v72, 16, v22
    v_and_b32 v73, 0xffff0000, v22
    v_pk_add_f32 v[4:5], v[4:5], v[72:73]
    v_lshlrev_b32 v74, 16, v23
    v_and_b32 v75, 0xffff0000, v23
    v_pk_add_f32 v[4:5], v[4:5], v[74:75]
    s_waitcnt vmcnt(4)
    v_lshlrev_b32 v76, 16, v24
    v_and_b32 v77, 0xffff0000, v24
    v_pk_add_f32 v[4:5], v[4:5], v[76:77]
    v_lshlrev_b32 v78, 16, v25
    v_and_b32 v79, 0xffff0000, v25
    v_pk_add_f32 v[4:5], v[4:5], v[78:79]
    v_lshlrev_b32 v80, 16, v26
    v_and_b32 v81, 0xffff0000, v26
    v_pk_add_f32 v[4:5], v[4:5], v[80:81]
    v_lshlrev_b32 v82, 16, v27
    v_and_b32 v83, 0xffff0000, v27
    v_pk_add_f32 v[4:5], v[4:5], v[82:83]
    s_waitcnt vmcnt(3)
    v_lshlrev_b32 v84, 16, v28
    v_and_b32 v85, 0xffff0000, v28
    v_pk_add_f32 v[4:5], v[4:5], v[84:85]
    v_lshlrev_b32 v86, 16, v29
    v_and_b32 v87, 0xffff0000, v29
    v_pk_add_f32 v[4:5], v[4:5], v[86:87]
    v_lshlrev_b32 v88, 16, v30
    v_and_b32 v89, 0xffff0000, v30
    v_pk_add_f32 v[4:5], v[4:5], v[88:89]
    v_lshlrev_b32 v90, 16, v31
    v_and_b32 v91, 0xffff0000, v31
    v_pk_add_f32 v[4:5], v[4:5], v[90:91]
    s_waitcnt vmcnt(2)
    v_lshlrev_b32 v92, 16, v32
    v_and_b32 v93, 0xffff0000, v32
    v_pk_add_f32 v[4:5], v[4:5], v[92:93]
    v_lshlrev_b32 v94, 16, v33
    v_and_b32 v95, 0xffff0000, v33
    v_pk_add_f32 v[4:5], v[4:5], v[94:95]
    v_lshlrev_b32 v96, 16, v34
    v_and_b32 v97, 0xffff0000, v34
    v_pk_add_f32 v[4:5], v[4:5], v[96:97]
    v_lshlrev_b32 v98, 16, v35
    v_and_b32 v99, 0xffff0000, v35
    v_pk_add_f32 v[4:5], v[4:5], v[98:99]
    s_waitcnt vmcnt(1)
    v_lshlrev_b32 v100, 16, v36
    v_and_b32 v101, 0xffff0000, v36
    v_pk_add_f32 v[4:5], v[4:5], v[100:101]
    v_lshlrev_b32 v102, 16, v37
    v_and_b32 v103, 0xffff0000, v37
    v_pk_add_f32 v[4:5], v[4:5], v[102:103]
    v_lshlrev_b32 v104, 16, v38
    v_and_b32 v105, 0xffff0000, v38
    v_pk_add_f32 v[4:5], v[4:5], v[104:105]
    v_lshlrev_b32 v106, 16, v39
    v_and_b32 v107, 0xffff0000, v39
    v_pk_add_f32 v[4:5], v[4:5], v[106:107]
    s_waitcnt vmcnt(0)
    v_lshlrev_b32 v108, 16, v40
    v_and_b32 v109, 0xffff0000, v40
    v_pk_add_f32 v[4:5], v[4:5], v[108:109]
    v_lshlrev_b32 v110, 16, v41
    v_and_b32 v111, 0xffff0000, v41
    v_pk_add_f32 v[4:5], v[4:5], v[110:111]
    v_lshlrev_b32 v112, 16, v42
    v_and_b32 v113, 0xffff0000, v42
    v_pk_add_f32 v[4:5], v[4:5], v[112:113]
    v_lshlrev_b32 v114, 16, v43
    v_and_b32 v115, 0xffff0000, v43
    v_pk_add_f32 v[4:5], v[4:5], v[114:115]
    v_add_f32 v4, v4, v5
    s_nop 1
    v_add_f32_dpp v5, v4, v4 quad_perm:[1,0,3,2] row_mask:0xf bank_mask:0xf
    s_nop 1
    v_add_f32_dpp v4, v5, v5 quad_perm:[2,3,0,1] row_mask:0xf bank_mask:0xf
    s_nop 1
    v_add_f32_dpp v5, v4, v4 row_half_mirror row_mask:0xf bank_mask:0xf
    v_mov_b32 v4, v5
    v_mul_f32 v4, 0x3ae38e39, v4
    v_mov_b32 v5, v4
    v_mov_b32 v6, 0
    v_mov_b32 v7, 0
    v_pk_add_f32 v[116:117], v[44:45], v[4:5] neg_lo:[0,1] neg_hi:[0,1]
    v_pk_fma_f32 v[6:7], v[116:117], v[116:117], v[6:7]
    v_pk_add_f32 v[116:117], v[46:47], v[4:5] neg_lo:[0,1] neg_hi:[0,1]
    v_pk_fma_f32 v[6:7], v[116:117], v[116:117], v[6:7]
    v_pk_add_f32 v[116:117], v[48:49], v[4:5] neg_lo:[0,1] neg_hi:[0,1]
    v_pk_fma_f32 v[6:7], v[116:117], v[116:117], v[6:7]
    v_pk_add_f32 v[116:117], v[50:51], v[4:5] neg_lo:[0,1] neg_hi:[0,1]
    v_pk_fma_f32 v[6:7], v[116:117], v[116:117], v[6:7]
    v_pk_add_f32 v[116:117], v[52:53], v[4:5] neg_lo:[0,1] neg_hi:[0,1]
    v_pk_fma_f32 v[6:7], v[116:117], v[116:117], v[6:7]
    v_pk_add_f32 v[116:117], v[54:55], v[4:5] neg_lo:[0,1] neg_hi:[0,1]
    v_pk_fma_f32 v[6:7], v[116:117], v[116:117], v[6:7]
    v_pk_add_f32 v[116:117], v[56:57], v[4:5] neg_lo:[0,1] neg_hi:[0,1]
    v_pk_fma_f32 v[6:7], v[116:117], v[116:117], v[6:7]
    v_pk_add_f32 v[116:117], v[58:59], v[4:5] neg_lo:[0,1] neg_hi:[0,1]
    v_pk_fma_f32 v[6:7], v[116:117], v[116:117], v[6:7]
    v_pk_add_f32 v[116:117], v[60:61], v[4:5] neg_lo:[0,1] neg_hi:[0,1]
    v_pk_fma_f32 v[6:7], v[116:117], v[116:117], v[6:7]
    v_pk_add_f32 v[116:117], v[62:63], v[4:5] neg_lo:[0,1] neg_hi:[0,1]
    v_pk_fma_f32 v[6:7], v[116:117], v[116:117], v[6:7]
    v_pk_add_f32 v[116:117], v[64:65], v[4:5] neg_lo:[0,1] neg_hi:[0,1]
    v_pk_fma_f32 v[6:7], v[116:117], v[116:117], v[6:7]
    v_pk_add_f32 v[116:117], v[66:67], v[4:5] neg_lo:[0,1] neg_hi:[0,1]
    v_pk_fma_f32 v[6:7], v[116:117], v[116:117], v[6:7]
    v_pk_add_f32 v[116:117], v[68:69], v[4:5] neg_lo:[0,1] neg_hi:[0,1]
    v_pk_fma_f32 v[6:7], v[116:117], v[116:117], v[6:7]
    v_pk_add_f32 v[116:117], v[70:71], v[4:5] neg_lo:[0,1] neg_hi:[0,1]
    v_pk_fma_f32 v[6:7], v[116:117], v[116:117], v[6:7]
    v_pk_add_f32 v[116:117], v[72:73], v[4:5] neg_lo:[0,1] neg_hi:[0,1]
    v_pk_fma_f32 v[6:7], v[116:117], v[116:117], v[6:7]
    v_pk_add_f32 v[116:117], v[74:75], v[4:5] neg_lo:[0,1] neg_hi:[0,1]
    v_pk_fma_f32 v[6:7], v[116:117], v[116:117], v[6:7]
    v_pk_add_f32 v[116:117], v[76:77], v[4:5] neg_lo:[0,1] neg_hi:[0,1]
    v_pk_fma_f32 v[6:7], v[116:117], v[116:117], v[6:7]
    v_pk_add_f32 v[116:117], v[78:79], v[4:5] neg_lo:[0,1] neg_hi:[0,1]
    v_pk_fma_f32 v[6:7], v[116:117], v[116:117], v[6:7]
    v_pk_add_f32 v[116:117], v[80:81], v[4:5] neg_lo:[0,1] neg_hi:[0,1]
    v_pk_fma_f32 v[6:7], v[116:117], v[116:117], v[6:7]
    v_pk_add_f32 v[116:117], v[82:83], v[4:5] neg_lo:[0,1] neg_hi:[0,1]
    v_pk_fma_f32 v[6:7], v[116:117], v[116:117], v[6:7]
    v_pk_add_f32 v[116:117], v[84:85], v[4:5] neg_lo:[0,1] neg_hi:[0,1]
    v_pk_fma_f32 v[6:7], v[116:117], v[116:117], v[6:7]
    v_pk_add_f32 v[116:117], v[86:87], v[4:5] neg_lo:[0,1] neg_hi:[0,1]
    v_pk_fma_f32 v[6:7], v[116:117], v[116:117], v[6:7]
    v_pk_add_f32 v[116:117], v[88:89], v[4:5] neg_lo:[0,1] neg_hi:[0,1]
    v_pk_fma_f32 v[6:7], v[116:117], v[116:117], v[6:7]
    v_pk_add_f32 v[116:117], v[90:91], v[4:5] neg_lo:[0,1] neg_hi:[0,1]
    v_pk_fma_f32 v[6:7], v[116:117], v[116:117], v[6:7]
    v_pk_add_f32 v[116:117], v[92:93], v[4:5] neg_lo:[0,1] neg_hi:[0,1]
    v_pk_fma_f32 v[6:7], v[116:117], v[116:117], v[6:7]
    v_pk_add_f32 v[116:117], v[94:95], v[4:5] neg_lo:[0,1] neg_hi:[0,1]
    v_pk_fma_f32 v[6:7], v[116:117], v[116:117], v[6:7]
    v_pk_add_f32 v[116:117], v[96:97], v[4:5] neg_lo:[0,1] neg_hi:[0,1]
    v_pk_fma_f32 v[6:7], v[116:117], v[116:117], v[6:7]
    v_pk_add_f32 v[116:117], v[98:99], v[4:5] neg_lo:[0,1] neg_hi:[0,1]
    v_pk_fma_f32 v[6:7], v[116:117], v[116:117], v[6:7]
    v_pk_add_f32 v[116:117], v[100:101], v[4:5] neg_lo:[0,1] neg_hi:[0,1]
    v_pk_fma_f32 v[6:7], v[116:117], v[116:117], v[6:7]
    v_pk_add_f32 v[116:117], v[102:103], v[4:5] neg_lo:[0,1] neg_hi:[0,1]
    v_pk_fma_f32 v[6:7], v[116:117], v[116:117], v[6:7]
    v_pk_add_f32 v[116:117], v[104:105], v[4:5] neg_lo:[0,1] neg_hi:[0,1]
    v_pk_fma_f32 v[6:7], v[116:117], v[116:117], v[6:7]
    v_pk_add_f32 v[116:117], v[106:107], v[4:5] neg_lo:[0,1] neg_hi:[0,1]
    v_pk_fma_f32 v[6:7], v[116:117], v[116:117], v[6:7]
    v_pk_add_f32 v[116:117], v[108:109], v[4:5] neg_lo:[0,1] neg_hi:[0,1]
    v_pk_fma_f32 v[6:7], v[116:117], v[116:117], v[6:7]
    v_pk_add_f32 v[116:117], v[110:111], v[4:5] neg_lo:[0,1] neg_hi:[0,1]
    v_pk_fma_f32 v[6:7], v[116:117], v[116:117], v[6:7]
    v_pk_add_f32 v[116:117], v[112:113], v[4:5] neg_lo:[0,1] neg_hi:[0,1]
    v_pk_fma_f32 v[6:7], v[116:117], v[116:117], v[6:7]
    v_pk_add_f32 v[116:117], v[114:115], v[4:5] neg_lo:[0,1] neg_hi:[0,1]
    v_pk_fma_f32 v[6:7], v[116:117], v[116:117], v[6:7]
    v_add_f32 v6, v6, v7
    s_nop 1
    v_add_f32_dpp v7, v6, v6 quad_perm:[1,0,3,2] row_mask:0xf bank_mask:0xf
    s_nop 1
    v_add_f32_dpp v6, v7, v7 quad_perm:[2,3,0,1] row_mask:0xf bank_mask:0xf
    s_nop 1
    v_add_f32_dpp v7, v6, v6 row_half_mirror row_mask:0xf bank_mask:0xf
    v_mov_b32 v6, v7
    v_mul_f32 v6, 0x3ae38e39, v6
    v_cvt_pk_bf16_f32 v6, 0, v6
    v_add_f32 v6, 0x3727c5ac, v6
    v_cvt_pk_bf16_f32 v6, 0, v6
    v_sqrt_f32 v6, v6
    s_nop 0
    v_cvt_pk_bf16_f32 v6, 0, v6
    v_rcp_f32 v6, v6
    v_cvt_pk_bf16_f32 v4, 0, v4
    v_mov_b32 v5, v4
    v_mov_b32 v7, v6
    v_pk_add_f32 v[44:45], v[44:45], v[4:5] neg_lo:[0,1] neg_hi:[0,1]
    v_cvt_pk_bf16_f32 v44, 0, v44
    v_cvt_pk_bf16_f32 v45, 0, v45
    v_pk_mul_f32 v[44:45], v[44:45], v[6:7]
    v_cvt_pk_bf16_f32 v8, v44, v45
    v_pk_add_f32 v[46:47], v[46:47], v[4:5] neg_lo:[0,1] neg_hi:[0,1]
    v_cvt_pk_bf16_f32 v46, 0, v46
    v_cvt_pk_bf16_f32 v47, 0, v47
    v_pk_mul_f32 v[46:47], v[46:47], v[6:7]
    v_cvt_pk_bf16_f32 v9, v46, v47
    v_pk_add_f32 v[48:49], v[48:49], v[4:5] neg_lo:[0,1] neg_hi:[0,1]
    v_cvt_pk_bf16_f32 v48, 0, v48
    v_cvt_pk_bf16_f32 v49, 0, v49
    v_pk_mul_f32 v[48:49], v[48:49], v[6:7]
    v_cvt_pk_bf16_f32 v10, v48, v49
    v_pk_add_f32 v[50:51], v[50:51], v[4:5] neg_lo:[0,1] neg_hi:[0,1]
    v_cvt_pk_bf16_f32 v50, 0, v50
    v_cvt_pk_bf16_f32 v51, 0, v51
    v_pk_mul_f32 v[50:51], v[50:51], v[6:7]
    v_cvt_pk_bf16_f32 v11, v50, v51
    v_pk_add_f32 v[52:53], v[52:53], v[4:5] neg_lo:[0,1] neg_hi:[0,1]
    v_cvt_pk_bf16_f32 v52, 0, v52
    v_cvt_pk_bf16_f32 v53, 0, v53
    v_pk_mul_f32 v[52:53], v[52:53], v[6:7]
    v_cvt_pk_bf16_f32 v12, v52, v53
    v_pk_add_f32 v[54:55], v[54:55], v[4:5] neg_lo:[0,1] neg_hi:[0,1]
    v_cvt_pk_bf16_f32 v54, 0, v54
    v_cvt_pk_bf16_f32 v55, 0, v55
    v_pk_mul_f32 v[54:55], v[54:55], v[6:7]
    v_cvt_pk_bf16_f32 v13, v54, v55
    v_pk_add_f32 v[56:57], v[56:57], v[4:5] neg_lo:[0,1] neg_hi:[0,1]
    v_cvt_pk_bf16_f32 v56, 0, v56
    v_cvt_pk_bf16_f32 v57, 0, v57
    v_pk_mul_f32 v[56:57], v[56:57], v[6:7]
    v_cvt_pk_bf16_f32 v14, v56, v57
    v_pk_add_f32 v[58:59], v[58:59], v[4:5] neg_lo:[0,1] neg_hi:[0,1]
    v_cvt_pk_bf16_f32 v58, 0, v58
    v_cvt_pk_bf16_f32 v59, 0, v59
    v_pk_mul_f32 v[58:59], v[58:59], v[6:7]
    v_cvt_pk_bf16_f32 v15, v58, v59
    v_pk_add_f32 v[60:61], v[60:61], v[4:5] neg_lo:[0,1] neg_hi:[0,1]
    v_cvt_pk_bf16_f32 v60, 0, v60
    v_cvt_pk_bf16_f32 v61, 0, v61
    v_pk_mul_f32 v[60:61], v[60:61], v[6:7]
    v_cvt_pk_bf16_f32 v16, v60, v61
    v_pk_add_f32 v[62:63], v[62:63], v[4:5] neg_lo:[0,1] neg_hi:[0,1]
    v_cvt_pk_bf16_f32 v62, 0, v62
    v_cvt_pk_bf16_f32 v63, 0, v63
    v_pk_mul_f32 v[62:63], v[62:63], v[6:7]
    v_cvt_pk_bf16_f32 v17, v62, v63
    v_pk_add_f32 v[64:65], v[64:65], v[4:5] neg_lo:[0,1] neg_hi:[0,1]
    v_cvt_pk_bf16_f32 v64, 0, v64
    v_cvt_pk_bf16_f32 v65, 0, v65
    v_pk_mul_f32 v[64:65], v[64:65], v[6:7]
    v_cvt_pk_bf16_f32 v18, v64, v65
    v_pk_add_f32 v[66:67], v[66:67], v[4:5] neg_lo:[0,1] neg_hi:[0,1]
    v_cvt_pk_bf16_f32 v66, 0, v66
    v_cvt_pk_bf16_f32 v67, 0, v67
    v_pk_mul_f32 v[66:67], v[66:67], v[6:7]
    v_cvt_pk_bf16_f32 v19, v66, v67
    v_pk_add_f32 v[68:69], v[68:69], v[4:5] neg_lo:[0,1] neg_hi:[0,1]
    v_cvt_pk_bf16_f32 v68, 0, v68
    v_cvt_pk_bf16_f32 v69, 0, v69
    v_pk_mul_f32 v[68:69], v[68:69], v[6:7]
    v_cvt_pk_bf16_f32 v20, v68, v69
    v_pk_add_f32 v[70:71], v[70:71], v[4:5] neg_lo:[0,1] neg_hi:[0,1]
    v_cvt_pk_bf16_f32 v70, 0, v70
    v_cvt_pk_bf16_f32 v71, 0, v71
    v_pk_mul_f32 v[70:71], v[70:71], v[6:7]
    v_cvt_pk_bf16_f32 v21, v70, v71
    v_pk_add_f32 v[72:73], v[72:73], v[4:5] neg_lo:[0,1] neg_hi:[0,1]
    v_cvt_pk_bf16_f32 v72, 0, v72
    v_cvt_pk_bf16_f32 v73, 0, v73
    v_pk_mul_f32 v[72:73], v[72:73], v[6:7]
    v_cvt_pk_bf16_f32 v22, v72, v73
    v_pk_add_f32 v[74:75], v[74:75], v[4:5] neg_lo:[0,1] neg_hi:[0,1]
    v_cvt_pk_bf16_f32 v74, 0, v74
    v_cvt_pk_bf16_f32 v75, 0, v75
    v_pk_mul_f32 v[74:75], v[74:75], v[6:7]
    v_cvt_pk_bf16_f32 v23, v74, v75
    v_pk_add_f32 v[76:77], v[76:77], v[4:5] neg_lo:[0,1] neg_hi:[0,1]
    v_cvt_pk_bf16_f32 v76, 0, v76
    v_cvt_pk_bf16_f32 v77, 0, v77
    v_pk_mul_f32 v[76:77], v[76:77], v[6:7]
    v_cvt_pk_bf16_f32 v24, v76, v77
    v_pk_add_f32 v[78:79], v[78:79], v[4:5] neg_lo:[0,1] neg_hi:[0,1]
    v_cvt_pk_bf16_f32 v78, 0, v78
    v_cvt_pk_bf16_f32 v79, 0, v79
    v_pk_mul_f32 v[78:79], v[78:79], v[6:7]
    v_cvt_pk_bf16_f32 v25, v78, v79
    v_pk_add_f32 v[80:81], v[80:81], v[4:5] neg_lo:[0,1] neg_hi:[0,1]
    v_cvt_pk_bf16_f32 v80, 0, v80
    v_cvt_pk_bf16_f32 v81, 0, v81
    v_pk_mul_f32 v[80:81], v[80:81], v[6:7]
    v_cvt_pk_bf16_f32 v26, v80, v81
    v_pk_add_f32 v[82:83], v[82:83], v[4:5] neg_lo:[0,1] neg_hi:[0,1]
    v_cvt_pk_bf16_f32 v82, 0, v82
    v_cvt_pk_bf16_f32 v83, 0, v83
    v_pk_mul_f32 v[82:83], v[82:83], v[6:7]
    v_cvt_pk_bf16_f32 v27, v82, v83
    v_pk_add_f32 v[84:85], v[84:85], v[4:5] neg_lo:[0,1] neg_hi:[0,1]
    v_cvt_pk_bf16_f32 v84, 0, v84
    v_cvt_pk_bf16_f32 v85, 0, v85
    v_pk_mul_f32 v[84:85], v[84:85], v[6:7]
    v_cvt_pk_bf16_f32 v28, v84, v85
    v_pk_add_f32 v[86:87], v[86:87], v[4:5] neg_lo:[0,1] neg_hi:[0,1]
    v_cvt_pk_bf16_f32 v86, 0, v86
    v_cvt_pk_bf16_f32 v87, 0, v87
    v_pk_mul_f32 v[86:87], v[86:87], v[6:7]
    v_cvt_pk_bf16_f32 v29, v86, v87
    v_pk_add_f32 v[88:89], v[88:89], v[4:5] neg_lo:[0,1] neg_hi:[0,1]
    v_cvt_pk_bf16_f32 v88, 0, v88
    v_cvt_pk_bf16_f32 v89, 0, v89
    v_pk_mul_f32 v[88:89], v[88:89], v[6:7]
    v_cvt_pk_bf16_f32 v30, v88, v89
    v_pk_add_f32 v[90:91], v[90:91], v[4:5] neg_lo:[0,1] neg_hi:[0,1]
    v_cvt_pk_bf16_f32 v90, 0, v90
    v_cvt_pk_bf16_f32 v91, 0, v91
    v_pk_mul_f32 v[90:91], v[90:91], v[6:7]
    v_cvt_pk_bf16_f32 v31, v90, v91
    v_pk_add_f32 v[92:93], v[92:93], v[4:5] neg_lo:[0,1] neg_hi:[0,1]
    v_cvt_pk_bf16_f32 v92, 0, v92
    v_cvt_pk_bf16_f32 v93, 0, v93
    v_pk_mul_f32 v[92:93], v[92:93], v[6:7]
    v_cvt_pk_bf16_f32 v32, v92, v93
    v_pk_add_f32 v[94:95], v[94:95], v[4:5] neg_lo:[0,1] neg_hi:[0,1]
    v_cvt_pk_bf16_f32 v94, 0, v94
    v_cvt_pk_bf16_f32 v95, 0, v95
    v_pk_mul_f32 v[94:95], v[94:95], v[6:7]
    v_cvt_pk_bf16_f32 v33, v94, v95
    v_pk_add_f32 v[96:97], v[96:97], v[4:5] neg_lo:[0,1] neg_hi:[0,1]
    v_cvt_pk_bf16_f32 v96, 0, v96
    v_cvt_pk_bf16_f32 v97, 0, v97
    v_pk_mul_f32 v[96:97], v[96:97], v[6:7]
    v_cvt_pk_bf16_f32 v34, v96, v97
    v_pk_add_f32 v[98:99], v[98:99], v[4:5] neg_lo:[0,1] neg_hi:[0,1]
    v_cvt_pk_bf16_f32 v98, 0, v98
    v_cvt_pk_bf16_f32 v99, 0, v99
    v_pk_mul_f32 v[98:99], v[98:99], v[6:7]
    v_cvt_pk_bf16_f32 v35, v98, v99
    v_pk_add_f32 v[100:101], v[100:101], v[4:5] neg_lo:[0,1] neg_hi:[0,1]
    v_cvt_pk_bf16_f32 v100, 0, v100
    v_cvt_pk_bf16_f32 v101, 0, v101
    v_pk_mul_f32 v[100:101], v[100:101], v[6:7]
    v_cvt_pk_bf16_f32 v36, v100, v101
    v_pk_add_f32 v[102:103], v[102:103], v[4:5] neg_lo:[0,1] neg_hi:[0,1]
    v_cvt_pk_bf16_f32 v102, 0, v102
    v_cvt_pk_bf16_f32 v103, 0, v103
    v_pk_mul_f32 v[102:103], v[102:103], v[6:7]
    v_cvt_pk_bf16_f32 v37, v102, v103
    v_pk_add_f32 v[104:105], v[104:105], v[4:5] neg_lo:[0,1] neg_hi:[0,1]
    v_cvt_pk_bf16_f32 v104, 0, v104
    v_cvt_pk_bf16_f32 v105, 0, v105
    v_pk_mul_f32 v[104:105], v[104:105], v[6:7]
    v_cvt_pk_bf16_f32 v38, v104, v105
    v_pk_add_f32 v[106:107], v[106:107], v[4:5] neg_lo:[0,1] neg_hi:[0,1]
    v_cvt_pk_bf16_f32 v106, 0, v106
    v_cvt_pk_bf16_f32 v107, 0, v107
    v_pk_mul_f32 v[106:107], v[106:107], v[6:7]
    v_cvt_pk_bf16_f32 v39, v106, v107
    v_pk_add_f32 v[108:109], v[108:109], v[4:5] neg_lo:[0,1] neg_hi:[0,1]
    v_cvt_pk_bf16_f32 v108, 0, v108
    v_cvt_pk_bf16_f32 v109, 0, v109
    v_pk_mul_f32 v[108:109], v[108:109], v[6:7]
    v_cvt_pk_bf16_f32 v40, v108, v109
    v_pk_add_f32 v[110:111], v[110:111], v[4:5] neg_lo:[0,1] neg_hi:[0,1]
    v_cvt_pk_bf16_f32 v110, 0, v110
    v_cvt_pk_bf16_f32 v111, 0, v111
    v_pk_mul_f32 v[110:111], v[110:111], v[6:7]
    v_cvt_pk_bf16_f32 v41, v110, v111
    v_pk_add_f32 v[112:113], v[112:113], v[4:5] neg_lo:[0,1] neg_hi:[0,1]
    v_cvt_pk_bf16_f32 v112, 0, v112
    v_cvt_pk_bf16_f32 v113, 0, v113
    v_pk_mul_f32 v[112:113], v[112:113], v[6:7]
    v_cvt_pk_bf16_f32 v42, v112, v113
    v_pk_add_f32 v[114:115], v[114:115], v[4:5] neg_lo:[0,1] neg_hi:[0,1]
    v_cvt_pk_bf16_f32 v114, 0, v114
    v_cvt_pk_bf16_f32 v115, 0, v115
    v_pk_mul_f32 v[114:115], v[114:115], v[6:7]
    v_cvt_pk_bf16_f32 v43, v114, v115
    v_mul_u32_u24 v3, 1184, v1
    v_lshl_add_u32 v3, v2, 4, v3
    ds_write_b128 v3, v[8:11] offset:0
    ds_write_b128 v3, v[12:15] offset:128
    ds_write_b128 v3, v[16:19] offset:256
    ds_write_b128 v3, v[20:23] offset:384
    ds_write_b128 v3, v[24:27] offset:512
    ds_write_b128 v3, v[28:31] offset:640
    ds_write_b128 v3, v[32:35] offset:768
    ds_write_b128 v3, v[36:39] offset:896
    ds_write_b128 v3, v[40:43] offset:1024
    v_and_b32 v1, 63, v0
    v_lshrrev_b32 v2, 6, v0
    v_lshrrev_b32 v4, 4, v1
    v_bfe_u32 v5, v1, 2, 2
    v_lshl_add_u32 v5, v4, 3, v5
    v_mul_u32_u24 v5, 1184, v5
    v_and_b32 v6, 3, v1
    v_lshl_add_u32 v5, v6, 3, v5
    v_lshl_add_u32 v5, v2, 5, v5
    v_and_b32 v6, 15, v1
    v_lshlrev_b32 v6, 6, v6
    v_lshl_add_u32 v6, v4, 4, v6
    v_lshl_add_u32 v6, v2, 10, v6
    s_mul_i32 s16, s3, 36864
    s_waitcnt lgkmcnt(0)
    s_barrier
    ds_read_b64_tr_b16 v[8:9], v5 offset:0
    ds_read_b64_tr_b16 v[10:11], v5 offset:4736
    ds_read_b64_tr_b16 v[12:13], v5 offset:128
    ds_read_b64_tr_b16 v[14:15], v5 offset:4864
    ds_read_b64_tr_b16 v[16:17], v5 offset:256
    ds_read_b64_tr_b16 v[18:19], v5 offset:4992
    ds_read_b64_tr_b16 v[20:21], v5 offset:384
    ds_read_b64_tr_b16 v[22:23], v5 offset:5120
    ds_read_b64_tr_b16 v[24:25], v5 offset:512
    ds_read_b64_tr_b16 v[26:27], v5 offset:5248
    ds_read_b64_tr_b16 v[28:29], v5 offset:640
    ds_read_b64_tr_b16 v[30:31], v5 offset:5376
    ds_read_b64_tr_b16 v[32:33], v5 offset:768
    ds_read_b64_tr_b16 v[34:35], v5 offset:5504
    ds_read_b64_tr_b16 v[36:37], v5 offset:896
    ds_read_b64_tr_b16 v[38:39], v5 offset:5632
    ds_read_b64_tr_b16 v[40:41], v5 offset:1024
    ds_read_b64_tr_b16 v[42:43], v5 offset:5760
    s_waitcnt lgkmcnt(15)
    s_add_u32 s17, s16, 0
    buffer_store_dwordx4 v[8:11], v6, s[12:15], s17 offen
    s_waitcnt lgkmcnt(14)
    s_add_u32 s17, s16, 4096
    buffer_store_dwordx4 v[12:15], v6, s[12:15], s17 offen
    s_waitcnt lgkmcnt(12)
    s_add_u32 s17, s16, 8192
    buffer_store_dwordx4 v[16:19], v6, s[12:15], s17 offen
    s_waitcnt lgkmcnt(10)
    s_add_u32 s17, s16, 12288
    buffer_store_dwordx4 v[20:23], v6, s[12:15], s17 offen
    s_waitcnt lgkmcnt(8)
    s_add_u32 s17, s16, 16384
    buffer_store_dwordx4 v[24:27], v6, s[12:15], s17 offen
    s_waitcnt lgkmcnt(6)
    s_add_u32 s17, s16, 20480
    buffer_store_dwordx4 v[28:31], v6, s[12:15], s17 offen
    s_waitcnt lgkmcnt(4)
    s_add_u32 s17, s16, 24576
    buffer_store_dwordx4 v[32:35], v6, s[12:15], s17 offen
    s_waitcnt lgkmcnt(2)
    s_add_u32 s17, s16, 28672
    buffer_store_dwordx4 v[36:39], v6, s[12:15], s17 offen
    s_waitcnt lgkmcnt(0)
    s_add_u32 s17, s16, 32768
    buffer_store_dwordx4 v[40:43], v6, s[12:15], s17 offen
    s_endpgm
prekernel_role_4:
    s_load_dwordx2 s[4:5], s[0:1], 8
    s_load_dwordx2 s[6:7], s[0:1], 16
    s_load_dwordx2 s[8:9], s[0:1], 24
    s_load_dwordx2 s[10:11], s[0:1], 32
    s_load_dwordx2 s[12:13], s[0:1], 40
    s_load_dwordx2 s[14:15], s[0:1], 48
    s_load_dwordx2 s[16:17], s[0:1], 56
    s_load_dwordx2 s[18:19], s[0:1], 136
    v_lshrrev_b32 v1, 6, v0
    v_and_b32 v0, 63, v0
    v_readfirstlane_b32 s33, v1
    s_lshl_b32 s34, s3, 2
    s_add_u32 s34, s34, s33
    s_mul_i32 s35, s33, 19536
    v_lshlrev_b32 v1, 2, v0
    s_lshl_b32 s20, s34, 8
    s_lshl_b32 s21, s34, 1
    v_mov_b32 v2, s21
    s_waitcnt lgkmcnt(0)
    s_mov_b32 s24, s16
    s_mov_b32 s25, s17
    s_mov_b32 s26, 0x480
    s_mov_b32 s27, 0x00020000
    buffer_load_ushort v10, v2, s[24:27], 0 offen
    s_mov_b32 s24, s4
    s_mov_b32 s25, s5
    s_mov_b32 s26, 0x24000
    s_mov_b32 s27, 0x00020000
    buffer_load_dword v4, v1, s[24:27], s20 offen
    s_mov_b32 s24, s6
    s_mov_b32 s25, s7
    s_mov_b32 s26, 0x24000
    s_mov_b32 s27, 0x00020000
    buffer_load_dword v5, v1, s[24:27], s20 offen
    s_mov_b32 s24, s8
    s_mov_b32 s25, s9
    s_mov_b32 s26, 0x24000
    s_mov_b32 s27, 0x00020000
    buffer_load_dword v6, v1, s[24:27], s20 offen
    s_mov_b32 s24, s10
    s_mov_b32 s25, s11
    s_mov_b32 s26, 0x24000
    s_mov_b32 s27, 0x00020000
    buffer_load_dword v7, v1, s[24:27], s20 offen
    s_mov_b32 s24, s12
    s_mov_b32 s25, s13
    s_mov_b32 s26, 0x24000
    s_mov_b32 s27, 0x00020000
    buffer_load_dword v8, v1, s[24:27], s20 offen
    s_mov_b32 s24, s14
    s_mov_b32 s25, s15
    s_mov_b32 s26, 0x24000
    s_mov_b32 s27, 0x00020000
    buffer_load_dword v9, v1, s[24:27], s20 offen
    s_add_u32 s28, s18, 0x250000
    s_addc_u32 s29, s19, 0
    s_mov_b32 s30, 0x240000
    s_mov_b32 s31, 0x00020000
    v_lshlrev_b32 v3, 3, v0
    v_add_u32 v3, s35, v3
    v_and_b32 v11, 15, v0
    v_lshrrev_b32 v12, 4, v0
    v_mul_u32_u24 v13, 528, v11
    v_lshl_add_u32 v13, v12, 4, v13
    v_add_u32 v13, s35, v13
    v_lshrrev_b32 v14, 2, v11
    v_add_u32 v14, 12, v14
    v_add_u32 v15, 16, v11
    v_cmp_gt_u32 vcc, 5, v11
    s_nop 1
    v_cndmask_b32 v14, v14, v15, vcc
    v_mul_u32_u24 v14, 528, v14
    v_lshl_add_u32 v14, v12, 4, v14
    v_add_u32 v14, s35, v14
    v_lshlrev_b32 v15, 4, v12
    s_mov_b32 s36, 0x40000
    s_mov_b32 s37, 0x20400
    v_lshrrev_b64 v[18:19], v15, s[36:37]
    v_and_b32 v18, 0xffff, v18
    v_lshl_add_u32 v18, v11, 3, v18
    v_lshlrev_b32 v16, 2, v18
    v_add_u32 v16, s35, v16
    s_mov_b32 s38, 0x60001
    s_mov_b32 s39, 0x8000106
    v_lshrrev_b64 v[18:19], v15, s[38:39]
    v_and_b32 v18, 0xffff, v18
    v_lshl_add_u32 v18, v11, 3, v18
    v_lshlrev_b32 v17, 2, v18
    v_add_u32 v17, s35, v17
    s_mov_b32 s40, 0x3f800000
    s_mov_b32 s41, 0x41000000
    s_mov_b32 s42, 0x42800000
    s_mov_b32 s43, 0x44000000
    s_waitcnt vmcnt(6)
    v_lshlrev_b32 v10, 16, v10
    v_mul_f32 v10, 0x3fb8aa3b, v10
    v_exp_f32 v10, v10
    s_nop 0
    v_cvt_pk_bf16_f32 v10, 0, v10
    s_waitcnt vmcnt(0)
    v_lshlrev_b32 v20, 16, v4
    v_and_b32 v21, 0xffff0000, v4
    v_lshlrev_b32 v22, 16, v5
    v_and_b32 v23, 0xffff0000, v5
    v_lshlrev_b32 v24, 16, v6
    v_and_b32 v25, 0xffff0000, v6
    v_lshlrev_b32 v26, 16, v7
    v_and_b32 v27, 0xffff0000, v7
    v_lshlrev_b32 v28, 16, v8
    v_and_b32 v29, 0xffff0000, v8
    v_lshlrev_b32 v30, 16, v9
    v_and_b32 v31, 0xffff0000, v9
    v_pk_mul_f32 v[20:21], v[20:21], v[10:11] op_sel_hi:[1,0]
    v_pk_mul_f32 v[22:23], v[22:23], v[10:11] op_sel_hi:[1,0]
    v_pk_mul_f32 v[24:25], v[24:25], v[10:11] op_sel_hi:[1,0]
    v_pk_mul_f32 v[26:27], v[26:27], v[10:11] op_sel_hi:[1,0]
    s_mov_b32 s44, 0x3fb8aa3b
    s_mov_b32 s45, 0x3e22f983
    v_pk_mul_f32 v[20:21], v[20:21], s[44:45] op_sel_hi:[1,0]
    v_pk_mul_f32 v[22:23], v[22:23], s[44:45] op_sel:[0,1] op_sel_hi:[1,1]
    v_pk_mul_f32 v[32:33], v[28:29], v[24:25]
    v_pk_mul_f32 v[34:35], v[28:29], v[26:27]
    v_pk_fma_f32 v[32:33], v[30:31], v[26:27], v[32:33] neg_lo:[1,0,0] neg_hi:[1,0,0]
    v_pk_fma_f32 v[34:35], v[30:31], v[24:25], v[34:35]
    v_max3_f32 v4, abs(v32), abs(v33), abs(v34)
    v_max_f32 v4, v4, abs(v35)
    s_nop 1
    v_max_f32_dpp v4, v4, v4 quad_perm:[1,0,3,2] row_mask:0xf bank_mask:0xf
    s_nop 1
    v_max_f32_dpp v4, v4, v4 quad_perm:[2,3,0,1] row_mask:0xf bank_mask:0xf
    s_nop 1
    v_max_f32_dpp v4, v4, v4 row_half_mirror row_mask:0xf bank_mask:0xf
    s_nop 1
    v_max_f32_dpp v4, v4, v4 row_mirror row_mask:0xf bank_mask:0xf
    v_mov_b32 v5, v4
    s_nop 1
    v_permlane16_swap_b32 v4, v5
    v_max_f32 v4, v4, v5
    v_mov_b32 v5, v4
    s_nop 1
    v_permlane32_swap_b32 v4, v5
    v_max_f32 v4, v4, v5
    v_lshrrev_b32 v4, 23, v4
    v_max_u32 v4, 20, v4
    v_min_u32 v4, 254, v4
    v_sub_u32 v6, 266, v4
    v_lshlrev_b32 v6, 23, v6
    v_subrev_u32 v8, 12, v4
    v_lshlrev_b32 v8, 23, v8
    v_pk_mul_f32 v[32:33], v[32:33], v[6:7] op_sel_hi:[1,0]
    v_pk_mul_f32 v[34:35], v[34:35], v[6:7] op_sel_hi:[1,0]
    v_pk_mul_f32 v[88:89], v[20:21], s[40:41] op_sel_hi:[1,0]
    v_pk_mul_f32 v[90:91], v[22:23], s[40:41] op_sel_hi:[1,0]
    v_exp_f32 v88, v88
    v_fract_f32 v90, v90
    v_exp_f32 v89, v89
    v_fract_f32 v91, v91
    v_cos_f32 v40, v90
    v_cos_f32 v41, v91
    v_sin_f32 v42, v90
    v_sin_f32 v43, v91
    v_pk_mul_f32 v[40:41], v[40:41], v[88:89]
    v_pk_mul_f32 v[42:43], v[42:43], v[88:89]
    v_pk_mul_f32 v[92:93], v[20:21], s[40:41] op_sel:[0,1] op_sel_hi:[1,1]
    v_pk_mul_f32 v[94:95], v[22:23], s[40:41] op_sel:[0,1] op_sel_hi:[1,1]
    v_exp_f32 v92, v92
    v_fract_f32 v94, v94
    v_exp_f32 v93, v93
    v_fract_f32 v95, v95
    v_cos_f32 v52, v94
    v_cos_f32 v53, v95
    v_sin_f32 v54, v94
    v_sin_f32 v55, v95
    v_pk_mul_f32 v[52:53], v[52:53], v[92:93]
    v_pk_mul_f32 v[54:55], v[54:55], v[92:93]
    v_pk_mul_f32 v[88:89], v[20:21], s[42:43] op_sel_hi:[1,0]
    v_pk_mul_f32 v[90:91], v[22:23], s[42:43] op_sel_hi:[1,0]
    v_exp_f32 v88, v88
    v_fract_f32 v90, v90
    v_exp_f32 v89, v89
    v_fract_f32 v91, v91
    v_cos_f32 v64, v90
    v_cos_f32 v65, v91
    v_sin_f32 v66, v90
    v_sin_f32 v67, v91
    v_pk_mul_f32 v[64:65], v[64:65], v[88:89]
    v_pk_mul_f32 v[66:67], v[66:67], v[88:89]
    v_pk_mul_f32 v[92:93], v[20:21], s[42:43] op_sel:[0,1] op_sel_hi:[1,1]
    v_pk_mul_f32 v[94:95], v[22:23], s[42:43] op_sel:[0,1] op_sel_hi:[1,1]
    v_exp_f32 v92, v92
    v_fract_f32 v94, v94
    v_exp_f32 v93, v93
    v_fract_f32 v95, v95
    v_cos_f32 v76, v94
    v_cos_f32 v77, v95
    v_sin_f32 v78, v94
    v_sin_f32 v79, v95
    v_pk_mul_f32 v[76:77], v[76:77], v[92:93]
    v_pk_mul_f32 v[78:79], v[78:79], v[92:93]
    v_pk_mul_f32 v[44:45], v[40:41], v[40:41]
    v_pk_mul_f32 v[46:47], v[40:41], v[42:43]
    v_pk_fma_f32 v[44:45], v[42:43], v[42:43], v[44:45] neg_lo:[1,0,0] neg_hi:[1,0,0]
    v_pk_fma_f32 v[46:47], v[42:43], v[40:41], v[46:47]
    v_pk_mul_f32 v[48:49], v[44:45], v[44:45]
    v_pk_mul_f32 v[50:51], v[44:45], v[46:47]
    v_pk_fma_f32 v[48:49], v[46:47], v[46:47], v[48:49] neg_lo:[1,0,0] neg_hi:[1,0,0]
    v_pk_fma_f32 v[50:51], v[46:47], v[44:45], v[50:51]
    v_pk_mul_f32 v[56:57], v[52:53], v[52:53]
    v_pk_mul_f32 v[58:59], v[52:53], v[54:55]
    v_pk_fma_f32 v[56:57], v[54:55], v[54:55], v[56:57] neg_lo:[1,0,0] neg_hi:[1,0,0]
    v_pk_fma_f32 v[58:59], v[54:55], v[52:53], v[58:59]
    v_pk_mul_f32 v[60:61], v[56:57], v[56:57]
    v_pk_mul_f32 v[62:63], v[56:57], v[58:59]
    v_pk_fma_f32 v[60:61], v[58:59], v[58:59], v[60:61] neg_lo:[1,0,0] neg_hi:[1,0,0]
    v_pk_fma_f32 v[62:63], v[58:59], v[56:57], v[62:63]
    v_pk_mul_f32 v[68:69], v[64:65], v[64:65]
    v_pk_mul_f32 v[70:71], v[64:65], v[66:67]
    v_pk_fma_f32 v[68:69], v[66:67], v[66:67], v[68:69] neg_lo:[1,0,0] neg_hi:[1,0,0]
    v_pk_fma_f32 v[70:71], v[66:67], v[64:65], v[70:71]
    v_pk_mul_f32 v[72:73], v[68:69], v[68:69]
    v_pk_mul_f32 v[74:75], v[68:69], v[70:71]
    v_pk_fma_f32 v[72:73], v[70:71], v[70:71], v[72:73] neg_lo:[1,0,0] neg_hi:[1,0,0]
    v_pk_fma_f32 v[74:75], v[70:71], v[68:69], v[74:75]
    v_pk_mul_f32 v[80:81], v[76:77], v[76:77]
    v_pk_mul_f32 v[82:83], v[76:77], v[78:79]
    v_pk_fma_f32 v[80:81], v[78:79], v[78:79], v[80:81] neg_lo:[1,0,0] neg_hi:[1,0,0]
    v_pk_fma_f32 v[82:83], v[78:79], v[76:77], v[82:83]
    v_pk_mul_f32 v[84:85], v[80:81], v[80:81]
    v_pk_mul_f32 v[86:87], v[80:81], v[82:83]
    v_pk_fma_f32 v[84:85], v[82:83], v[82:83], v[84:85] neg_lo:[1,0,0] neg_hi:[1,0,0]
    v_pk_fma_f32 v[86:87], v[82:83], v[80:81], v[86:87]
    v_cvt_pk_f16_f32 v96, v32, v33
    v_cvt_pk_f16_f32 v97, -v34, -v35
    ds_write_b64 v3, v[96:97] offset:0
    v_pk_mul_f32 v[104:105], v[32:33], v[40:41]
    v_pk_mul_f32 v[106:107], v[32:33], v[42:43]
    v_pk_fma_f32 v[104:105], v[34:35], v[42:43], v[104:105] neg_lo:[1,0,0] neg_hi:[1,0,0]
    v_pk_fma_f32 v[106:107], v[34:35], v[40:41], v[106:107]
    v_cvt_pk_f16_f32 v98, v104, v105
    v_cvt_pk_f16_f32 v99, -v106, -v107
    ds_write_b64 v3, v[98:99] offset:8448
    v_pk_mul_f32 v[108:109], v[32:33], v[44:45]
    v_pk_mul_f32 v[110:111], v[32:33], v[46:47]
    v_pk_fma_f32 v[108:109], v[34:35], v[46:47], v[108:109] neg_lo:[1,0,0] neg_hi:[1,0,0]
    v_pk_fma_f32 v[110:111], v[34:35], v[44:45], v[110:111]
    v_cvt_pk_f16_f32 v100, v108, v109
    v_cvt_pk_f16_f32 v101, -v110, -v111
    ds_write_b64 v3, v[100:101] offset:6336
    v_pk_mul_f32 v[112:113], v[104:105], v[44:45]
    v_pk_mul_f32 v[114:115], v[104:105], v[46:47]
    v_pk_fma_f32 v[112:113], v[106:107], v[46:47], v[112:113] neg_lo:[1,0,0] neg_hi:[1,0,0]
    v_pk_fma_f32 v[114:115], v[106:107], v[44:45], v[114:115]
    v_cvt_pk_f16_f32 v102, v112, v113
    v_cvt_pk_f16_f32 v103, -v114, -v115
    ds_write_b64 v3, v[102:103] offset:8976
    v_pk_mul_f32 v[104:105], v[32:33], v[48:49]
    v_pk_mul_f32 v[106:107], v[32:33], v[50:51]
    v_pk_fma_f32 v[104:105], v[34:35], v[50:51], v[104:105] neg_lo:[1,0,0] neg_hi:[1,0,0]
    v_pk_fma_f32 v[106:107], v[34:35], v[48:49], v[106:107]
    v_cvt_pk_f16_f32 v96, v104, v105
    v_cvt_pk_f16_f32 v97, -v106, -v107
    ds_write_b64 v3, v[96:97] offset:2112
    v_pk_mul_f32 v[108:109], v[104:105], v[40:41]
    v_pk_mul_f32 v[110:111], v[104:105], v[42:43]
    v_pk_fma_f32 v[108:109], v[106:107], v[42:43], v[108:109] neg_lo:[1,0,0] neg_hi:[1,0,0]
    v_pk_fma_f32 v[110:111], v[106:107], v[40:41], v[110:111]
    v_cvt_pk_f16_f32 v98, v108, v109
    v_cvt_pk_f16_f32 v99, -v110, -v111
    ds_write_b64 v3, v[98:99] offset:9504
    v_pk_mul_f32 v[112:113], v[104:105], v[44:45]
    v_pk_mul_f32 v[114:115], v[104:105], v[46:47]
    v_pk_fma_f32 v[112:113], v[106:107], v[46:47], v[112:113] neg_lo:[1,0,0] neg_hi:[1,0,0]
    v_pk_fma_f32 v[114:115], v[106:107], v[44:45], v[114:115]
    v_cvt_pk_f16_f32 v100, v112, v113
    v_cvt_pk_f16_f32 v101, -v114, -v115
    ds_write_b64 v3, v[100:101] offset:10560
    v_pk_mul_f32 v[116:117], v[112:113], v[40:41]
    v_pk_mul_f32 v[118:119], v[112:113], v[42:43]
    v_pk_fma_f32 v[116:117], v[114:115], v[42:43], v[116:117] neg_lo:[1,0,0] neg_hi:[1,0,0]
    v_pk_fma_f32 v[118:119], v[114:115], v[40:41], v[118:119]
    v_cvt_pk_f16_f32 v102, v116, v117
    v_cvt_pk_f16_f32 v103, -v118, -v119
    ds_write_b64 v3, v[102:103] offset:10032
    v_pk_mul_f32 v[104:105], v[32:33], v[72:73]
    v_pk_mul_f32 v[106:107], v[32:33], v[74:75]
    v_pk_fma_f32 v[104:105], v[34:35], v[74:75], v[104:105] neg_lo:[1,0,0] neg_hi:[1,0,0]
    v_pk_fma_f32 v[106:107], v[34:35], v[72:73], v[106:107]
    v_cvt_pk_f16_f32 v96, v104, v105
    v_cvt_pk_f16_f32 v97, -v106, -v107
    ds_write_b64 v3, v[96:97] offset:528
    v_pk_mul_f32 v[108:109], v[104:105], v[44:45]
    v_pk_mul_f32 v[110:111], v[104:105], v[46:47]
    v_pk_fma_f32 v[108:109], v[106:107], v[46:47], v[108:109] neg_lo:[1,0,0] neg_hi:[1,0,0]
    v_pk_fma_f32 v[110:111], v[106:107], v[44:45], v[110:111]
    v_cvt_pk_f16_f32 v98, v108, v109
    v_cvt_pk_f16_f32 v99, -v110, -v111
    ds_write_b64 v3, v[98:99] offset:6864
    v_pk_mul_f32 v[112:113], v[104:105], v[48:49]
    v_pk_mul_f32 v[114:115], v[104:105], v[50:51]
    v_pk_fma_f32 v[112:113], v[106:107], v[50:51], v[112:113] neg_lo:[1,0,0] neg_hi:[1,0,0]
    v_pk_fma_f32 v[114:115], v[106:107], v[48:49], v[114:115]
    v_cvt_pk_f16_f32 v100, v112, v113
    v_cvt_pk_f16_f32 v101, -v114, -v115
    ds_write_b64 v3, v[100:101] offset:2640
    v_pk_mul_f32 v[116:117], v[112:113], v[44:45]
    v_pk_mul_f32 v[118:119], v[112:113], v[46:47]
    v_pk_fma_f32 v[116:117], v[114:115], v[46:47], v[116:117] neg_lo:[1,0,0] neg_hi:[1,0,0]
    v_pk_fma_f32 v[118:119], v[114:115], v[44:45], v[118:119]
    v_cvt_pk_f16_f32 v102, v116, v117
    v_cvt_pk_f16_f32 v103, -v118, -v119
    ds_write_b64 v3, v[102:103] offset:7392
    v_pk_mul_f32 v[104:105], v[32:33], v[76:77]
    v_pk_mul_f32 v[106:107], v[32:33], v[78:79]
    v_pk_fma_f32 v[104:105], v[34:35], v[78:79], v[104:105] neg_lo:[1,0,0] neg_hi:[1,0,0]
    v_pk_fma_f32 v[106:107], v[34:35], v[76:77], v[106:107]
    v_cvt_pk_f16_f32 v96, v104, v105
    v_cvt_pk_f16_f32 v97, -v106, -v107
    ds_write_b64 v3, v[96:97] offset:1056
    v_pk_mul_f32 v[108:109], v[104:105], v[48:49]
    v_pk_mul_f32 v[110:111], v[104:105], v[50:51]
    v_pk_fma_f32 v[108:109], v[106:107], v[50:51], v[108:109] neg_lo:[1,0,0] neg_hi:[1,0,0]
    v_pk_fma_f32 v[110:111], v[106:107], v[48:49], v[110:111]
    v_cvt_pk_f16_f32 v98, v108, v109
    v_cvt_pk_f16_f32 v99, -v110, -v111
    ds_write_b64 v3, v[98:99] offset:3168
    v_pk_mul_f32 v[112:113], v[104:105], v[72:73]
    v_pk_mul_f32 v[114:115], v[104:105], v[74:75]
    v_pk_fma_f32 v[112:113], v[106:107], v[74:75], v[112:113] neg_lo:[1,0,0] neg_hi:[1,0,0]
    v_pk_fma_f32 v[114:115], v[106:107], v[72:73], v[114:115]
    v_cvt_pk_f16_f32 v100, v112, v113
    v_cvt_pk_f16_f32 v101, -v114, -v115
    ds_write_b64 v3, v[100:101] offset:1584
    v_pk_mul_f32 v[116:117], v[112:113], v[48:49]
    v_pk_mul_f32 v[118:119], v[112:113], v[50:51]
    v_pk_fma_f32 v[116:117], v[114:115], v[50:51], v[116:117] neg_lo:[1,0,0] neg_hi:[1,0,0]
    v_pk_fma_f32 v[118:119], v[114:115], v[48:49], v[118:119]
    v_cvt_pk_f16_f32 v102, v116, v117
    v_cvt_pk_f16_f32 v103, -v118, -v119
    ds_write_b64 v3, v[102:103] offset:3696
    v_pk_mul_f32 v[104:105], v[32:33], v[80:81]
    v_pk_mul_f32 v[106:107], v[32:33], v[82:83]
    v_pk_fma_f32 v[104:105], v[34:35], v[82:83], v[104:105] neg_lo:[1,0,0] neg_hi:[1,0,0]
    v_pk_fma_f32 v[106:107], v[34:35], v[80:81], v[106:107]
    v_cvt_pk_f16_f32 v96, v104, v105
    v_cvt_pk_f16_f32 v97, -v106, -v107
    ds_write_b64 v3, v[96:97] offset:4224
    v_pk_mul_f32 v[108:109], v[104:105], v[72:73]
    v_pk_mul_f32 v[110:111], v[104:105], v[74:75]
    v_pk_fma_f32 v[108:109], v[106:107], v[74:75], v[108:109] neg_lo:[1,0,0] neg_hi:[1,0,0]
    v_pk_fma_f32 v[110:111], v[106:107], v[72:73], v[110:111]
    v_cvt_pk_f16_f32 v98, v108, v109
    v_cvt_pk_f16_f32 v99, -v110, -v111
    ds_write_b64 v3, v[98:99] offset:4752
    v_pk_mul_f32 v[112:113], v[104:105], v[76:77]
    v_pk_mul_f32 v[114:115], v[104:105], v[78:79]
    v_pk_fma_f32 v[112:113], v[106:107], v[78:79], v[112:113] neg_lo:[1,0,0] neg_hi:[1,0,0]
    v_pk_fma_f32 v[114:115], v[106:107], v[76:77], v[114:115]
    v_cvt_pk_f16_f32 v100, v112, v113
    v_cvt_pk_f16_f32 v101, -v114, -v115
    ds_write_b64 v3, v[100:101] offset:5280
    v_pk_mul_f32 v[116:117], v[112:113], v[72:73]
    v_pk_mul_f32 v[118:119], v[112:113], v[74:75]
    v_pk_fma_f32 v[116:117], v[114:115], v[74:75], v[116:117] neg_lo:[1,0,0] neg_hi:[1,0,0]
    v_pk_fma_f32 v[118:119], v[114:115], v[72:73], v[118:119]
    v_cvt_pk_f16_f32 v102, v116, v117
    v_cvt_pk_f16_f32 v103, -v118, -v119
    ds_write_b64 v3, v[102:103] offset:5808
    v_pk_mul_f32 v[120:121], v[32:33], v[84:85]
    v_pk_mul_f32 v[122:123], v[32:33], v[86:87]
    v_pk_fma_f32 v[120:121], v[34:35], v[86:87], v[120:121] neg_lo:[1,0,0] neg_hi:[1,0,0]
    v_pk_fma_f32 v[122:123], v[34:35], v[84:85], v[122:123]
    v_cvt_pk_f16_f32 v96, v120, v121
    v_cvt_pk_f16_f32 v97, -v122, -v123
    ds_write_b64 v3, v[96:97] offset:7920
    v_mov_b32 v124, 1.0
    v_mov_b32 v125, 1.0
    v_mov_b32 v126, 0
    v_mov_b32 v127, 0
    v_cvt_pk_f16_f32 v98, v124, v125
    v_cvt_pk_f16_f32 v99, v126, v127
    ds_write_b64 v3, v[98:99] offset:11088
    v_cvt_pk_f16_f32 v100, v52, v53
    v_cvt_pk_f16_f32 v101, v54, v55
    ds_write_b64 v3, v[100:101] offset:11616
    v_cvt_pk_f16_f32 v102, v56, v57
    v_cvt_pk_f16_f32 v103, v58, v59
    ds_write_b64 v3, v[102:103] offset:12144
    v_pk_mul_f32 v[128:129], v[56:57], v[52:53]
    v_pk_mul_f32 v[130:131], v[56:57], v[54:55]
    v_pk_fma_f32 v[128:129], v[58:59], v[54:55], v[128:129] neg_lo:[1,0,0] neg_hi:[1,0,0]
    v_pk_fma_f32 v[130:131], v[58:59], v[52:53], v[130:131]
    v_cvt_pk_f16_f32 v96, v128, v129
    v_cvt_pk_f16_f32 v97, v130, v131
    ds_write_b64 v3, v[96:97] offset:12672
    v_cvt_pk_f16_f32 v98, v60, v61
    v_cvt_pk_f16_f32 v99, v62, v63
    ds_write_b64 v3, v[98:99] offset:13200
    v_pk_mul_f32 v[132:133], v[60:61], v[52:53]
    v_pk_mul_f32 v[134:135], v[60:61], v[54:55]
    v_pk_fma_f32 v[132:133], v[62:63], v[54:55], v[132:133] neg_lo:[1,0,0] neg_hi:[1,0,0]
    v_pk_fma_f32 v[134:135], v[62:63], v[52:53], v[134:135]
    v_cvt_pk_f16_f32 v100, v132, v133
    v_cvt_pk_f16_f32 v101, v134, v135
    ds_write_b64 v3, v[100:101] offset:13728
    v_pk_mul_f32 v[136:137], v[60:61], v[56:57]
    v_pk_mul_f32 v[138:139], v[60:61], v[58:59]
    v_pk_fma_f32 v[136:137], v[62:63], v[58:59], v[136:137] neg_lo:[1,0,0] neg_hi:[1,0,0]
    v_pk_fma_f32 v[138:139], v[62:63], v[56:57], v[138:139]
    v_cvt_pk_f16_f32 v102, v136, v137
    v_cvt_pk_f16_f32 v103, v138, v139
    ds_write_b64 v3, v[102:103] offset:14256
    v_pk_mul_f32 v[140:141], v[136:137], v[52:53]
    v_pk_mul_f32 v[142:143], v[136:137], v[54:55]
    v_pk_fma_f32 v[140:141], v[138:139], v[54:55], v[140:141] neg_lo:[1,0,0] neg_hi:[1,0,0]
    v_pk_fma_f32 v[142:143], v[138:139], v[52:53], v[142:143]
    v_cvt_pk_f16_f32 v96, v140, v141
    v_cvt_pk_f16_f32 v97, v142, v143
    ds_write_b64 v3, v[96:97] offset:14784
    v_cvt_pk_f16_f32 v98, v64, v65
    v_cvt_pk_f16_f32 v99, v66, v67
    ds_write_b64 v3, v[98:99] offset:15312
    v_pk_mul_f32 v[144:145], v[64:65], v[52:53]
    v_pk_mul_f32 v[146:147], v[64:65], v[54:55]
    v_pk_fma_f32 v[144:145], v[66:67], v[54:55], v[144:145] neg_lo:[1,0,0] neg_hi:[1,0,0]
    v_pk_fma_f32 v[146:147], v[66:67], v[52:53], v[146:147]
    v_cvt_pk_f16_f32 v100, v144, v145
    v_cvt_pk_f16_f32 v101, v146, v147
    ds_write_b64 v3, v[100:101] offset:15840
    v_pk_mul_f32 v[148:149], v[64:65], v[56:57]
    v_pk_mul_f32 v[150:151], v[64:65], v[58:59]
    v_pk_fma_f32 v[148:149], v[66:67], v[58:59], v[148:149] neg_lo:[1,0,0] neg_hi:[1,0,0]
    v_pk_fma_f32 v[150:151], v[66:67], v[56:57], v[150:151]
    v_cvt_pk_f16_f32 v102, v148, v149
    v_cvt_pk_f16_f32 v103, v150, v151
    ds_write_b64 v3, v[102:103] offset:16368
    v_pk_mul_f32 v[152:153], v[148:149], v[52:53]
    v_pk_mul_f32 v[154:155], v[148:149], v[54:55]
    v_pk_fma_f32 v[152:153], v[150:151], v[54:55], v[152:153] neg_lo:[1,0,0] neg_hi:[1,0,0]
    v_pk_fma_f32 v[154:155], v[150:151], v[52:53], v[154:155]
    v_cvt_pk_f16_f32 v96, v152, v153
    v_cvt_pk_f16_f32 v97, v154, v155
    ds_write_b64 v3, v[96:97] offset:16896
    v_pk_mul_f32 v[156:157], v[64:65], v[60:61]
    v_pk_mul_f32 v[158:159], v[64:65], v[62:63]
    v_pk_fma_f32 v[156:157], v[66:67], v[62:63], v[156:157] neg_lo:[1,0,0] neg_hi:[1,0,0]
    v_pk_fma_f32 v[158:159], v[66:67], v[60:61], v[158:159]
    v_cvt_pk_f16_f32 v98, v156, v157
    v_cvt_pk_f16_f32 v99, v158, v159
    ds_write_b64 v3, v[98:99] offset:17424
    v_pk_mul_f32 v[160:161], v[156:157], v[52:53]
    v_pk_mul_f32 v[162:163], v[156:157], v[54:55]
    v_pk_fma_f32 v[160:161], v[158:159], v[54:55], v[160:161] neg_lo:[1,0,0] neg_hi:[1,0,0]
    v_pk_fma_f32 v[162:163], v[158:159], v[52:53], v[162:163]
    v_cvt_pk_f16_f32 v100, v160, v161
    v_cvt_pk_f16_f32 v101, v162, v163
    ds_write_b64 v3, v[100:101] offset:17952
    v_pk_mul_f32 v[164:165], v[156:157], v[56:57]
    v_pk_mul_f32 v[166:167], v[156:157], v[58:59]
    v_pk_fma_f32 v[164:165], v[158:159], v[58:59], v[164:165] neg_lo:[1,0,0] neg_hi:[1,0,0]
    v_pk_fma_f32 v[166:167], v[158:159], v[56:57], v[166:167]
    v_cvt_pk_f16_f32 v102, v164, v165
    v_cvt_pk_f16_f32 v103, v166, v167
    ds_write_b64 v3, v[102:103] offset:18480
    v_pk_mul_f32 v[168:169], v[164:165], v[52:53]
    v_pk_mul_f32 v[170:171], v[164:165], v[54:55]
    v_pk_fma_f32 v[168:169], v[166:167], v[54:55], v[168:169] neg_lo:[1,0,0] neg_hi:[1,0,0]
    v_pk_fma_f32 v[170:171], v[166:167], v[52:53], v[170:171]
    v_cvt_pk_f16_f32 v96, v168, v169
    v_cvt_pk_f16_f32 v97, v170, v171
    ds_write_b64 v3, v[96:97] offset:19008
    s_waitcnt lgkmcnt(0)
    ds_read_b128 v[172:175], v13 offset:0
    ds_read_b128 v[204:207], v14 offset:0
    ds_read_b128 v[236:239], v13 offset:11088
    ds_read_b128 v[176:179], v13 offset:64
    ds_read_b128 v[208:211], v14 offset:64
    ds_read_b128 v[240:243], v13 offset:11152
    ds_read_b128 v[180:183], v13 offset:128
    ds_read_b128 v[212:215], v14 offset:128
    ds_read_b128 v[244:247], v13 offset:11216
    ds_read_b128 v[184:187], v13 offset:192
    ds_read_b128 v[216:219], v14 offset:192
    ds_read_b128 v[248:251], v13 offset:11280
    s_waitcnt lgkmcnt(9)
    v_mfma_f32_16x16x32_f16 v[104:107], v[172:175], v[236:239], 0
    v_mfma_f32_16x16x32_f16 v[108:111], v[204:207], v[236:239], 0
    s_waitcnt lgkmcnt(6)
    v_mfma_f32_16x16x32_f16 v[104:107], v[176:179], v[240:243], v[104:107]
    v_mfma_f32_16x16x32_f16 v[108:111], v[208:211], v[240:243], v[108:111]
    s_waitcnt lgkmcnt(3)
    v_mfma_f32_16x16x32_f16 v[104:107], v[180:183], v[244:247], v[104:107]
    v_mfma_f32_16x16x32_f16 v[108:111], v[212:215], v[244:247], v[108:111]
    s_waitcnt lgkmcnt(0)
    v_mfma_f32_16x16x32_f16 v[104:107], v[184:187], v[248:251], v[104:107]
    v_mfma_f32_16x16x32_f16 v[108:111], v[216:219], v[248:251], v[108:111]
    ds_read_b128 v[188:191], v13 offset:256
    ds_read_b128 v[220:223], v14 offset:256
    ds_read_b128 v[236:239], v13 offset:11344
    ds_read_b128 v[192:195], v13 offset:320
    ds_read_b128 v[224:227], v14 offset:320
    ds_read_b128 v[240:243], v13 offset:11408
    ds_read_b128 v[196:199], v13 offset:384
    ds_read_b128 v[228:231], v14 offset:384
    ds_read_b128 v[244:247], v13 offset:11472
    ds_read_b128 v[200:203], v13 offset:448
    ds_read_b128 v[232:235], v14 offset:448
    ds_read_b128 v[248:251], v13 offset:11536
    s_waitcnt lgkmcnt(9)
    v_mfma_f32_16x16x32_f16 v[104:107], v[188:191], v[236:239], v[104:107]
    v_mfma_f32_16x16x32_f16 v[108:111], v[220:223], v[236:239], v[108:111]
    s_waitcnt lgkmcnt(6)
    v_mfma_f32_16x16x32_f16 v[104:107], v[192:195], v[240:243], v[104:107]
    v_mfma_f32_16x16x32_f16 v[108:111], v[224:227], v[240:243], v[108:111]
    s_waitcnt lgkmcnt(3)
    v_mfma_f32_16x16x32_f16 v[104:107], v[196:199], v[244:247], v[104:107]
    v_mfma_f32_16x16x32_f16 v[108:111], v[228:231], v[244:247], v[108:111]
    s_waitcnt lgkmcnt(0)
    v_mfma_f32_16x16x32_f16 v[104:107], v[200:203], v[248:251], v[104:107]
    v_mfma_f32_16x16x32_f16 v[108:111], v[232:235], v[248:251], v[108:111]
    v_cvt_pk_f16_f32 v98, v68, v69
    v_cvt_pk_f16_f32 v99, v70, v71
    ds_write_b64 v3, v[98:99] offset:11088
    v_pk_mul_f32 v[92:93], v[52:53], v[68:69]
    v_pk_mul_f32 v[94:95], v[52:53], v[70:71]
    v_pk_fma_f32 v[92:93], v[54:55], v[70:71], v[92:93] neg_lo:[1,0,0] neg_hi:[1,0,0]
    v_pk_fma_f32 v[94:95], v[54:55], v[68:69], v[94:95]
    v_cvt_pk_f16_f32 v100, v92, v93
    v_cvt_pk_f16_f32 v101, v94, v95
    ds_write_b64 v3, v[100:101] offset:11616
    v_pk_mul_f32 v[88:89], v[56:57], v[68:69]
    v_pk_mul_f32 v[90:91], v[56:57], v[70:71]
    v_pk_fma_f32 v[88:89], v[58:59], v[70:71], v[88:89] neg_lo:[1,0,0] neg_hi:[1,0,0]
    v_pk_fma_f32 v[90:91], v[58:59], v[68:69], v[90:91]
    v_cvt_pk_f16_f32 v102, v88, v89
    v_cvt_pk_f16_f32 v103, v90, v91
    ds_write_b64 v3, v[102:103] offset:12144
    v_pk_mul_f32 v[92:93], v[128:129], v[68:69]
    v_pk_mul_f32 v[94:95], v[128:129], v[70:71]
    v_pk_fma_f32 v[92:93], v[130:131], v[70:71], v[92:93] neg_lo:[1,0,0] neg_hi:[1,0,0]
    v_pk_fma_f32 v[94:95], v[130:131], v[68:69], v[94:95]
    v_cvt_pk_f16_f32 v96, v92, v93
    v_cvt_pk_f16_f32 v97, v94, v95
    ds_write_b64 v3, v[96:97] offset:12672
    v_pk_mul_f32 v[88:89], v[60:61], v[68:69]
    v_pk_mul_f32 v[90:91], v[60:61], v[70:71]
    v_pk_fma_f32 v[88:89], v[62:63], v[70:71], v[88:89] neg_lo:[1,0,0] neg_hi:[1,0,0]
    v_pk_fma_f32 v[90:91], v[62:63], v[68:69], v[90:91]
    v_cvt_pk_f16_f32 v98, v88, v89
    v_cvt_pk_f16_f32 v99, v90, v91
    ds_write_b64 v3, v[98:99] offset:13200
    v_pk_mul_f32 v[92:93], v[132:133], v[68:69]
    v_pk_mul_f32 v[94:95], v[132:133], v[70:71]
    v_pk_fma_f32 v[92:93], v[134:135], v[70:71], v[92:93] neg_lo:[1,0,0] neg_hi:[1,0,0]
    v_pk_fma_f32 v[94:95], v[134:135], v[68:69], v[94:95]
    v_cvt_pk_f16_f32 v100, v92, v93
    v_cvt_pk_f16_f32 v101, v94, v95
    ds_write_b64 v3, v[100:101] offset:13728
    v_pk_mul_f32 v[88:89], v[136:137], v[68:69]
    v_pk_mul_f32 v[90:91], v[136:137], v[70:71]
    v_pk_fma_f32 v[88:89], v[138:139], v[70:71], v[88:89] neg_lo:[1,0,0] neg_hi:[1,0,0]
    v_pk_fma_f32 v[90:91], v[138:139], v[68:69], v[90:91]
    v_cvt_pk_f16_f32 v102, v88, v89
    v_cvt_pk_f16_f32 v103, v90, v91
    ds_write_b64 v3, v[102:103] offset:14256
    v_pk_mul_f32 v[92:93], v[140:141], v[68:69]
    v_pk_mul_f32 v[94:95], v[140:141], v[70:71]
    v_pk_fma_f32 v[92:93], v[142:143], v[70:71], v[92:93] neg_lo:[1,0,0] neg_hi:[1,0,0]
    v_pk_fma_f32 v[94:95], v[142:143], v[68:69], v[94:95]
    v_cvt_pk_f16_f32 v96, v92, v93
    v_cvt_pk_f16_f32 v97, v94, v95
    ds_write_b64 v3, v[96:97] offset:14784
    v_pk_mul_f32 v[88:89], v[64:65], v[68:69]
    v_pk_mul_f32 v[90:91], v[64:65], v[70:71]
    v_pk_fma_f32 v[88:89], v[66:67], v[70:71], v[88:89] neg_lo:[1,0,0] neg_hi:[1,0,0]
    v_pk_fma_f32 v[90:91], v[66:67], v[68:69], v[90:91]
    v_cvt_pk_f16_f32 v98, v88, v89
    v_cvt_pk_f16_f32 v99, v90, v91
    ds_write_b64 v3, v[98:99] offset:15312
    v_pk_mul_f32 v[92:93], v[144:145], v[68:69]
    v_pk_mul_f32 v[94:95], v[144:145], v[70:71]
    v_pk_fma_f32 v[92:93], v[146:147], v[70:71], v[92:93] neg_lo:[1,0,0] neg_hi:[1,0,0]
    v_pk_fma_f32 v[94:95], v[146:147], v[68:69], v[94:95]
    v_cvt_pk_f16_f32 v100, v92, v93
    v_cvt_pk_f16_f32 v101, v94, v95
    ds_write_b64 v3, v[100:101] offset:15840
    v_pk_mul_f32 v[88:89], v[148:149], v[68:69]
    v_pk_mul_f32 v[90:91], v[148:149], v[70:71]
    v_pk_fma_f32 v[88:89], v[150:151], v[70:71], v[88:89] neg_lo:[1,0,0] neg_hi:[1,0,0]
    v_pk_fma_f32 v[90:91], v[150:151], v[68:69], v[90:91]
    v_cvt_pk_f16_f32 v102, v88, v89
    v_cvt_pk_f16_f32 v103, v90, v91
    ds_write_b64 v3, v[102:103] offset:16368
    v_pk_mul_f32 v[92:93], v[152:153], v[68:69]
    v_pk_mul_f32 v[94:95], v[152:153], v[70:71]
    v_pk_fma_f32 v[92:93], v[154:155], v[70:71], v[92:93] neg_lo:[1,0,0] neg_hi:[1,0,0]
    v_pk_fma_f32 v[94:95], v[154:155], v[68:69], v[94:95]
    v_cvt_pk_f16_f32 v96, v92, v93
    v_cvt_pk_f16_f32 v97, v94, v95
    ds_write_b64 v3, v[96:97] offset:16896
    v_pk_mul_f32 v[88:89], v[156:157], v[68:69]
    v_pk_mul_f32 v[90:91], v[156:157], v[70:71]
    v_pk_fma_f32 v[88:89], v[158:159], v[70:71], v[88:89] neg_lo:[1,0,0] neg_hi:[1,0,0]
    v_pk_fma_f32 v[90:91], v[158:159], v[68:69], v[90:91]
    v_cvt_pk_f16_f32 v98, v88, v89
    v_cvt_pk_f16_f32 v99, v90, v91
    ds_write_b64 v3, v[98:99] offset:17424
    v_pk_mul_f32 v[92:93], v[160:161], v[68:69]
    v_pk_mul_f32 v[94:95], v[160:161], v[70:71]
    v_pk_fma_f32 v[92:93], v[162:163], v[70:71], v[92:93] neg_lo:[1,0,0] neg_hi:[1,0,0]
    v_pk_fma_f32 v[94:95], v[162:163], v[68:69], v[94:95]
    v_cvt_pk_f16_f32 v100, v92, v93
    v_cvt_pk_f16_f32 v101, v94, v95
    ds_write_b64 v3, v[100:101] offset:17952
    v_pk_mul_f32 v[88:89], v[164:165], v[68:69]
    v_pk_mul_f32 v[90:91], v[164:165], v[70:71]
    v_pk_fma_f32 v[88:89], v[166:167], v[70:71], v[88:89] neg_lo:[1,0,0] neg_hi:[1,0,0]
    v_pk_fma_f32 v[90:91], v[166:167], v[68:69], v[90:91]
    v_cvt_pk_f16_f32 v102, v88, v89
    v_cvt_pk_f16_f32 v103, v90, v91
    ds_write_b64 v3, v[102:103] offset:18480
    v_pk_mul_f32 v[92:93], v[168:169], v[68:69]
    v_pk_mul_f32 v[94:95], v[168:169], v[70:71]
    v_pk_fma_f32 v[92:93], v[170:171], v[70:71], v[92:93] neg_lo:[1,0,0] neg_hi:[1,0,0]
    v_pk_fma_f32 v[94:95], v[170:171], v[68:69], v[94:95]
    v_cvt_pk_f16_f32 v96, v92, v93
    v_cvt_pk_f16_f32 v97, v94, v95
    ds_write_b64 v3, v[96:97] offset:19008
    s_waitcnt lgkmcnt(0)
    ds_read_b128 v[236:239], v13 offset:11088
    ds_read_b128 v[240:243], v13 offset:11152
    ds_read_b128 v[244:247], v13 offset:11216
    ds_read_b128 v[248:251], v13 offset:11280
    s_waitcnt lgkmcnt(3)
    v_mfma_f32_16x16x32_f16 v[112:115], v[172:175], v[236:239], 0
    v_mfma_f32_16x16x32_f16 v[116:119], v[204:207], v[236:239], 0
    s_waitcnt lgkmcnt(2)
    v_mfma_f32_16x16x32_f16 v[112:115], v[176:179], v[240:243], v[112:115]
    v_mfma_f32_16x16x32_f16 v[116:119], v[208:211], v[240:243], v[116:119]
    s_waitcnt lgkmcnt(1)
    v_mfma_f32_16x16x32_f16 v[112:115], v[180:183], v[244:247], v[112:115]
    v_mfma_f32_16x16x32_f16 v[116:119], v[212:215], v[244:247], v[116:119]
    s_waitcnt lgkmcnt(0)
    v_mfma_f32_16x16x32_f16 v[112:115], v[184:187], v[248:251], v[112:115]
    v_mfma_f32_16x16x32_f16 v[116:119], v[216:219], v[248:251], v[116:119]
    ds_read_b128 v[236:239], v13 offset:11344
    ds_read_b128 v[240:243], v13 offset:11408
    ds_read_b128 v[244:247], v13 offset:11472
    ds_read_b128 v[248:251], v13 offset:11536
    s_waitcnt lgkmcnt(3)
    v_mfma_f32_16x16x32_f16 v[112:115], v[188:191], v[236:239], v[112:115]
    v_mfma_f32_16x16x32_f16 v[116:119], v[220:223], v[236:239], v[116:119]
    s_waitcnt lgkmcnt(2)
    v_mfma_f32_16x16x32_f16 v[112:115], v[192:195], v[240:243], v[112:115]
    v_mfma_f32_16x16x32_f16 v[116:119], v[224:227], v[240:243], v[116:119]
    s_waitcnt lgkmcnt(1)
    v_mfma_f32_16x16x32_f16 v[112:115], v[196:199], v[244:247], v[112:115]
    v_mfma_f32_16x16x32_f16 v[116:119], v[228:231], v[244:247], v[116:119]
    s_waitcnt lgkmcnt(0)
    v_mfma_f32_16x16x32_f16 v[112:115], v[200:203], v[248:251], v[112:115]
    v_mfma_f32_16x16x32_f16 v[116:119], v[232:235], v[248:251], v[116:119]
    v_pk_mul_f32 v[104:105], v[104:105], v[8:9] op_sel_hi:[1,0]
    v_pk_mul_f32 v[106:107], v[106:107], v[8:9] op_sel_hi:[1,0]
    v_pk_mul_f32 v[108:109], v[108:109], v[8:9] op_sel_hi:[1,0]
    v_pk_mul_f32 v[110:111], v[110:111], v[8:9] op_sel_hi:[1,0]
    s_nop 2
    v_pk_mul_f32 v[112:113], v[112:113], v[8:9] op_sel_hi:[1,0]
    v_pk_mul_f32 v[114:115], v[114:115], v[8:9] op_sel_hi:[1,0]
    v_pk_mul_f32 v[116:117], v[116:117], v[8:9] op_sel_hi:[1,0]
    v_pk_mul_f32 v[118:119], v[118:119], v[8:9] op_sel_hi:[1,0]
    ds_write_b32 v16, v104 offset:0
    ds_write_b32 v16, v105 offset:1024
    ds_write_b32 v16, v106 offset:2048
    ds_write_b32 v16, v107 offset:3072
    ds_write_b32 v17, v108 offset:0
    ds_write_b32 v16, v112 offset:512
    ds_write_b32 v16, v113 offset:1536
    ds_write_b32 v16, v114 offset:2560
    ds_write_b32 v16, v115 offset:3584
    ds_write_b32 v17, v116 offset:512
    s_mov_b64 exec, 0xffff
    ds_write_b32 v17, v109 offset:8
    ds_write_b32 v17, v110 offset:16
    ds_write_b32 v17, v111 offset:24
    ds_write_b32 v17, v117 offset:520
    ds_write_b32 v17, v118 offset:528
    ds_write_b32 v17, v119 offset:536
    s_mov_b64 exec, -1
    v_lshlrev_b32 v4, 5, v0
    v_add_u32 v4, s35, v4
    v_lshlrev_b32 v5, 4, v0
    s_lshl_b32 s20, s34, 12
    v_and_b32 v6, 1, v0
    v_cmp_eq_u32 s[36:37], 1, v6
    v_cmp_lt_u32 vcc, 31, v0
    s_waitcnt lgkmcnt(0)
    ds_read_b128 v[20:23], v4
    ds_read_b128 v[24:27], v4 offset:16
    ds_read_b32 v28, v4 offset:32
    v_add_u32 v7, 2048, v4
    ds_read2_b32 v[30:31], v7 offset0:0 offset1:4
    ds_read_b32 v32, v7 offset:32
    v_add_u32 v7, 4096, v4
    ds_read2_b32 v[34:35], v7 offset0:0 offset1:8
    v_add_u32 v7, 6144, v4
    ds_read2_b32 v[36:37], v7 offset0:0 offset1:8
    s_waitcnt lgkmcnt(0)
    v_cndmask_b32 v21, v21, v20, vcc
    v_cndmask_b32 v23, v23, v24, vcc
    v_cndmask_b32 v25, v25, v24, vcc
    v_cndmask_b32 v27, v27, v28, vcc
    v_cvt_pk_bf16_f32 v40, v27, v26
    v_cvt_pk_bf16_f32 v41, v25, v24
    v_cvt_pk_bf16_f32 v42, v23, v22
    v_cvt_pk_bf16_f32 v43, v21, v20
    buffer_store_dwordx4 v[40:43], v5, s[28:31], s20 offen
    v_cvt_pk_bf16_f32 v44, v32, v32
    v_cvt_pk_bf16_f32 v45, v31, v31
    v_cvt_pk_bf16_f32 v46, v31, v30
    v_cvt_pk_bf16_f32 v47, v30, v30
    buffer_store_dwordx4 v[44:47], v5, s[28:31], s20 offen offset:1024
    v_cndmask_b32 v38, v34, v35, s[36:37]
    v_cvt_pk_bf16_f32 v48, v35, v35
    v_cvt_pk_bf16_f32 v49, v35, v38
    v_cvt_pk_bf16_f32 v50, v34, v34
    v_cvt_pk_bf16_f32 v51, v34, v34
    buffer_store_dwordx4 v[48:51], v5, s[28:31], s20 offen offset:2048
    v_cndmask_b32 v39, v36, v37, s[36:37]
    v_cvt_pk_bf16_f32 v52, v37, v37
    v_cvt_pk_bf16_f32 v53, v37, v39
    v_cvt_pk_bf16_f32 v54, v36, v36
    v_cvt_pk_bf16_f32 v55, v36, v36
    buffer_store_dwordx4 v[52:55], v5, s[28:31], s20 offen offset:3072
    s_endpgm
prekernel_role_5:
    s_load_dwordx2 s[4:5], s[0:1], 112
    s_load_dwordx2 s[6:7], s[0:1], 136
    s_load_dwordx2 s[16:17], s[0:1], 104
    v_lshrrev_b32 v1, 3, v0
    v_and_b32 v2, 7, v0
    v_mul_u32_u24 v3, 6912, v1
    v_lshl_add_u32 v3, v2, 4, v3
    s_lshl_b32 s24, s3, 7
    v_lshlrev_b32 v4, 1, v0
    s_waitcnt lgkmcnt(0)
    s_mov_b32 s8, s4
    s_mov_b32 s9, s5
    s_mov_b32 s10, 0x3cc000
    s_mov_b32 s11, 0x00020000
    s_mov_b32 s12, s6
    s_mov_b32 s13, s7
    s_mov_b32 s14, 0x5200
    s_mov_b32 s15, 0x00020000
    s_mov_b32 s20, s16
    s_mov_b32 s21, s17
    s_mov_b32 s22, 0x480
    s_mov_b32 s23, 0x00020000
    buffer_load_ushort v5, v4, s[20:23], 0 offen offset:0
    buffer_load_ushort v6, v4, s[20:23], 0 offen offset:512
    buffer_load_ushort v7, v4, s[20:23], 0 offen offset:1024
    s_add_u32 s25, s24, 0
    buffer_load_dwordx4 v[16:19], v3, s[8:11], s25 offen
    s_add_u32 s25, s24, 221184
    buffer_load_dwordx4 v[20:23], v3, s[8:11], s25 offen
    s_add_u32 s25, s24, 442368
    buffer_load_dwordx4 v[24:27], v3, s[8:11], s25 offen
    s_add_u32 s25, s24, 663552
    buffer_load_dwordx4 v[28:31], v3, s[8:11], s25 offen
    s_add_u32 s25, s24, 884736
    buffer_load_dwordx4 v[32:35], v3, s[8:11], s25 offen
    s_add_u32 s25, s24, 1105920
    buffer_load_dwordx4 v[36:39], v3, s[8:11], s25 offen
    s_add_u32 s25, s24, 1327104
    buffer_load_dwordx4 v[40:43], v3, s[8:11], s25 offen
    s_add_u32 s25, s24, 1548288
    buffer_load_dwordx4 v[44:47], v3, s[8:11], s25 offen
    s_add_u32 s25, s24, 1769472
    buffer_load_dwordx4 v[48:51], v3, s[8:11], s25 offen
    s_add_u32 s25, s24, 1990656
    buffer_load_dwordx4 v[52:55], v3, s[8:11], s25 offen
    s_add_u32 s25, s24, 2211840
    buffer_load_dwordx4 v[56:59], v3, s[8:11], s25 offen
    s_add_u32 s25, s24, 2433024
    buffer_load_dwordx4 v[60:63], v3, s[8:11], s25 offen
    s_add_u32 s25, s24, 2654208
    buffer_load_dwordx4 v[64:67], v3, s[8:11], s25 offen
    s_add_u32 s25, s24, 2875392
    buffer_load_dwordx4 v[68:71], v3, s[8:11], s25 offen
    s_add_u32 s25, s24, 3096576
    buffer_load_dwordx4 v[72:75], v3, s[8:11], s25 offen
    s_add_u32 s25, s24, 3317760
    buffer_load_dwordx4 v[76:79], v3, s[8:11], s25 offen
    s_add_u32 s25, s24, 3538944
    buffer_load_dwordx4 v[80:83], v3, s[8:11], s25 offen
    s_add_u32 s25, s24, 3760128
    buffer_load_dwordx4 v[84:87], v3, s[8:11], s25 offen
    v_lshlrev_b32 v4, 2, v0
    s_waitcnt vmcnt(18)
    v_lshlrev_b32 v5, 16, v5
    v_mul_f32 v8, 0xbfb8aa3b, v5
    v_exp_f32 v8, v8
    s_nop 0
    v_add_f32 v8, 1.0, v8
    v_rcp_f32 v8, v8
    s_nop 0
    v_mul_f32 v8, v8, v5
    v_cvt_pk_bf16_f32 v8, 0, v8
    ds_write_b32 v4, v8 offset:0
    v_lshlrev_b32 v6, 16, v6
    v_mul_f32 v8, 0xbfb8aa3b, v6
    v_exp_f32 v8, v8
    s_nop 0
    v_add_f32 v8, 1.0, v8
    v_rcp_f32 v8, v8
    s_nop 0
    v_mul_f32 v8, v8, v6
    v_cvt_pk_bf16_f32 v8, 0, v8
    ds_write_b32 v4, v8 offset:1024
    v_lshlrev_b32 v7, 16, v7
    v_mul_f32 v8, 0xbfb8aa3b, v7
    v_exp_f32 v8, v8
    s_nop 0
    v_add_f32 v8, 1.0, v8
    v_rcp_f32 v8, v8
    s_nop 0
    v_mul_f32 v8, v8, v7
    v_cvt_pk_bf16_f32 v8, 0, v8
    ds_write_b32 v4, v8 offset:2048
    v_lshlrev_b32 v4, 2, v1
    s_waitcnt lgkmcnt(0)
    s_barrier
    ds_read_b32 v88, v4 offset:0
    ds_read_b32 v89, v4 offset:128
    ds_read_b32 v90, v4 offset:256
    ds_read_b32 v91, v4 offset:384
    ds_read_b32 v92, v4 offset:512
    ds_read_b32 v93, v4 offset:640
    ds_read_b32 v94, v4 offset:768
    ds_read_b32 v95, v4 offset:896
    ds_read_b32 v96, v4 offset:1024
    ds_read_b32 v97, v4 offset:1152
    ds_read_b32 v98, v4 offset:1280
    ds_read_b32 v99, v4 offset:1408
    ds_read_b32 v100, v4 offset:1536
    ds_read_b32 v101, v4 offset:1664
    ds_read_b32 v102, v4 offset:1792
    ds_read_b32 v103, v4 offset:1920
    ds_read_b32 v104, v4 offset:2048
    ds_read_b32 v105, v4 offset:2176
    v_mov_b32 v108, 0
    v_mov_b32 v109, 0
    v_mov_b32 v110, 0
    v_mov_b32 v111, 0
    v_mov_b32 v112, 0
    v_mov_b32 v113, 0
    v_mov_b32 v114, 0
    v_mov_b32 v115, 0
    s_waitcnt lgkmcnt(0)
    s_waitcnt vmcnt(17)
    v_lshlrev_b32 v8, 16, v16
    v_and_b32 v9, 0xffff0000, v16
    v_fmac_f32 v108, v8, v88
    v_fmac_f32 v109, v9, v88
    v_lshlrev_b32 v8, 16, v17
    v_and_b32 v9, 0xffff0000, v17
    v_fmac_f32 v110, v8, v88
    v_fmac_f32 v111, v9, v88
    v_lshlrev_b32 v8, 16, v18
    v_and_b32 v9, 0xffff0000, v18
    v_fmac_f32 v112, v8, v88
    v_fmac_f32 v113, v9, v88
    v_lshlrev_b32 v8, 16, v19
    v_and_b32 v9, 0xffff0000, v19
    v_fmac_f32 v114, v8, v88
    v_fmac_f32 v115, v9, v88
    s_waitcnt vmcnt(16)
    v_lshlrev_b32 v8, 16, v20
    v_and_b32 v9, 0xffff0000, v20
    v_fmac_f32 v108, v8, v89
    v_fmac_f32 v109, v9, v89
    v_lshlrev_b32 v8, 16, v21
    v_and_b32 v9, 0xffff0000, v21
    v_fmac_f32 v110, v8, v89
    v_fmac_f32 v111, v9, v89
    v_lshlrev_b32 v8, 16, v22
    v_and_b32 v9, 0xffff0000, v22
    v_fmac_f32 v112, v8, v89
    v_fmac_f32 v113, v9, v89
    v_lshlrev_b32 v8, 16, v23
    v_and_b32 v9, 0xffff0000, v23
    v_fmac_f32 v114, v8, v89
    v_fmac_f32 v115, v9, v89
    s_waitcnt vmcnt(15)
    v_lshlrev_b32 v8, 16, v24
    v_and_b32 v9, 0xffff0000, v24
    v_fmac_f32 v108, v8, v90
    v_fmac_f32 v109, v9, v90
    v_lshlrev_b32 v8, 16, v25
    v_and_b32 v9, 0xffff0000, v25
    v_fmac_f32 v110, v8, v90
    v_fmac_f32 v111, v9, v90
    v_lshlrev_b32 v8, 16, v26
    v_and_b32 v9, 0xffff0000, v26
    v_fmac_f32 v112, v8, v90
    v_fmac_f32 v113, v9, v90
    v_lshlrev_b32 v8, 16, v27
    v_and_b32 v9, 0xffff0000, v27
    v_fmac_f32 v114, v8, v90
    v_fmac_f32 v115, v9, v90
    s_waitcnt vmcnt(14)
    v_lshlrev_b32 v8, 16, v28
    v_and_b32 v9, 0xffff0000, v28
    v_fmac_f32 v108, v8, v91
    v_fmac_f32 v109, v9, v91
    v_lshlrev_b32 v8, 16, v29
    v_and_b32 v9, 0xffff0000, v29
    v_fmac_f32 v110, v8, v91
    v_fmac_f32 v111, v9, v91
    v_lshlrev_b32 v8, 16, v30
    v_and_b32 v9, 0xffff0000, v30
    v_fmac_f32 v112, v8, v91
    v_fmac_f32 v113, v9, v91
    v_lshlrev_b32 v8, 16, v31
    v_and_b32 v9, 0xffff0000, v31
    v_fmac_f32 v114, v8, v91
    v_fmac_f32 v115, v9, v91
    s_waitcnt vmcnt(13)
    v_lshlrev_b32 v8, 16, v32
    v_and_b32 v9, 0xffff0000, v32
    v_fmac_f32 v108, v8, v92
    v_fmac_f32 v109, v9, v92
    v_lshlrev_b32 v8, 16, v33
    v_and_b32 v9, 0xffff0000, v33
    v_fmac_f32 v110, v8, v92
    v_fmac_f32 v111, v9, v92
    v_lshlrev_b32 v8, 16, v34
    v_and_b32 v9, 0xffff0000, v34
    v_fmac_f32 v112, v8, v92
    v_fmac_f32 v113, v9, v92
    v_lshlrev_b32 v8, 16, v35
    v_and_b32 v9, 0xffff0000, v35
    v_fmac_f32 v114, v8, v92
    v_fmac_f32 v115, v9, v92
    s_waitcnt vmcnt(12)
    v_lshlrev_b32 v8, 16, v36
    v_and_b32 v9, 0xffff0000, v36
    v_fmac_f32 v108, v8, v93
    v_fmac_f32 v109, v9, v93
    v_lshlrev_b32 v8, 16, v37
    v_and_b32 v9, 0xffff0000, v37
    v_fmac_f32 v110, v8, v93
    v_fmac_f32 v111, v9, v93
    v_lshlrev_b32 v8, 16, v38
    v_and_b32 v9, 0xffff0000, v38
    v_fmac_f32 v112, v8, v93
    v_fmac_f32 v113, v9, v93
    v_lshlrev_b32 v8, 16, v39
    v_and_b32 v9, 0xffff0000, v39
    v_fmac_f32 v114, v8, v93
    v_fmac_f32 v115, v9, v93
    s_waitcnt vmcnt(11)
    v_lshlrev_b32 v8, 16, v40
    v_and_b32 v9, 0xffff0000, v40
    v_fmac_f32 v108, v8, v94
    v_fmac_f32 v109, v9, v94
    v_lshlrev_b32 v8, 16, v41
    v_and_b32 v9, 0xffff0000, v41
    v_fmac_f32 v110, v8, v94
    v_fmac_f32 v111, v9, v94
    v_lshlrev_b32 v8, 16, v42
    v_and_b32 v9, 0xffff0000, v42
    v_fmac_f32 v112, v8, v94
    v_fmac_f32 v113, v9, v94
    v_lshlrev_b32 v8, 16, v43
    v_and_b32 v9, 0xffff0000, v43
    v_fmac_f32 v114, v8, v94
    v_fmac_f32 v115, v9, v94
    s_waitcnt vmcnt(10)
    v_lshlrev_b32 v8, 16, v44
    v_and_b32 v9, 0xffff0000, v44
    v_fmac_f32 v108, v8, v95
    v_fmac_f32 v109, v9, v95
    v_lshlrev_b32 v8, 16, v45
    v_and_b32 v9, 0xffff0000, v45
    v_fmac_f32 v110, v8, v95
    v_fmac_f32 v111, v9, v95
    v_lshlrev_b32 v8, 16, v46
    v_and_b32 v9, 0xffff0000, v46
    v_fmac_f32 v112, v8, v95
    v_fmac_f32 v113, v9, v95
    v_lshlrev_b32 v8, 16, v47
    v_and_b32 v9, 0xffff0000, v47
    v_fmac_f32 v114, v8, v95
    v_fmac_f32 v115, v9, v95
    s_waitcnt vmcnt(9)
    v_lshlrev_b32 v8, 16, v48
    v_and_b32 v9, 0xffff0000, v48
    v_fmac_f32 v108, v8, v96
    v_fmac_f32 v109, v9, v96
    v_lshlrev_b32 v8, 16, v49
    v_and_b32 v9, 0xffff0000, v49
    v_fmac_f32 v110, v8, v96
    v_fmac_f32 v111, v9, v96
    v_lshlrev_b32 v8, 16, v50
    v_and_b32 v9, 0xffff0000, v50
    v_fmac_f32 v112, v8, v96
    v_fmac_f32 v113, v9, v96
    v_lshlrev_b32 v8, 16, v51
    v_and_b32 v9, 0xffff0000, v51
    v_fmac_f32 v114, v8, v96
    v_fmac_f32 v115, v9, v96
    s_waitcnt vmcnt(8)
    v_lshlrev_b32 v8, 16, v52
    v_and_b32 v9, 0xffff0000, v52
    v_fmac_f32 v108, v8, v97
    v_fmac_f32 v109, v9, v97
    v_lshlrev_b32 v8, 16, v53
    v_and_b32 v9, 0xffff0000, v53
    v_fmac_f32 v110, v8, v97
    v_fmac_f32 v111, v9, v97
    v_lshlrev_b32 v8, 16, v54
    v_and_b32 v9, 0xffff0000, v54
    v_fmac_f32 v112, v8, v97
    v_fmac_f32 v113, v9, v97
    v_lshlrev_b32 v8, 16, v55
    v_and_b32 v9, 0xffff0000, v55
    v_fmac_f32 v114, v8, v97
    v_fmac_f32 v115, v9, v97
    s_waitcnt vmcnt(7)
    v_lshlrev_b32 v8, 16, v56
    v_and_b32 v9, 0xffff0000, v56
    v_fmac_f32 v108, v8, v98
    v_fmac_f32 v109, v9, v98
    v_lshlrev_b32 v8, 16, v57
    v_and_b32 v9, 0xffff0000, v57
    v_fmac_f32 v110, v8, v98
    v_fmac_f32 v111, v9, v98
    v_lshlrev_b32 v8, 16, v58
    v_and_b32 v9, 0xffff0000, v58
    v_fmac_f32 v112, v8, v98
    v_fmac_f32 v113, v9, v98
    v_lshlrev_b32 v8, 16, v59
    v_and_b32 v9, 0xffff0000, v59
    v_fmac_f32 v114, v8, v98
    v_fmac_f32 v115, v9, v98
    s_waitcnt vmcnt(6)
    v_lshlrev_b32 v8, 16, v60
    v_and_b32 v9, 0xffff0000, v60
    v_fmac_f32 v108, v8, v99
    v_fmac_f32 v109, v9, v99
    v_lshlrev_b32 v8, 16, v61
    v_and_b32 v9, 0xffff0000, v61
    v_fmac_f32 v110, v8, v99
    v_fmac_f32 v111, v9, v99
    v_lshlrev_b32 v8, 16, v62
    v_and_b32 v9, 0xffff0000, v62
    v_fmac_f32 v112, v8, v99
    v_fmac_f32 v113, v9, v99
    v_lshlrev_b32 v8, 16, v63
    v_and_b32 v9, 0xffff0000, v63
    v_fmac_f32 v114, v8, v99
    v_fmac_f32 v115, v9, v99
    s_waitcnt vmcnt(5)
    v_lshlrev_b32 v8, 16, v64
    v_and_b32 v9, 0xffff0000, v64
    v_fmac_f32 v108, v8, v100
    v_fmac_f32 v109, v9, v100
    v_lshlrev_b32 v8, 16, v65
    v_and_b32 v9, 0xffff0000, v65
    v_fmac_f32 v110, v8, v100
    v_fmac_f32 v111, v9, v100
    v_lshlrev_b32 v8, 16, v66
    v_and_b32 v9, 0xffff0000, v66
    v_fmac_f32 v112, v8, v100
    v_fmac_f32 v113, v9, v100
    v_lshlrev_b32 v8, 16, v67
    v_and_b32 v9, 0xffff0000, v67
    v_fmac_f32 v114, v8, v100
    v_fmac_f32 v115, v9, v100
    s_waitcnt vmcnt(4)
    v_lshlrev_b32 v8, 16, v68
    v_and_b32 v9, 0xffff0000, v68
    v_fmac_f32 v108, v8, v101
    v_fmac_f32 v109, v9, v101
    v_lshlrev_b32 v8, 16, v69
    v_and_b32 v9, 0xffff0000, v69
    v_fmac_f32 v110, v8, v101
    v_fmac_f32 v111, v9, v101
    v_lshlrev_b32 v8, 16, v70
    v_and_b32 v9, 0xffff0000, v70
    v_fmac_f32 v112, v8, v101
    v_fmac_f32 v113, v9, v101
    v_lshlrev_b32 v8, 16, v71
    v_and_b32 v9, 0xffff0000, v71
    v_fmac_f32 v114, v8, v101
    v_fmac_f32 v115, v9, v101
    s_waitcnt vmcnt(3)
    v_lshlrev_b32 v8, 16, v72
    v_and_b32 v9, 0xffff0000, v72
    v_fmac_f32 v108, v8, v102
    v_fmac_f32 v109, v9, v102
    v_lshlrev_b32 v8, 16, v73
    v_and_b32 v9, 0xffff0000, v73
    v_fmac_f32 v110, v8, v102
    v_fmac_f32 v111, v9, v102
    v_lshlrev_b32 v8, 16, v74
    v_and_b32 v9, 0xffff0000, v74
    v_fmac_f32 v112, v8, v102
    v_fmac_f32 v113, v9, v102
    v_lshlrev_b32 v8, 16, v75
    v_and_b32 v9, 0xffff0000, v75
    v_fmac_f32 v114, v8, v102
    v_fmac_f32 v115, v9, v102
    s_waitcnt vmcnt(2)
    v_lshlrev_b32 v8, 16, v76
    v_and_b32 v9, 0xffff0000, v76
    v_fmac_f32 v108, v8, v103
    v_fmac_f32 v109, v9, v103
    v_lshlrev_b32 v8, 16, v77
    v_and_b32 v9, 0xffff0000, v77
    v_fmac_f32 v110, v8, v103
    v_fmac_f32 v111, v9, v103
    v_lshlrev_b32 v8, 16, v78
    v_and_b32 v9, 0xffff0000, v78
    v_fmac_f32 v112, v8, v103
    v_fmac_f32 v113, v9, v103
    v_lshlrev_b32 v8, 16, v79
    v_and_b32 v9, 0xffff0000, v79
    v_fmac_f32 v114, v8, v103
    v_fmac_f32 v115, v9, v103
    s_waitcnt vmcnt(1)
    v_lshlrev_b32 v8, 16, v80
    v_and_b32 v9, 0xffff0000, v80
    v_fmac_f32 v108, v8, v104
    v_fmac_f32 v109, v9, v104
    v_lshlrev_b32 v8, 16, v81
    v_and_b32 v9, 0xffff0000, v81
    v_fmac_f32 v110, v8, v104
    v_fmac_f32 v111, v9, v104
    v_lshlrev_b32 v8, 16, v82
    v_and_b32 v9, 0xffff0000, v82
    v_fmac_f32 v112, v8, v104
    v_fmac_f32 v113, v9, v104
    v_lshlrev_b32 v8, 16, v83
    v_and_b32 v9, 0xffff0000, v83
    v_fmac_f32 v114, v8, v104
    v_fmac_f32 v115, v9, v104
    s_waitcnt vmcnt(0)
    v_lshlrev_b32 v8, 16, v84
    v_and_b32 v9, 0xffff0000, v84
    v_fmac_f32 v108, v8, v105
    v_fmac_f32 v109, v9, v105
    v_lshlrev_b32 v8, 16, v85
    v_and_b32 v9, 0xffff0000, v85
    v_fmac_f32 v110, v8, v105
    v_fmac_f32 v111, v9, v105
    v_lshlrev_b32 v8, 16, v86
    v_and_b32 v9, 0xffff0000, v86
    v_fmac_f32 v112, v8, v105
    v_fmac_f32 v113, v9, v105
    v_lshlrev_b32 v8, 16, v87
    v_and_b32 v9, 0xffff0000, v87
    v_fmac_f32 v114, v8, v105
    v_fmac_f32 v115, v9, v105
    v_lshlrev_b32 v4, 8, v1
    v_lshl_add_u32 v4, v2, 5, v4
    ds_write_b128 v4, v[108:111] offset:4096
    ds_write_b128 v4, v[112:115] offset:4112
    s_waitcnt lgkmcnt(0)
    s_barrier
    v_cmp_gt_u32 vcc, 64, v0
    s_nop 0
    s_and_saveexec_b64 s[26:27], vcc
    s_cbranch_execz prekernel_end_1
    v_lshlrev_b32 v4, 2, v0
    ds_read_b32 v16, v4 offset:4096
    ds_read_b32 v17, v4 offset:4352
    ds_read_b32 v18, v4 offset:4608
    ds_read_b32 v19, v4 offset:4864
    ds_read_b32 v20, v4 offset:5120
    ds_read_b32 v21, v4 offset:5376
    ds_read_b32 v22, v4 offset:5632
    ds_read_b32 v23, v4 offset:5888
    ds_read_b32 v24, v4 offset:6144
    ds_read_b32 v25, v4 offset:6400
    ds_read_b32 v26, v4 offset:6656
    ds_read_b32 v27, v4 offset:6912
    ds_read_b32 v28, v4 offset:7168
    ds_read_b32 v29, v4 offset:7424
    ds_read_b32 v30, v4 offset:7680
    ds_read_b32 v31, v4 offset:7936
    ds_read_b32 v32, v4 offset:8192
    ds_read_b32 v33, v4 offset:8448
    ds_read_b32 v34, v4 offset:8704
    ds_read_b32 v35, v4 offset:8960
    ds_read_b32 v36, v4 offset:9216
    ds_read_b32 v37, v4 offset:9472
    ds_read_b32 v38, v4 offset:9728
    ds_read_b32 v39, v4 offset:9984
    ds_read_b32 v40, v4 offset:10240
    ds_read_b32 v41, v4 offset:10496
    ds_read_b32 v42, v4 offset:10752
    ds_read_b32 v43, v4 offset:11008
    ds_read_b32 v44, v4 offset:11264
    ds_read_b32 v45, v4 offset:11520
    ds_read_b32 v46, v4 offset:11776
    ds_read_b32 v47, v4 offset:12032
    s_waitcnt lgkmcnt(0)
    v_add_f32 v16, v16, v32
    v_add_f32 v17, v17, v33
    v_add_f32 v18, v18, v34
    v_add_f32 v19, v19, v35
    v_add_f32 v20, v20, v36
    v_add_f32 v21, v21, v37
    v_add_f32 v22, v22, v38
    v_add_f32 v23, v23, v39
    v_add_f32 v24, v24, v40
    v_add_f32 v25, v25, v41
    v_add_f32 v26, v26, v42
    v_add_f32 v27, v27, v43
    v_add_f32 v28, v28, v44
    v_add_f32 v29, v29, v45
    v_add_f32 v30, v30, v46
    v_add_f32 v31, v31, v47
    v_add_f32 v16, v16, v24
    v_add_f32 v17, v17, v25
    v_add_f32 v18, v18, v26
    v_add_f32 v19, v19, v27
    v_add_f32 v20, v20, v28
    v_add_f32 v21, v21, v29
    v_add_f32 v22, v22, v30
    v_add_f32 v23, v23, v31
    v_add_f32 v16, v16, v20
    v_add_f32 v17, v17, v21
    v_add_f32 v18, v18, v22
    v_add_f32 v19, v19, v23
    v_add_f32 v16, v16, v18
    v_add_f32 v17, v17, v19
    v_add_f32 v16, v16, v17
    v_cvt_pk_bf16_f32 v16, 0, v16
    s_lshl_b32 s24, s3, 8
    buffer_store_dword v16, v4, s[12:15], s24 offen
    s_cmp_lt_u32 s3, 27
    s_cbranch_scc1 prekernel_end_1
    s_cmp_ge_u32 s3, 45
    s_cbranch_scc1 prekernel_end_1
    v_add_f32 v17, 1.0, v16
    v_cvt_pk_bf16_f32 v17, 0, v17
    s_cmp_ge_u32 s3, 36
    s_mov_b32 s25, 2564
    s_cselect_b32 s24, -2048, s25
    s_cselect_b64 vcc, -1, 0
    s_lshl_b32 s25, s3, 9
    s_add_u32 s24, s24, s25
    v_cndmask_b32 v16, v16, v17, vcc
    v_lshlrev_b32 v4, 3, v0
    buffer_store_dword v16, v4, s[12:15], s24 offen
    s_endpgm
prekernel_role_6:
    s_load_dwordx2 s[4:5], s[0:1], 96
    s_load_dwordx2 s[8:9], s[0:1], 136
    v_lshrrev_b32 v1, 6, v0
    v_and_b32 v0, 63, v0
    v_readfirstlane_b32 s10, v1
    s_add_u32 s11, s3, 0
    v_lshlrev_b32 v1, 4, v0
    s_mul_i32 s15, s10, 9216
    s_mul_i32 s14, s11, 36864
    s_add_u32 s14, s14, s15
    s_waitcnt lgkmcnt(0)
    s_mov_b32 s16, s4
    s_mov_b32 s17, s5
    s_mov_b32 s18, 0x510000
    s_mov_b32 s19, 0x00020000
    s_add_u32 s24, s8, 0x1570000
    s_addc_u32 s25, s9, 0
    s_mov_b32 s26, 0x510000
    s_mov_b32 s27, 0x00020000
    s_add_u32 s28, s15, 0
    s_mov_b32 m0, s28
    s_add_u32 s28, s14, 0
    buffer_load_dwordx4 v1, s[16:19], s28 offen offset:0 lds
    buffer_load_dwordx4 v1, s[16:19], s28 offen offset:1024 lds
    buffer_load_dwordx4 v1, s[16:19], s28 offen offset:2048 lds
    buffer_load_dwordx4 v1, s[16:19], s28 offen offset:3072 lds
    s_add_u32 s28, s15, 4096
    s_mov_b32 m0, s28
    s_add_u32 s28, s14, 4096
    buffer_load_dwordx4 v1, s[16:19], s28 offen offset:0 lds
    buffer_load_dwordx4 v1, s[16:19], s28 offen offset:1024 lds
    buffer_load_dwordx4 v1, s[16:19], s28 offen offset:2048 lds
    buffer_load_dwordx4 v1, s[16:19], s28 offen offset:3072 lds
    s_add_u32 s28, s15, 8192
    s_mov_b32 m0, s28
    s_add_u32 s28, s14, 8192
    buffer_load_dwordx4 v1, s[16:19], s28 offen offset:0 lds
    v_lshrrev_b32 v2, 4, v0
    v_lshlrev_b32 v2, 3, v2
    v_bfe_u32 v3, v0, 2, 2
    v_add_u32 v2, v2, v3
    v_mul_u32_u24 v2, 1152, v2
    v_and_b32 v3, 3, v0
    v_lshl_add_u32 v2, v3, 3, v2
    s_mul_i32 s28, s10, 288
    v_add_u32 v2, s28, v2
    s_mov_b32 s43, s11
    s_mul_i32 s42, s10, 144
    s_add_u32 s42, s42, s43
    s_mul_i32 s42, s42, 9216
    s_add_u32 s32, s42, 0
    s_add_u32 s33, s42, 1024
    s_add_u32 s34, s42, 2048
    s_add_u32 s35, s42, 3072
    s_add_u32 s36, s42, 4096
    s_add_u32 s37, s42, 5120
    s_add_u32 s38, s42, 6144
    s_add_u32 s39, s42, 7168
    s_add_u32 s40, s42, 8192
    s_waitcnt vmcnt(0)
    s_barrier
    ds_read_b64_tr_b16 v[8:9], v2 offset:0
    ds_read_b64_tr_b16 v[10:11], v2 offset:4608
    ds_read_b64_tr_b16 v[12:13], v2 offset:32
    ds_read_b64_tr_b16 v[14:15], v2 offset:4640
    ds_read_b64_tr_b16 v[16:17], v2 offset:64
    ds_read_b64_tr_b16 v[18:19], v2 offset:4672
    ds_read_b64_tr_b16 v[20:21], v2 offset:96
    ds_read_b64_tr_b16 v[22:23], v2 offset:4704
    ds_read_b64_tr_b16 v[24:25], v2 offset:128
    ds_read_b64_tr_b16 v[26:27], v2 offset:4736
    ds_read_b64_tr_b16 v[28:29], v2 offset:160
    ds_read_b64_tr_b16 v[30:31], v2 offset:4768
    ds_read_b64_tr_b16 v[32:33], v2 offset:192
    ds_read_b64_tr_b16 v[34:35], v2 offset:4800
    ds_read_b64_tr_b16 v[36:37], v2 offset:224
    ds_read_b64_tr_b16 v[38:39], v2 offset:4832
    ds_read_b64_tr_b16 v[40:41], v2 offset:256
    ds_read_b64_tr_b16 v[42:43], v2 offset:4864
    s_waitcnt lgkmcnt(15)
    buffer_store_dwordx4 v[8:11], v1, s[24:27], s32 offen
    s_waitcnt lgkmcnt(14)
    buffer_store_dwordx4 v[12:15], v1, s[24:27], s33 offen
    s_waitcnt lgkmcnt(12)
    buffer_store_dwordx4 v[16:19], v1, s[24:27], s34 offen
    s_waitcnt lgkmcnt(10)
    buffer_store_dwordx4 v[20:23], v1, s[24:27], s35 offen
    s_waitcnt lgkmcnt(8)
    buffer_store_dwordx4 v[24:27], v1, s[24:27], s36 offen
    s_waitcnt lgkmcnt(6)
    buffer_store_dwordx4 v[28:31], v1, s[24:27], s37 offen
    s_waitcnt lgkmcnt(4)
    buffer_store_dwordx4 v[32:35], v1, s[24:27], s38 offen
    s_waitcnt lgkmcnt(2)
    buffer_store_dwordx4 v[36:39], v1, s[24:27], s39 offen
    s_waitcnt lgkmcnt(0)
    buffer_store_dwordx4 v[40:43], v1, s[24:27], s40 offen
    s_endpgm
prekernel_role_7:
    s_load_dwordx2 s[4:5], s[0:1], 136
    v_lshlrev_b32 v1, 7, v0
    v_mov_b32 v4, 0
    s_waitcnt lgkmcnt(0)
    s_add_u32 s8, s4, 0x3e80000
    s_addc_u32 s9, s5, 0
    s_mov_b32 s10, 0x98000
    s_mov_b32 s11, 0x00020000
    s_mov_b32 s12, 0
    buffer_store_dword v4, v1, s[8:11], s12 offen
    s_mov_b32 s12, 32768
    buffer_store_dword v4, v1, s[8:11], s12 offen
    s_mov_b32 s12, 65536
    buffer_store_dword v4, v1, s[8:11], s12 offen
    s_mov_b32 s12, 98304
    buffer_store_dword v4, v1, s[8:11], s12 offen
    s_mov_b32 s12, 131072
    buffer_store_dword v4, v1, s[8:11], s12 offen
    s_mov_b32 s12, 163840
    buffer_store_dword v4, v1, s[8:11], s12 offen
    s_endpgm
.globl conv_kernel
.p2align 8
.type conv_kernel,@function
conv_kernel:
    s_sub_u32 s3, s2, 0
    s_cmp_lt_u32 s2, 576
    s_cbranch_scc1 convkernel_role_2
    s_sub_u32 s3, s2, 576
    s_cmp_lt_u32 s2, 640
    s_cbranch_scc1 convkernel_role_3
    s_sub_u32 s3, s2, 640
    s_cmp_lt_u32 s2, 704
    s_cbranch_scc1 convkernel_role_4
convkernel_end_1:
    s_endpgm
convkernel_role_2:
    s_load_dwordx2 s[4:5], s[0:1], 136
    s_load_dwordx2 s[6:7], s[0:1], 64
    s_and_b32 s34, s3, 7
    s_mul_i32 s34, s34, 72
    s_lshr_b32 s20, s3, 3
    s_add_u32 s34, s34, s20
    s_lshl_b32 s20, s34, 2
    s_lshr_b32 s21, s34, 1
    s_lshl_b32 s21, s21, 2
    v_lshrrev_b32 v3, 6, v0
    s_nop 0
    v_readfirstlane_b32 s33, v3
    v_lshrrev_b32 v1, 2, v0
    v_mul_u32_u24 v1, 36864, v1
    v_and_b32 v3, 3, v0
    v_lshl_add_u32 v1, v3, 4, v1
    v_subrev_u32 v16, 1, v0
    v_lshrrev_b32 v17, 2, v16
    v_mul_u32_u24 v17, 36864, v17
    v_and_b32 v16, 3, v16
    v_lshl_add_u32 v17, v16, 4, v17
    v_lshlrev_b32 v2, 4, v0
    v_and_b32 v0, 63, v0
    s_waitcnt lgkmcnt(0)
    s_load_dword s24, s[4:5], s20
    s_add_u32 s22, s20, 2304
    s_load_dword s25, s[4:5], s22
    s_add_u32 s22, s20, 4608
    s_load_dword s26, s[4:5], s22
    s_load_dword s27, s[6:7], s21
    s_add_u32 s8, s4, 0x10000
    s_addc_u32 s9, s5, 0
    s_mov_b32 s10, 0x240000
    s_mov_b32 s11, 0x00020000
    s_add_u32 s12, s4, 0x250000
    s_addc_u32 s13, s5, 0
    s_mov_b32 s14, 0x240000
    s_mov_b32 s15, 0x00020000
    s_add_u32 s16, s4, 0x490000
    s_addc_u32 s17, s5, 0
    s_mov_b32 s18, 0x240000
    s_mov_b32 s19, 0x00020000
    s_lshl_b32 s22, s34, 4
    s_lshl_b32 s23, s34, 6
    buffer_load_dwordx4 v[8:11], v17, s[8:11], s23 offen
    buffer_load_dwordx4 v[12:15], v1, s[8:11], s23 offen
    s_lshl_b32 s23, s34, 12
    s_lshl_b32 s35, s33, 10
    s_add_u32 s35, s35, 35312
    s_mov_b32 m0, s35
    s_nop 0
    buffer_load_dwordx4 v2, s[12:15], s23 offen lds
    v_mov_b32 v4, 0
    v_mov_b32 v5, 0
    v_mov_b32 v6, 0
    v_mov_b32 v7, 0
    v_lshrrev_b32 v3, 8, v2
    v_mul_u32_u24 v3, 4384, v3
    v_and_b32 v16, 0xf0, v2
    v_add_u32 v3, v3, v16
    v_cmp_gt_u32 vcc, 2288, v2
    s_nop 0
    s_and_saveexec_b64 s[28:29], vcc
    s_cbranch_execz convkernel_z_5
    ds_write_b128 v3, v[4:7]
convkernel_z_5:
    s_mov_b64 exec, s[28:29]
    s_waitcnt lgkmcnt(0)
    v_mov_b32 v4, s25
    v_add_f32 v4, 1.0, v4
    v_cvt_pk_bf16_f32 v4, 0, v4
    v_mov_b32 v5, v4
    v_mov_b32 v6, s24
    v_mov_b32 v7, s24
    s_lshl_b32 s30, s27, 16
    s_and_b32 s31, s27, 0xffff0000
    s_bitcmp1_b32 s34, 0
    s_cselect_b32 s27, s31, s30
    v_cmp_eq_u32 s[38:39], 0, v2
    s_waitcnt vmcnt(2)
    v_lshlrev_b32 v40, 16, v8
    v_and_b32 v41, 0xffff0000, v8
    v_pk_mul_f32 v[40:41], v[40:41], v[4:5]
    v_cvt_pk_bf16_f32 v40, 0, v40
    v_cvt_pk_bf16_f32 v41, 0, v41
    v_pk_add_f32 v[40:41], v[40:41], v[6:7]
    v_cvt_pk_bf16_f32 v8, v40, v41
    v_cndmask_b32 v8, v8, 0, s[38:39]
    v_lshlrev_b32 v42, 16, v9
    v_and_b32 v43, 0xffff0000, v9
    v_pk_mul_f32 v[42:43], v[42:43], v[4:5]
    v_cvt_pk_bf16_f32 v42, 0, v42
    v_cvt_pk_bf16_f32 v43, 0, v43
    v_pk_add_f32 v[42:43], v[42:43], v[6:7]
    v_cvt_pk_bf16_f32 v9, v42, v43
    v_cndmask_b32 v9, v9, 0, s[38:39]
    v_mov_b32 v18, v9
    v_lshlrev_b32 v40, 16, v10
    v_and_b32 v41, 0xffff0000, v10
    v_pk_mul_f32 v[40:41], v[40:41], v[4:5]
    v_cvt_pk_bf16_f32 v40, 0, v40
    v_cvt_pk_bf16_f32 v41, 0, v41
    v_pk_add_f32 v[40:41], v[40:41], v[6:7]
    v_cvt_pk_bf16_f32 v10, v40, v41
    v_cndmask_b32 v10, v10, 0, s[38:39]
    v_mov_b32 v19, v10
    v_lshlrev_b32 v42, 16, v11
    v_and_b32 v43, 0xffff0000, v11
    v_pk_mul_f32 v[42:43], v[42:43], v[4:5]
    v_cvt_pk_bf16_f32 v42, 0, v42
    v_cvt_pk_bf16_f32 v43, 0, v43
    v_pk_add_f32 v[42:43], v[42:43], v[6:7]
    v_cvt_pk_bf16_f32 v11, v42, v43
    v_cndmask_b32 v11, v11, 0, s[38:39]
    v_mov_b32 v20, v11
    s_waitcnt vmcnt(1)
    v_lshlrev_b32 v40, 16, v12
    v_and_b32 v41, 0xffff0000, v12
    v_pk_mul_f32 v[40:41], v[40:41], v[4:5]
    v_cvt_pk_bf16_f32 v40, 0, v40
    v_cvt_pk_bf16_f32 v41, 0, v41
    v_pk_add_f32 v[40:41], v[40:41], v[6:7]
    v_cvt_pk_bf16_f32 v12, v40, v41
    v_mov_b32 v21, v12
    v_lshlrev_b32 v42, 16, v13
    v_and_b32 v43, 0xffff0000, v13
    v_pk_mul_f32 v[42:43], v[42:43], v[4:5]
    v_cvt_pk_bf16_f32 v42, 0, v42
    v_cvt_pk_bf16_f32 v43, 0, v43
    v_pk_add_f32 v[42:43], v[42:43], v[6:7]
    v_cvt_pk_bf16_f32 v13, v42, v43
    v_mov_b32 v22, v13
    v_lshlrev_b32 v40, 16, v14
    v_and_b32 v41, 0xffff0000, v14
    v_pk_mul_f32 v[40:41], v[40:41], v[4:5]
    v_cvt_pk_bf16_f32 v40, 0, v40
    v_cvt_pk_bf16_f32 v41, 0, v41
    v_pk_add_f32 v[40:41], v[40:41], v[6:7]
    v_cvt_pk_bf16_f32 v14, v40, v41
    v_mov_b32 v23, v14
    v_lshlrev_b32 v42, 16, v15
    v_and_b32 v43, 0xffff0000, v15
    v_pk_mul_f32 v[42:43], v[42:43], v[4:5]
    v_cvt_pk_bf16_f32 v42, 0, v42
    v_cvt_pk_bf16_f32 v43, 0, v43
    v_pk_add_f32 v[42:43], v[42:43], v[6:7]
    v_cvt_pk_bf16_f32 v15, v42, v43
    v_alignbit_b32 v24, v9, v8, 16
    v_alignbit_b32 v25, v10, v9, 16
    v_alignbit_b32 v32, v10, v9, 16
    v_alignbit_b32 v26, v11, v10, 16
    v_alignbit_b32 v33, v11, v10, 16
    v_alignbit_b32 v27, v12, v11, 16
    v_alignbit_b32 v34, v12, v11, 16
    v_alignbit_b32 v28, v13, v12, 16
    v_alignbit_b32 v35, v13, v12, 16
    v_alignbit_b32 v29, v14, v13, 16
    v_alignbit_b32 v36, v14, v13, 16
    v_alignbit_b32 v30, v15, v14, 16
    v_alignbit_b32 v37, v15, v14, 16
    ds_write_b128 v2, v[24:27] offset:256
    ds_write_b128 v2, v[18:21] offset:4640
    ds_write_b128 v2, v[32:35] offset:9024
    ds_write_b128 v2, v[10:13] offset:13408
    ds_write_b128 v2, v[26:29] offset:17792
    ds_write_b128 v2, v[20:23] offset:22176
    ds_write_b128 v2, v[34:37] offset:26560
    ds_write_b128 v2, v[12:15] offset:30944
    v_and_b32 v4, 7, v0
    v_mul_u32_u24 v4, 274, v4
    v_bfe_u32 v5, v0, 3, 1
    v_lshl_add_u32 v4, v5, 4, v4
    v_lshrrev_b32 v5, 4, v0
    v_sub_u32 v4, v4, v5
    v_add_u32 v4, 27, v4
    v_lshlrev_b32 v4, 4, v4
    s_lshl_b32 s36, s33, 7
    v_subrev_u32 v4, s36, v4
    v_and_b32 v6, 15, v0
    v_add_u32 v7, v6, v5
    v_lshlrev_b32 v7, 4, v7
    s_add_u32 s36, s36, 35072
    v_add_u32 v7, s36, v7
    s_waitcnt vmcnt(0) lgkmcnt(0)
    s_barrier
    ds_read_b128 v[104:107], v7 offset:0
    ds_read_b128 v[40:43], v4 offset:64
    ds_read_b128 v[108:111], v7 offset:512
    ds_read_b128 v[44:47], v4 offset:576
    ds_read_b128 v[112:115], v7 offset:1024
    ds_read_b128 v[48:51], v4 offset:1088
    ds_read_b128 v[116:119], v7 offset:1536
    ds_read_b128 v[52:55], v4 offset:1600
    ds_read_b128 v[120:123], v7 offset:2048
    ds_read_b128 v[56:59], v4 offset:2112
    ds_read_b128 v[124:127], v7 offset:2560
    ds_read_b128 v[60:63], v4 offset:2624
    s_waitcnt lgkmcnt(11)
    s_waitcnt lgkmcnt(10)
    v_mfma_f32_16x16x32_bf16 v[8:11], v[40:43], v[104:107], 0
    ds_read_b128 v[128:131], v7 offset:3072
    s_waitcnt lgkmcnt(9)
    v_mfma_f32_16x16x32_bf16 v[12:15], v[44:47], v[104:107], 0
    ds_read_b128 v[64:67], v4 offset:3136
    v_mfma_f32_16x16x32_bf16 v[12:15], v[40:43], v[108:111], v[12:15]
    ds_read_b128 v[132:135], v7 offset:3584
    v_mfma_f32_16x16x32_bf16 v[16:19], v[44:47], v[108:111], 0
    ds_read_b128 v[68:71], v4 offset:3648
    s_waitcnt lgkmcnt(10)
    v_mfma_f32_16x16x32_bf16 v[16:19], v[48:51], v[104:107], v[16:19]
    ds_read_b128 v[136:139], v7 offset:64
    v_mfma_f32_16x16x32_bf16 v[20:23], v[48:51], v[108:111], 0
    ds_read_b128 v[72:75], v4 offset:0
    v_mfma_f32_16x16x32_bf16 v[16:19], v[40:43], v[112:115], v[16:19]
    ds_read_b128 v[140:143], v7 offset:576
    v_mfma_f32_16x16x32_bf16 v[20:23], v[44:47], v[112:115], v[20:23]
    ds_read_b128 v[76:79], v4 offset:512
    v_mfma_f32_16x16x32_bf16 v[24:27], v[48:51], v[112:115], 0
    ds_read_b128 v[144:147], v7 offset:1088
    s_waitcnt lgkmcnt(13)
    v_mfma_f32_16x16x32_bf16 v[20:23], v[52:55], v[104:107], v[20:23]
    ds_read_b128 v[80:83], v4 offset:1024
    v_mfma_f32_16x16x32_bf16 v[24:27], v[52:55], v[108:111], v[24:27]
    ds_read_b128 v[148:151], v7 offset:1600
    v_mfma_f32_16x16x32_bf16 v[28:31], v[52:55], v[112:115], 0
    ds_read_b128 v[84:87], v4 offset:1536
    v_mfma_f32_16x16x32_bf16 v[20:23], v[40:43], v[116:119], v[20:23]
    ds_read_b128 v[152:155], v7 offset:2112
    v_mfma_f32_16x16x32_bf16 v[24:27], v[44:47], v[116:119], v[24:27]
    ds_read_b128 v[88:91], v4 offset:2048
    v_mfma_f32_16x16x32_bf16 v[28:31], v[48:51], v[116:119], v[28:31]
    ds_read_b128 v[156:159], v7 offset:2624
    v_mfma_f32_16x16x32_bf16 v[32:35], v[52:55], v[116:119], 0
    ds_read_b128 v[92:95], v4 offset:2560
    s_waitcnt lgkmcnt(15)
    v_mfma_f32_16x16x32_bf16 v[24:27], v[56:59], v[104:107], v[24:27]
    ds_read_b128 v[160:163], v7 offset:3136
    v_mfma_f32_16x16x32_bf16 v[28:31], v[56:59], v[108:111], v[28:31]
    ds_read_b128 v[96:99], v4 offset:3072
    v_mfma_f32_16x16x32_bf16 v[32:35], v[56:59], v[112:115], v[32:35]
    ds_read_b128 v[164:167], v7 offset:3648
    v_mfma_f32_16x16x32_bf16 v[36:39], v[56:59], v[116:119], 0
    ds_read_b128 v[100:103], v4 offset:3584
    v_mfma_f32_16x16x32_bf16 v[24:27], v[40:43], v[120:123], v[24:27]
    v_mfma_f32_16x16x32_bf16 v[28:31], v[44:47], v[120:123], v[28:31]
    v_mfma_f32_16x16x32_bf16 v[32:35], v[48:51], v[120:123], v[32:35]
    v_mfma_f32_16x16x32_bf16 v[36:39], v[52:55], v[120:123], v[36:39]
    v_mfma_f32_16x16x32_bf16 v[28:31], v[60:63], v[104:107], v[28:31]
    v_mfma_f32_16x16x32_bf16 v[32:35], v[60:63], v[108:111], v[32:35]
    v_mfma_f32_16x16x32_bf16 v[36:39], v[60:63], v[112:115], v[36:39]
    v_mfma_f32_16x16x32_bf16 v[28:31], v[40:43], v[124:127], v[28:31]
    v_mfma_f32_16x16x32_bf16 v[32:35], v[44:47], v[124:127], v[32:35]
    v_mfma_f32_16x16x32_bf16 v[36:39], v[48:51], v[124:127], v[36:39]
    s_waitcnt lgkmcnt(15)
    v_mfma_f32_16x16x32_bf16 v[32:35], v[64:67], v[104:107], v[32:35]
    v_mfma_f32_16x16x32_bf16 v[36:39], v[64:67], v[108:111], v[36:39]
    v_mfma_f32_16x16x32_bf16 v[32:35], v[40:43], v[128:131], v[32:35]
    v_mfma_f32_16x16x32_bf16 v[36:39], v[44:47], v[128:131], v[36:39]
    v_mfma_f32_16x16x32_bf16 v[36:39], v[68:71], v[104:107], v[36:39]
    v_mfma_f32_16x16x32_bf16 v[36:39], v[40:43], v[132:135], v[36:39]
    s_waitcnt lgkmcnt(14)
    v_mfma_f32_16x16x32_bf16 v[8:11], v[72:75], v[136:139], v[8:11]
    s_waitcnt lgkmcnt(12)
    v_mfma_f32_16x16x32_bf16 v[12:15], v[76:79], v[136:139], v[12:15]
    v_mfma_f32_16x16x32_bf16 v[12:15], v[72:75], v[140:143], v[12:15]
    v_mfma_f32_16x16x32_bf16 v[16:19], v[76:79], v[140:143], v[16:19]
    s_waitcnt lgkmcnt(10)
    v_mfma_f32_16x16x32_bf16 v[16:19], v[80:83], v[136:139], v[16:19]
    v_mfma_f32_16x16x32_bf16 v[20:23], v[80:83], v[140:143], v[20:23]
    v_mfma_f32_16x16x32_bf16 v[16:19], v[72:75], v[144:147], v[16:19]
    v_mfma_f32_16x16x32_bf16 v[20:23], v[76:79], v[144:147], v[20:23]
    v_mfma_f32_16x16x32_bf16 v[24:27], v[80:83], v[144:147], v[24:27]
    s_waitcnt lgkmcnt(8)
    v_mfma_f32_16x16x32_bf16 v[20:23], v[84:87], v[136:139], v[20:23]
    v_mfma_f32_16x16x32_bf16 v[24:27], v[84:87], v[140:143], v[24:27]
    v_mfma_f32_16x16x32_bf16 v[28:31], v[84:87], v[144:147], v[28:31]
    v_mfma_f32_16x16x32_bf16 v[20:23], v[72:75], v[148:151], v[20:23]
    v_mfma_f32_16x16x32_bf16 v[24:27], v[76:79], v[148:151], v[24:27]
    v_mfma_f32_16x16x32_bf16 v[28:31], v[80:83], v[148:151], v[28:31]
    v_mfma_f32_16x16x32_bf16 v[32:35], v[84:87], v[148:151], v[32:35]
    s_waitcnt lgkmcnt(6)
    v_mfma_f32_16x16x32_bf16 v[24:27], v[88:91], v[136:139], v[24:27]
    v_mfma_f32_16x16x32_bf16 v[28:31], v[88:91], v[140:143], v[28:31]
    v_mfma_f32_16x16x32_bf16 v[32:35], v[88:91], v[144:147], v[32:35]
    v_mfma_f32_16x16x32_bf16 v[36:39], v[88:91], v[148:151], v[36:39]
    v_mfma_f32_16x16x32_bf16 v[24:27], v[72:75], v[152:155], v[24:27]
    v_mfma_f32_16x16x32_bf16 v[28:31], v[76:79], v[152:155], v[28:31]
    v_mfma_f32_16x16x32_bf16 v[32:35], v[80:83], v[152:155], v[32:35]
    v_mfma_f32_16x16x32_bf16 v[36:39], v[84:87], v[152:155], v[36:39]
    s_waitcnt lgkmcnt(4)
    v_mfma_f32_16x16x32_bf16 v[28:31], v[92:95], v[136:139], v[28:31]
    v_mfma_f32_16x16x32_bf16 v[32:35], v[92:95], v[140:143], v[32:35]
    v_mfma_f32_16x16x32_bf16 v[36:39], v[92:95], v[144:147], v[36:39]
    v_mfma_f32_16x16x32_bf16 v[28:31], v[72:75], v[156:159], v[28:31]
    v_mfma_f32_16x16x32_bf16 v[32:35], v[76:79], v[156:159], v[32:35]
    v_mfma_f32_16x16x32_bf16 v[36:39], v[80:83], v[156:159], v[36:39]
    s_waitcnt lgkmcnt(2)
    v_mfma_f32_16x16x32_bf16 v[32:35], v[96:99], v[136:139], v[32:35]
    v_mfma_f32_16x16x32_bf16 v[36:39], v[96:99], v[140:143], v[36:39]
    v_mfma_f32_16x16x32_bf16 v[32:35], v[72:75], v[160:163], v[32:35]
    v_mfma_f32_16x16x32_bf16 v[36:39], v[76:79], v[160:163], v[36:39]
    s_waitcnt lgkmcnt(0)
    v_mfma_f32_16x16x32_bf16 v[36:39], v[100:103], v[136:139], v[36:39]
    v_mfma_f32_16x16x32_bf16 v[36:39], v[72:75], v[164:167], v[36:39]
    v_lshrrev_b32 v4, 1, v5
    v_lshl_add_u32 v4, v4, 4, v6
    v_and_b32 v7, 1, v5
    v_lshlrev_b32 v3, 3, v7
    v_lshl_add_u32 v3, v4, 4, v3
    s_lshl_b32 s36, s33, 10
    v_add_u32 v3, s36, v3
    ds_read_b64 v[40:41], v3 offset:30944
    ds_read_b64 v[42:43], v3 offset:31456
    v_lshl_add_u32 v4, v7, 5, v4
    v_mul_u32_u24 v4, 9216, v4
    s_mul_i32 s23, s33, 589824
    s_add_u32 s23, s23, s22
    v_lshlrev_b32 v2, 4, v0
    s_waitcnt lgkmcnt(0)
    s_barrier
    s_cmp_eq_u32 s33, 0
    s_cbranch_scc1 convkernel_own_6
    s_sub_u32 s36, s33, 1
    s_and_b32 s36, s36, 3
    s_lshl_b32 s36, s36, 11
    v_add_u32 v3, s36, v2
    ds_write_b128 v3, v[8:11] offset:0
    ds_write_b128 v3, v[12:15] offset:1024
    s_branch convkernel_done_7
convkernel_own_6:
    v_mov_b32 v48, v8
    v_mov_b32 v49, v9
    v_mov_b32 v50, v10
    v_mov_b32 v51, v11
    v_mov_b32 v52, v12
    v_mov_b32 v53, v13
    v_mov_b32 v54, v14
    v_mov_b32 v55, v15
convkernel_done_7:
    s_cmp_eq_u32 s33, 1
    s_cbranch_scc1 convkernel_own_8
    s_sub_u32 s36, s33, 2
    s_and_b32 s36, s36, 3
    s_lshl_b32 s36, s36, 11
    v_add_u32 v3, s36, v2
    ds_write_b128 v3, v[16:19] offset:6144
    ds_write_b128 v3, v[20:23] offset:7168
    s_branch convkernel_done_9
convkernel_own_8:
    v_mov_b32 v48, v16
    v_mov_b32 v49, v17
    v_mov_b32 v50, v18
    v_mov_b32 v51, v19
    v_mov_b32 v52, v20
    v_mov_b32 v53, v21
    v_mov_b32 v54, v22
    v_mov_b32 v55, v23
convkernel_done_9:
    s_cmp_eq_u32 s33, 2
    s_cbranch_scc1 convkernel_own_10
    s_sub_u32 s36, s33, 3
    s_and_b32 s36, s36, 3
    s_lshl_b32 s36, s36, 11
    v_add_u32 v3, s36, v2
    ds_write_b128 v3, v[24:27] offset:12288
    ds_write_b128 v3, v[28:31] offset:13312
    s_branch convkernel_done_11
convkernel_own_10:
    v_mov_b32 v48, v24
    v_mov_b32 v49, v25
    v_mov_b32 v50, v26
    v_mov_b32 v51, v27
    v_mov_b32 v52, v28
    v_mov_b32 v53, v29
    v_mov_b32 v54, v30
    v_mov_b32 v55, v31
convkernel_done_11:
    s_cmp_eq_u32 s33, 3
    s_cbranch_scc1 convkernel_own_12
    s_sub_u32 s36, s33, 4
    s_and_b32 s36, s36, 3
    s_lshl_b32 s36, s36, 11
    v_add_u32 v3, s36, v2
    ds_write_b128 v3, v[32:35] offset:18432
    ds_write_b128 v3, v[36:39] offset:19456
    s_branch convkernel_done_13
convkernel_own_12:
    v_mov_b32 v48, v32
    v_mov_b32 v49, v33
    v_mov_b32 v50, v34
    v_mov_b32 v51, v35
    v_mov_b32 v52, v36
    v_mov_b32 v53, v37
    v_mov_b32 v54, v38
    v_mov_b32 v55, v39
convkernel_done_13:
    s_mul_i32 s36, s33, 6144
    v_add_u32 v3, s36, v2
    s_waitcnt lgkmcnt(0)
    s_barrier
    ds_read_b128 v[56:59], v3 offset:0
    ds_read_b128 v[60:63], v3 offset:1024
    ds_read_b128 v[64:67], v3 offset:2048
    ds_read_b128 v[68:71], v3 offset:3072
    ds_read_b128 v[72:75], v3 offset:4096
    ds_read_b128 v[76:79], v3 offset:5120
    v_lshlrev_b32 v80, 16, v40
    v_mul_f32 v80, s27, v80
    v_cvt_pk_bf16_f32 v80, 0, v80
    v_and_b32 v81, 0xffff0000, v40
    v_mul_f32 v81, s27, v81
    v_cvt_pk_bf16_f32 v81, 0, v81
    v_lshlrev_b32 v82, 16, v41
    v_mul_f32 v82, s27, v82
    v_cvt_pk_bf16_f32 v82, 0, v82
    v_and_b32 v83, 0xffff0000, v41
    v_mul_f32 v83, s27, v83
    v_cvt_pk_bf16_f32 v83, 0, v83
    v_lshlrev_b32 v84, 16, v42
    v_mul_f32 v84, s27, v84
    v_cvt_pk_bf16_f32 v84, 0, v84
    v_and_b32 v85, 0xffff0000, v42
    v_mul_f32 v85, s27, v85
    v_cvt_pk_bf16_f32 v85, 0, v85
    v_lshlrev_b32 v86, 16, v43
    v_mul_f32 v86, s27, v86
    v_cvt_pk_bf16_f32 v86, 0, v86
    v_and_b32 v87, 0xffff0000, v43
    v_mul_f32 v87, s27, v87
    v_cvt_pk_bf16_f32 v87, 0, v87
    s_waitcnt lgkmcnt(4)
    v_pk_add_f32 v[48:49], v[48:49], v[56:57]
    v_pk_add_f32 v[50:51], v[50:51], v[58:59]
    v_pk_add_f32 v[52:53], v[52:53], v[60:61]
    v_pk_add_f32 v[54:55], v[54:55], v[62:63]
    s_waitcnt lgkmcnt(2)
    v_pk_add_f32 v[48:49], v[48:49], v[64:65]
    v_pk_add_f32 v[50:51], v[50:51], v[66:67]
    v_pk_add_f32 v[52:53], v[52:53], v[68:69]
    v_pk_add_f32 v[54:55], v[54:55], v[70:71]
    s_waitcnt lgkmcnt(0)
    v_pk_add_f32 v[48:49], v[48:49], v[72:73]
    v_pk_add_f32 v[50:51], v[50:51], v[74:75]
    v_pk_add_f32 v[52:53], v[52:53], v[76:77]
    v_pk_add_f32 v[54:55], v[54:55], v[78:79]
    v_cvt_pk_bf16_f32 v48, 0, v48
    v_add_f32 v48, v48, v80
    v_cvt_pk_bf16_f32 v48, 0, v48
    v_mul_f32 v48, s26, v48
    v_cvt_pk_bf16_f32 v49, 0, v49
    v_add_f32 v49, v49, v81
    v_cvt_pk_bf16_f32 v49, 0, v49
    v_mul_f32 v49, s26, v49
    v_cvt_pk_bf16_f32 v50, 0, v50
    v_add_f32 v50, v50, v82
    v_cvt_pk_bf16_f32 v50, 0, v50
    v_mul_f32 v50, s26, v50
    v_cvt_pk_bf16_f32 v51, 0, v51
    v_add_f32 v51, v51, v83
    v_cvt_pk_bf16_f32 v51, 0, v51
    v_mul_f32 v51, s26, v51
    v_cvt_pk_bf16_f32 v52, 0, v52
    v_add_f32 v52, v52, v84
    v_cvt_pk_bf16_f32 v52, 0, v52
    v_mul_f32 v52, s26, v52
    v_cvt_pk_bf16_f32 v53, 0, v53
    v_add_f32 v53, v53, v85
    v_cvt_pk_bf16_f32 v53, 0, v53
    v_mul_f32 v53, s26, v53
    v_cvt_pk_bf16_f32 v54, 0, v54
    v_add_f32 v54, v54, v86
    v_cvt_pk_bf16_f32 v54, 0, v54
    v_mul_f32 v54, s26, v54
    v_cvt_pk_bf16_f32 v55, 0, v55
    v_add_f32 v55, v55, v87
    v_cvt_pk_bf16_f32 v55, 0, v55
    v_mul_f32 v55, s26, v55
    v_cvt_pk_bf16_f32 v8, v48, v49
    v_cvt_pk_bf16_f32 v9, v50, v51
    v_cvt_pk_bf16_f32 v10, v52, v53
    v_cvt_pk_bf16_f32 v11, v54, v55
    s_nop 0
    v_permlane16_swap_b32 v8, v10
    v_permlane16_swap_b32 v9, v11
    buffer_store_dwordx4 v[8:11], v4, s[16:19], s23 offen
    s_endpgm
convkernel_role_3:
    s_load_dwordx2 s[4:5], s[0:1], 80
    s_mul_i32 s16, s3, 82944
    s_add_u32 s16, s16, 0
    v_lshlrev_b32 v1, 7, v0
    s_waitcnt lgkmcnt(0)
    s_mov_b32 s8, s4
    s_mov_b32 s9, s5
    s_mov_b32 s10, 0x510000
    s_mov_b32 s11, 0x00020000
    buffer_load_dword v8, v1, s[8:11], s16 offen
    s_add_u32 s16, s16, 32768
    buffer_load_dword v9, v1, s[8:11], s16 offen
    s_add_u32 s16, s16, 32768
    v_cmp_gt_u32 vcc, 17408, v1
    v_mov_b32 v2, -1
    s_nop 0
    v_cndmask_b32 v1, v2, v1, vcc
    buffer_load_dword v10, v1, s[8:11], s16 offen
    s_add_u32 s16, s16, 32768
    s_waitcnt vmcnt(0)
    s_endpgm
convkernel_role_4:
    s_load_dwordx2 s[4:5], s[0:1], 88
    s_mul_i32 s16, s3, 82944
    s_add_u32 s16, s16, 0
    v_lshlrev_b32 v1, 7, v0
    s_waitcnt lgkmcnt(0)
    s_mov_b32 s8, s4
    s_mov_b32 s9, s5
    s_mov_b32 s10, 0x510000
    s_mov_b32 s11, 0x00020000
    buffer_load_dword v8, v1, s[8:11], s16 offen
    s_add_u32 s16, s16, 32768
    buffer_load_dword v9, v1, s[8:11], s16 offen
    s_add_u32 s16, s16, 32768
    v_cmp_gt_u32 vcc, 17408, v1
    v_mov_b32 v2, -1
    s_nop 0
    v_cndmask_b32 v1, v2, v1, vcc
    buffer_load_dword v10, v1, s[8:11], s16 offen
    s_add_u32 s16, s16, 32768
    s_waitcnt vmcnt(0)
    s_endpgm
.globl gemm1_kernel
.p2align 8
.type gemm1_kernel,@function
gemm1_kernel:
    s_cmp_ge_u32 s2, 256
    s_cbranch_scc1 gemm1kernel_end_1
    s_load_dwordx2 s[4:5], s[0:1], 136
    s_load_dwordx4 s[36:39], s[0:1], 80
    s_load_dwordx2 s[44:45], s[0:1], 0
    s_and_b32 s26, s2, 3
    s_lshl_b32 s26, s26, 3
    s_bfe_u32 s20, s2, 0x30003
    s_add_u32 s20, s20, s26
    s_bfe_u32 s26, s2, 0x10002
    s_lshl_b32 s26, s26, 2
    s_lshr_b32 s21, s2, 6
    s_add_u32 s21, s21, s26
    v_lshrrev_b32 v1, 6, v0
    v_and_b32 v0, 63, v0
    v_readfirstlane_b32 s22, v1
    v_lshlrev_b32 v1, 4, v0
    s_lshr_b32 s23, s22, 1
    s_waitcnt lgkmcnt(0)
    s_cmp_eq_u32 s23, 0
    s_cselect_b32 s12, s36, s38
    s_cselect_b32 s13, s37, s39
    s_mov_b32 s14, 0x510000
    s_mov_b32 s15, 0x00020000
    s_lshl_b32 s47, s21, 5
    s_add_u32 s47, s47, s20
    s_add_u32 s36, s4, 0x490000
    s_addc_u32 s37, s5, 0
    s_mov_b32 s38, 0x240000
    s_mov_b32 s39, 0x00020000
    s_mov_b32 s40, s44
    s_mov_b32 s41, s45
    s_mov_b32 s42, 0x240000
    s_mov_b32 s43, 0x00020000
    s_add_u32 s48, s4, 0x4000
    s_addc_u32 s49, s5, 0
    s_mov_b32 s50, 0x1200
    s_mov_b32 s51, 0x00020000
    v_lshlrev_b32 v24, 4, v0
    v_lshlrev_b32 v25, 1, v0
    v_lshlrev_b32 v26, 3, v0
    s_mul_i32 s52, s47, 9216
    s_mul_i32 s53, s22, 2304
    s_add_u32 s53, s53, s52
    s_lshl_b32 s54, s22, 2
    s_add_u32 s54, s54, s52
    buffer_load_ushort v66, v25, s[40:43], s53 offen offset:0
    buffer_load_ushort v67, v25, s[40:43], s53 offen offset:1152
    buffer_load_dword v38, v24, s[36:39], s54 offen offset:0
    buffer_load_ushort v68, v25, s[40:43], s53 offen offset:128
    buffer_load_ushort v69, v25, s[40:43], s53 offen offset:1280
    buffer_load_dword v39, v24, s[36:39], s54 offen offset:1024
    buffer_load_ushort v70, v25, s[40:43], s53 offen offset:256
    buffer_load_ushort v71, v25, s[40:43], s53 offen offset:1408
    buffer_load_dword v40, v24, s[36:39], s54 offen offset:2048
    buffer_load_ushort v72, v25, s[40:43], s53 offen offset:384
    buffer_load_ushort v73, v25, s[40:43], s53 offen offset:1536
    buffer_load_dword v41, v24, s[36:39], s54 offen offset:3072
    buffer_load_ushort v74, v25, s[40:43], s53 offen offset:512
    buffer_load_ushort v75, v25, s[40:43], s53 offen offset:1664
    s_add_u32 s54, s54, 4096
    buffer_load_dword v42, v24, s[36:39], s54 offen offset:0
    buffer_load_ushort v76, v25, s[40:43], s53 offen offset:640
    buffer_load_ushort v77, v25, s[40:43], s53 offen offset:1792
    buffer_load_dword v43, v24, s[36:39], s54 offen offset:1024
    buffer_load_ushort v78, v25, s[40:43], s53 offen offset:768
    buffer_load_ushort v79, v25, s[40:43], s53 offen offset:1920
    buffer_load_dword v44, v24, s[36:39], s54 offen offset:2048
    buffer_load_ushort v80, v25, s[40:43], s53 offen offset:896
    buffer_load_ushort v81, v25, s[40:43], s53 offen offset:2048
    buffer_load_dword v45, v24, s[36:39], s54 offen offset:3072
    buffer_load_ushort v82, v25, s[40:43], s53 offen offset:1024
    buffer_load_ushort v83, v25, s[40:43], s53 offen offset:2176
    s_add_u32 s54, s54, 4096
    buffer_load_dword v46, v24, s[36:39], s54 offen offset:0
    buffer_load_dwordx2 v[48:49], v26, s[48:51], 0 offen offset:0
    buffer_load_dwordx2 v[50:51], v26, s[48:51], 0 offen offset:512
    buffer_load_dwordx2 v[52:53], v26, s[48:51], 0 offen offset:1024
    buffer_load_dwordx2 v[54:55], v26, s[48:51], 0 offen offset:1536
    buffer_load_dwordx2 v[56:57], v26, s[48:51], 0 offen offset:2048
    buffer_load_dwordx2 v[58:59], v26, s[48:51], 0 offen offset:2560
    buffer_load_dwordx2 v[60:61], v26, s[48:51], 0 offen offset:3072
    buffer_load_dwordx2 v[62:63], v26, s[48:51], 0 offen offset:3584
    s_mov_b32 s54, 4096
    buffer_load_dwordx2 v[64:65], v26, s[48:51], s54 offen
    s_lshl_b32 s26, s23, 2
    v_bfe_u32 v4, v0, 4, 1
    v_lshlrev_b32 v4, 1, v4
    v_or_b32 v4, s26, v4
    v_and_b32 v5, 7, v0
    v_xor_b32 v4, v4, v5
    v_lshrrev_b32 v5, 3, v0
    v_mul_u32_u24 v2, 9216, v5
    v_lshl_add_u32 v2, v4, 4, v2
    v_lshrrev_b32 v5, 1, v0
    v_mul_u32_u24 v3, 9216, v5
    v_and_b32 v5, 1, v0
    v_lshl_add_u32 v3, v5, 4, v3
    v_bfe_u32 v4, v0, 4, 1
    v_lshrrev_b32 v5, 5, v0
    v_bfe_u32 v6, v0, 2, 2
    v_lshl_add_u32 v5, v5, 3, v6
    v_and_b32 v7, 1, v0
    v_lshlrev_b32 v7, 4, v7
    v_bfe_u32 v23, v0, 1, 1
    v_lshl_add_u32 v7, v23, 3, v7
    v_lshl_add_u32 v7, v4, 11, v7
    v_lshl_add_u32 v20, v5, 5, v7
    v_lshl_add_u32 v7, v5, 7, v7
    v_lshrrev_b32 v6, 1, v6
    v_lshl_add_u32 v6, v4, 1, v6
    v_xor_b32 v23, 0, v6
    v_lshl_add_u32 v8, v23, 5, v7
    v_add_u32 v9, 0x10000, v8
    v_add_u32 v10, 0x20000, v8
    v_xor_b32 v23, 1, v6
    v_lshl_add_u32 v11, v23, 5, v7
    v_add_u32 v12, 0x10000, v11
    v_add_u32 v13, 0x20000, v11
    v_xor_b32 v23, 2, v6
    v_lshl_add_u32 v14, v23, 5, v7
    v_add_u32 v15, 0x10000, v14
    v_add_u32 v16, 0x20000, v14
    v_xor_b32 v23, 3, v6
    v_lshl_add_u32 v17, v23, 5, v7
    v_add_u32 v18, 0x10000, v17
    v_add_u32 v19, 0x20000, v17
    v_add_u32 v21, 0x10000, v20
    v_add_u32 v22, 0x20000, v20
    s_add_u32 s8, s4, 0x910000
    s_addc_u32 s9, s5, 0
    s_mov_b32 s10, 0x240000
    s_mov_b32 s11, 0x00020000
    s_add_u32 s16, s4, 0x1a80000
    s_addc_u32 s17, s5, 0
    s_mov_b32 s18, 0x1200000
    s_mov_b32 s19, 0x00020000
    s_lshl_b32 s26, s21, 3
    s_lshl_b32 s27, s22, 1
    s_add_u32 s26, s26, s27
    s_mul_i32 s27, s26, 36864
    s_mul_i32 s24, s26, 294912
    s_lshl_b32 s28, s20, 13
    s_add_u32 s33, s24, s28
    s_lshl_b32 s28, s20, 10
    s_add_u32 s34, s24, s28
    s_add_u32 s34, s34, 262144
    s_and_b32 s28, s22, 1
    s_mul_i32 s31, s28, 73728
    s_lshl_b32 s29, s20, 8
    s_add_u32 s31, s31, s29
    s_mul_i32 s32, s28, 294912
    s_lshl_b32 s29, s20, 5
    s_add_u32 s32, s32, s29
    s_add_u32 s32, s32, 8192
    s_lshl_b32 s25, s22, 10
    s_add_u32 m0, s25, 0
    s_add_u32 s26, s31, 0
    buffer_load_dwordx4 v2, s[12:15], s26 offen lds
    s_add_u32 m0, s25, 4096
    s_add_u32 s26, s31, 147456
    buffer_load_dwordx4 v2, s[12:15], s26 offen lds
    s_add_u32 m0, s25, 8192
    s_add_u32 s26, s31, 294912
    buffer_load_dwordx4 v2, s[12:15], s26 offen lds
    s_add_u32 m0, s25, 12288
    s_add_u32 s26, s31, 442368
    buffer_load_dwordx4 v2, s[12:15], s26 offen lds
    s_add_u32 m0, s25, 16384
    s_add_u32 s26, s31, 589824
    buffer_load_dwordx4 v2, s[12:15], s26 offen lds
    s_add_u32 m0, s25, 20480
    s_add_u32 s26, s31, 737280
    buffer_load_dwordx4 v2, s[12:15], s26 offen lds
    s_add_u32 m0, s25, 24576
    s_add_u32 s26, s31, 884736
    buffer_load_dwordx4 v2, s[12:15], s26 offen lds
    s_add_u32 m0, s25, 28672
    s_add_u32 s26, s31, 1032192
    buffer_load_dwordx4 v2, s[12:15], s26 offen lds
    s_add_u32 m0, s25, 32768
    s_add_u32 s26, s31, 1179648
    buffer_load_dwordx4 v2, s[12:15], s26 offen lds
    s_add_u32 s36, s4, 0x6d0000
    s_addc_u32 s37, s5, 0
    s_mov_b32 s38, 0x240000
    s_mov_b32 s39, 0x00020000
    s_add_u32 s40, s4, 0x910000
    s_addc_u32 s41, s5, 0
    s_mov_b32 s42, 0x240000
    s_mov_b32 s43, 0x00020000
    s_mul_i32 s54, s22, 4608
    s_add_u32 s54, s54, 126976
    v_add_u32 v90, s54, v25
    v_add_u32 v91, s54, v24
    s_waitcnt vmcnt(42)
    v_lshlrev_b32 v66, 16, v66
    v_lshlrev_b32 v67, 16, v67
    v_lshlrev_b32 v86, 16, v38
    v_and_b32 v87, 0xffff0000, v38
    v_pk_add_f32 v[66:67], v[66:67], v[86:87]
    v_cvt_pk_bf16_f32 v28, v66, v67
    v_lshlrev_b32 v66, 16, v28
    v_and_b32 v67, 0xffff0000, v28
    v_mov_b32 v84, v66
    v_mov_b32 v85, v67
    ds_write_b16 v90, v28 offset:0
    ds_write_b16_d16_hi v90, v28 offset:1152
    s_waitcnt vmcnt(39)
    v_lshlrev_b32 v68, 16, v68
    v_lshlrev_b32 v69, 16, v69
    v_lshlrev_b32 v86, 16, v39
    v_and_b32 v87, 0xffff0000, v39
    v_pk_add_f32 v[68:69], v[68:69], v[86:87]
    v_cvt_pk_bf16_f32 v29, v68, v69
    v_lshlrev_b32 v68, 16, v29
    v_and_b32 v69, 0xffff0000, v29
    v_pk_add_f32 v[84:85], v[84:85], v[68:69]
    ds_write_b16 v90, v29 offset:128
    ds_write_b16_d16_hi v90, v29 offset:1280
    s_waitcnt vmcnt(36)
    v_lshlrev_b32 v70, 16, v70
    v_lshlrev_b32 v71, 16, v71
    v_lshlrev_b32 v86, 16, v40
    v_and_b32 v87, 0xffff0000, v40
    v_pk_add_f32 v[70:71], v[70:71], v[86:87]
    v_cvt_pk_bf16_f32 v30, v70, v71
    v_lshlrev_b32 v70, 16, v30
    v_and_b32 v71, 0xffff0000, v30
    v_pk_add_f32 v[84:85], v[84:85], v[70:71]
    ds_write_b16 v90, v30 offset:256
    ds_write_b16_d16_hi v90, v30 offset:1408
    s_waitcnt vmcnt(33)
    v_lshlrev_b32 v72, 16, v72
    v_lshlrev_b32 v73, 16, v73
    v_lshlrev_b32 v86, 16, v41
    v_and_b32 v87, 0xffff0000, v41
    v_pk_add_f32 v[72:73], v[72:73], v[86:87]
    v_cvt_pk_bf16_f32 v31, v72, v73
    v_lshlrev_b32 v72, 16, v31
    v_and_b32 v73, 0xffff0000, v31
    v_pk_add_f32 v[84:85], v[84:85], v[72:73]
    ds_write_b16 v90, v31 offset:384
    ds_write_b16_d16_hi v90, v31 offset:1536
    s_waitcnt vmcnt(30)
    v_lshlrev_b32 v74, 16, v74
    v_lshlrev_b32 v75, 16, v75
    v_lshlrev_b32 v86, 16, v42
    v_and_b32 v87, 0xffff0000, v42
    v_pk_add_f32 v[74:75], v[74:75], v[86:87]
    v_cvt_pk_bf16_f32 v32, v74, v75
    v_lshlrev_b32 v74, 16, v32
    v_and_b32 v75, 0xffff0000, v32
    v_pk_add_f32 v[84:85], v[84:85], v[74:75]
    ds_write_b16 v90, v32 offset:512
    ds_write_b16_d16_hi v90, v32 offset:1664
    s_waitcnt vmcnt(27)
    v_lshlrev_b32 v76, 16, v76
    v_lshlrev_b32 v77, 16, v77
    v_lshlrev_b32 v86, 16, v43
    v_and_b32 v87, 0xffff0000, v43
    v_pk_add_f32 v[76:77], v[76:77], v[86:87]
    v_cvt_pk_bf16_f32 v33, v76, v77
    v_lshlrev_b32 v76, 16, v33
    v_and_b32 v77, 0xffff0000, v33
    v_pk_add_f32 v[84:85], v[84:85], v[76:77]
    ds_write_b16 v90, v33 offset:640
    ds_write_b16_d16_hi v90, v33 offset:1792
    s_waitcnt vmcnt(24)
    v_lshlrev_b32 v78, 16, v78
    v_lshlrev_b32 v79, 16, v79
    v_lshlrev_b32 v86, 16, v44
    v_and_b32 v87, 0xffff0000, v44
    v_pk_add_f32 v[78:79], v[78:79], v[86:87]
    v_cvt_pk_bf16_f32 v34, v78, v79
    v_lshlrev_b32 v78, 16, v34
    v_and_b32 v79, 0xffff0000, v34
    v_pk_add_f32 v[84:85], v[84:85], v[78:79]
    ds_write_b16 v90, v34 offset:768
    ds_write_b16_d16_hi v90, v34 offset:1920
    s_waitcnt vmcnt(21)
    v_lshlrev_b32 v80, 16, v80
    v_lshlrev_b32 v81, 16, v81
    v_lshlrev_b32 v86, 16, v45
    v_and_b32 v87, 0xffff0000, v45
    v_pk_add_f32 v[80:81], v[80:81], v[86:87]
    v_cvt_pk_bf16_f32 v35, v80, v81
    v_lshlrev_b32 v80, 16, v35
    v_and_b32 v81, 0xffff0000, v35
    v_pk_add_f32 v[84:85], v[84:85], v[80:81]
    ds_write_b16 v90, v35 offset:896
    ds_write_b16_d16_hi v90, v35 offset:2048
    s_waitcnt vmcnt(18)
    v_lshlrev_b32 v82, 16, v82
    v_lshlrev_b32 v83, 16, v83
    v_lshlrev_b32 v86, 16, v46
    v_and_b32 v87, 0xffff0000, v46
    v_pk_add_f32 v[82:83], v[82:83], v[86:87]
    v_cvt_pk_bf16_f32 v36, v82, v83
    v_lshlrev_b32 v82, 16, v36
    v_and_b32 v83, 0xffff0000, v36
    v_pk_add_f32 v[84:85], v[84:85], v[82:83]
    ds_write_b16 v90, v36 offset:1024
    ds_write_b16_d16_hi v90, v36 offset:2176
    v_add_f32_dpp v84, v84, v84 quad_perm:[1,0,3,2] row_mask:0xf bank_mask:0xf
    v_add_f32_dpp v85, v85, v85 quad_perm:[1,0,3,2] row_mask:0xf bank_mask:0xf
    s_nop 0
    v_add_f32_dpp v84, v84, v84 quad_perm:[2,3,0,1] row_mask:0xf bank_mask:0xf
    v_add_f32_dpp v85, v85, v85 quad_perm:[2,3,0,1] row_mask:0xf bank_mask:0xf
    s_nop 0
    v_add_f32_dpp v84, v84, v84 row_half_mirror row_mask:0xf bank_mask:0xf
    v_add_f32_dpp v85, v85, v85 row_half_mirror row_mask:0xf bank_mask:0xf
    s_nop 0
    v_add_f32_dpp v84, v84, v84 row_mirror row_mask:0xf bank_mask:0xf
    v_add_f32_dpp v85, v85, v85 row_mirror row_mask:0xf bank_mask:0xf
    v_mov_b32 v86, v84
    v_mov_b32 v87, v85
    s_nop 0
    v_permlane16_swap_b32 v84, v86
    v_permlane16_swap_b32 v85, v87
    v_add_f32 v84, v84, v86
    v_add_f32 v85, v85, v87
    v_mov_b32 v86, v84
    v_mov_b32 v87, v85
    s_nop 0
    v_permlane32_swap_b32 v84, v86
    v_permlane32_swap_b32 v85, v87
    v_add_f32 v84, v84, v86
    v_add_f32 v85, v85, v87
    s_mov_b32 s52, 0x3ae38e39
    v_mul_f32 v84, s52, v84
    v_mul_f32 v85, s52, v85
    v_pk_add_f32 v[86:87], v[66:67], v[84:85] neg_lo:[0,1] neg_hi:[0,1]
    v_pk_mul_f32 v[88:89], v[86:87], v[86:87]
    v_pk_add_f32 v[86:87], v[68:69], v[84:85] neg_lo:[0,1] neg_hi:[0,1]
    v_pk_fma_f32 v[88:89], v[86:87], v[86:87], v[88:89]
    v_pk_add_f32 v[86:87], v[70:71], v[84:85] neg_lo:[0,1] neg_hi:[0,1]
    v_pk_fma_f32 v[88:89], v[86:87], v[86:87], v[88:89]
    v_pk_add_f32 v[86:87], v[72:73], v[84:85] neg_lo:[0,1] neg_hi:[0,1]
    v_pk_fma_f32 v[88:89], v[86:87], v[86:87], v[88:89]
    v_pk_add_f32 v[86:87], v[74:75], v[84:85] neg_lo:[0,1] neg_hi:[0,1]
    v_pk_fma_f32 v[88:89], v[86:87], v[86:87], v[88:89]
    v_pk_add_f32 v[86:87], v[76:77], v[84:85] neg_lo:[0,1] neg_hi:[0,1]
    v_pk_fma_f32 v[88:89], v[86:87], v[86:87], v[88:89]
    v_pk_add_f32 v[86:87], v[78:79], v[84:85] neg_lo:[0,1] neg_hi:[0,1]
    v_pk_fma_f32 v[88:89], v[86:87], v[86:87], v[88:89]
    v_pk_add_f32 v[86:87], v[80:81], v[84:85] neg_lo:[0,1] neg_hi:[0,1]
    v_pk_fma_f32 v[88:89], v[86:87], v[86:87], v[88:89]
    v_pk_add_f32 v[86:87], v[82:83], v[84:85] neg_lo:[0,1] neg_hi:[0,1]
    v_pk_fma_f32 v[88:89], v[86:87], v[86:87], v[88:89]
    ds_read_b128 v[92:95], v91 offset:0
    ds_read_b128 v[96:99], v91 offset:1024
    ds_read_b128 v[100:103], v91 offset:2048
    v_add_f32_dpp v88, v88, v88 quad_perm:[1,0,3,2] row_mask:0xf bank_mask:0xf
    v_add_f32_dpp v89, v89, v89 quad_perm:[1,0,3,2] row_mask:0xf bank_mask:0xf
    s_nop 0
    v_add_f32_dpp v88, v88, v88 quad_perm:[2,3,0,1] row_mask:0xf bank_mask:0xf
    v_add_f32_dpp v89, v89, v89 quad_perm:[2,3,0,1] row_mask:0xf bank_mask:0xf
    s_nop 0
    v_add_f32_dpp v88, v88, v88 row_half_mirror row_mask:0xf bank_mask:0xf
    v_add_f32_dpp v89, v89, v89 row_half_mirror row_mask:0xf bank_mask:0xf
    s_nop 0
    v_add_f32_dpp v88, v88, v88 row_mirror row_mask:0xf bank_mask:0xf
    v_add_f32_dpp v89, v89, v89 row_mirror row_mask:0xf bank_mask:0xf
    v_mov_b32 v86, v88
    v_mov_b32 v87, v89
    s_nop 0
    v_permlane16_swap_b32 v88, v86
    v_permlane16_swap_b32 v89, v87
    v_add_f32 v88, v88, v86
    v_add_f32 v89, v89, v87
    v_mov_b32 v86, v88
    v_mov_b32 v87, v89
    s_nop 0
    v_permlane32_swap_b32 v88, v86
    v_permlane32_swap_b32 v89, v87
    v_add_f32 v88, v88, v86
    v_add_f32 v89, v89, v87
    v_mul_f32 v88, s52, v88
    v_cvt_pk_bf16_f32 v88, 0, v88
    v_add_f32 v88, 0x3727c5ac, v88
    v_cvt_pk_bf16_f32 v88, 0, v88
    v_sqrt_f32 v88, v88
    v_cvt_pk_bf16_f32 v84, 0, v84
    v_cvt_pk_bf16_f32 v88, 0, v88
    v_rcp_f32 v88, v88
    v_mul_f32 v89, s52, v89
    v_cvt_pk_bf16_f32 v89, 0, v89
    v_add_f32 v89, 0x3727c5ac, v89
    v_cvt_pk_bf16_f32 v89, 0, v89
    v_sqrt_f32 v89, v89
    v_cvt_pk_bf16_f32 v85, 0, v85
    v_cvt_pk_bf16_f32 v89, 0, v89
    v_rcp_f32 v89, v89
    s_waitcnt lgkmcnt(0)
    buffer_store_dwordx4 v[92:95], v24, s[36:39], s53 offen offset:0 sc0 sc1
    buffer_store_dwordx4 v[96:99], v24, s[36:39], s53 offen offset:1024 sc0 sc1
    s_mov_b64 exec, 0xffff
    buffer_store_dwordx4 v[100:103], v24, s[36:39], s53 offen offset:2048 sc0 sc1
    s_mov_b64 exec, -1
    s_waitcnt vmcnt(12)
    v_pk_add_f32 v[66:67], v[66:67], v[84:85] neg_lo:[0,1] neg_hi:[0,1]
    v_cvt_pk_bf16_f32 v66, 0, v66
    v_cvt_pk_bf16_f32 v67, 0, v67
    v_pk_mul_f32 v[66:67], v[66:67], v[88:89]
    v_cvt_pk_bf16_f32 v66, 0, v66
    v_cvt_pk_bf16_f32 v67, 0, v67
    v_pk_mul_f32 v[66:67], v[66:67], v[48:49] op_sel_hi:[1,0]
    v_cvt_pk_bf16_f32 v66, 0, v66
    v_cvt_pk_bf16_f32 v67, 0, v67
    v_pk_add_f32 v[66:67], v[66:67], v[48:49] op_sel:[0,1] op_sel_hi:[1,1]
    v_cvt_pk_bf16_f32 v28, v66, v67
    ds_write_b16 v90, v28 offset:2304
    ds_write_b16_d16_hi v90, v28 offset:3456
    v_pk_add_f32 v[68:69], v[68:69], v[84:85] neg_lo:[0,1] neg_hi:[0,1]
    v_cvt_pk_bf16_f32 v68, 0, v68
    v_cvt_pk_bf16_f32 v69, 0, v69
    v_pk_mul_f32 v[68:69], v[68:69], v[88:89]
    v_cvt_pk_bf16_f32 v68, 0, v68
    v_cvt_pk_bf16_f32 v69, 0, v69
    v_pk_mul_f32 v[68:69], v[68:69], v[50:51] op_sel_hi:[1,0]
    v_cvt_pk_bf16_f32 v68, 0, v68
    v_cvt_pk_bf16_f32 v69, 0, v69
    v_pk_add_f32 v[68:69], v[68:69], v[50:51] op_sel:[0,1] op_sel_hi:[1,1]
    v_cvt_pk_bf16_f32 v29, v68, v69
    ds_write_b16 v90, v29 offset:2432
    ds_write_b16_d16_hi v90, v29 offset:3584
    v_pk_add_f32 v[70:71], v[70:71], v[84:85] neg_lo:[0,1] neg_hi:[0,1]
    v_cvt_pk_bf16_f32 v70, 0, v70
    v_cvt_pk_bf16_f32 v71, 0, v71
    v_pk_mul_f32 v[70:71], v[70:71], v[88:89]
    v_cvt_pk_bf16_f32 v70, 0, v70
    v_cvt_pk_bf16_f32 v71, 0, v71
    v_pk_mul_f32 v[70:71], v[70:71], v[52:53] op_sel_hi:[1,0]
    v_cvt_pk_bf16_f32 v70, 0, v70
    v_cvt_pk_bf16_f32 v71, 0, v71
    v_pk_add_f32 v[70:71], v[70:71], v[52:53] op_sel:[0,1] op_sel_hi:[1,1]
    v_cvt_pk_bf16_f32 v30, v70, v71
    ds_write_b16 v90, v30 offset:2560
    ds_write_b16_d16_hi v90, v30 offset:3712
    v_pk_add_f32 v[72:73], v[72:73], v[84:85] neg_lo:[0,1] neg_hi:[0,1]
    v_cvt_pk_bf16_f32 v72, 0, v72
    v_cvt_pk_bf16_f32 v73, 0, v73
    v_pk_mul_f32 v[72:73], v[72:73], v[88:89]
    v_cvt_pk_bf16_f32 v72, 0, v72
    v_cvt_pk_bf16_f32 v73, 0, v73
    v_pk_mul_f32 v[72:73], v[72:73], v[54:55] op_sel_hi:[1,0]
    v_cvt_pk_bf16_f32 v72, 0, v72
    v_cvt_pk_bf16_f32 v73, 0, v73
    v_pk_add_f32 v[72:73], v[72:73], v[54:55] op_sel:[0,1] op_sel_hi:[1,1]
    v_cvt_pk_bf16_f32 v31, v72, v73
    ds_write_b16 v90, v31 offset:2688
    ds_write_b16_d16_hi v90, v31 offset:3840
    v_pk_add_f32 v[74:75], v[74:75], v[84:85] neg_lo:[0,1] neg_hi:[0,1]
    v_cvt_pk_bf16_f32 v74, 0, v74
    v_cvt_pk_bf16_f32 v75, 0, v75
    v_pk_mul_f32 v[74:75], v[74:75], v[88:89]
    v_cvt_pk_bf16_f32 v74, 0, v74
    v_cvt_pk_bf16_f32 v75, 0, v75
    v_pk_mul_f32 v[74:75], v[74:75], v[56:57] op_sel_hi:[1,0]
    v_cvt_pk_bf16_f32 v74, 0, v74
    v_cvt_pk_bf16_f32 v75, 0, v75
    v_pk_add_f32 v[74:75], v[74:75], v[56:57] op_sel:[0,1] op_sel_hi:[1,1]
    v_cvt_pk_bf16_f32 v32, v74, v75
    ds_write_b16 v90, v32 offset:2816
    ds_write_b16_d16_hi v90, v32 offset:3968
    v_pk_add_f32 v[76:77], v[76:77], v[84:85] neg_lo:[0,1] neg_hi:[0,1]
    v_cvt_pk_bf16_f32 v76, 0, v76
    v_cvt_pk_bf16_f32 v77, 0, v77
    v_pk_mul_f32 v[76:77], v[76:77], v[88:89]
    v_cvt_pk_bf16_f32 v76, 0, v76
    v_cvt_pk_bf16_f32 v77, 0, v77
    v_pk_mul_f32 v[76:77], v[76:77], v[58:59] op_sel_hi:[1,0]
    v_cvt_pk_bf16_f32 v76, 0, v76
    v_cvt_pk_bf16_f32 v77, 0, v77
    v_pk_add_f32 v[76:77], v[76:77], v[58:59] op_sel:[0,1] op_sel_hi:[1,1]
    v_cvt_pk_bf16_f32 v33, v76, v77
    ds_write_b16 v90, v33 offset:2944
    ds_write_b16_d16_hi v90, v33 offset:4096
    v_pk_add_f32 v[78:79], v[78:79], v[84:85] neg_lo:[0,1] neg_hi:[0,1]
    v_cvt_pk_bf16_f32 v78, 0, v78
    v_cvt_pk_bf16_f32 v79, 0, v79
    v_pk_mul_f32 v[78:79], v[78:79], v[88:89]
    v_cvt_pk_bf16_f32 v78, 0, v78
    v_cvt_pk_bf16_f32 v79, 0, v79
    v_pk_mul_f32 v[78:79], v[78:79], v[60:61] op_sel_hi:[1,0]
    v_cvt_pk_bf16_f32 v78, 0, v78
    v_cvt_pk_bf16_f32 v79, 0, v79
    v_pk_add_f32 v[78:79], v[78:79], v[60:61] op_sel:[0,1] op_sel_hi:[1,1]
    v_cvt_pk_bf16_f32 v34, v78, v79
    ds_write_b16 v90, v34 offset:3072
    ds_write_b16_d16_hi v90, v34 offset:4224
    v_pk_add_f32 v[80:81], v[80:81], v[84:85] neg_lo:[0,1] neg_hi:[0,1]
    v_cvt_pk_bf16_f32 v80, 0, v80
    v_cvt_pk_bf16_f32 v81, 0, v81
    v_pk_mul_f32 v[80:81], v[80:81], v[88:89]
    v_cvt_pk_bf16_f32 v80, 0, v80
    v_cvt_pk_bf16_f32 v81, 0, v81
    v_pk_mul_f32 v[80:81], v[80:81], v[62:63] op_sel_hi:[1,0]
    v_cvt_pk_bf16_f32 v80, 0, v80
    v_cvt_pk_bf16_f32 v81, 0, v81
    v_pk_add_f32 v[80:81], v[80:81], v[62:63] op_sel:[0,1] op_sel_hi:[1,1]
    v_cvt_pk_bf16_f32 v35, v80, v81
    ds_write_b16 v90, v35 offset:3200
    ds_write_b16_d16_hi v90, v35 offset:4352
    v_pk_add_f32 v[82:83], v[82:83], v[84:85] neg_lo:[0,1] neg_hi:[0,1]
    v_cvt_pk_bf16_f32 v82, 0, v82
    v_cvt_pk_bf16_f32 v83, 0, v83
    v_pk_mul_f32 v[82:83], v[82:83], v[88:89]
    v_cvt_pk_bf16_f32 v82, 0, v82
    v_cvt_pk_bf16_f32 v83, 0, v83
    v_pk_mul_f32 v[82:83], v[82:83], v[64:65] op_sel_hi:[1,0]
    v_cvt_pk_bf16_f32 v82, 0, v82
    v_cvt_pk_bf16_f32 v83, 0, v83
    v_pk_add_f32 v[82:83], v[82:83], v[64:65] op_sel:[0,1] op_sel_hi:[1,1]
    v_cvt_pk_bf16_f32 v36, v82, v83
    ds_write_b16 v90, v36 offset:3328
    ds_write_b16_d16_hi v90, v36 offset:4480
    s_lshl_b32 s54, s22, 3
    v_lshrrev_b32 v86, 3, v0
    v_add_u32 v86, s54, v86
    v_and_b32 v87, 7, v0
    v_lshrrev_b32 v67, 1, v87
    v_mul_u32_u24 v67, 4608, v67
    v_and_b32 v68, 1, v87
    v_mul_u32_u24 v68, 1152, v68
    v_add_u32 v67, v67, v68
    v_lshl_add_u32 v67, v86, 4, v67
    v_add_u32 v67, 129280, v67
    v_lshrrev_b32 v66, 1, v86
    v_lshlrev_b32 v66, 10, v66
    v_and_b32 v68, 1, v86
    v_lshl_add_u32 v66, v68, 9, v66
    v_lshl_add_u32 v66, v87, 4, v66
    s_lshr_b32 s52, s47, 2
    s_mul_i32 s52, s52, 36864
    s_and_b32 s54, s47, 3
    s_lshl_b32 s54, s54, 7
    s_add_u32 s52, s52, s54
    s_waitcnt lgkmcnt(0)
    s_barrier
    ds_read_b128 v[104:107], v67 offset:0
    ds_read_b128 v[108:111], v67 offset:512
    ds_read_b128 v[112:115], v67 offset:1024
    s_waitcnt lgkmcnt(2)
    buffer_store_dwordx4 v[104:107], v66, s[40:43], s52 offen sc0 sc1
    s_add_u32 s52, s52, 16384
    s_waitcnt lgkmcnt(1)
    buffer_store_dwordx4 v[108:111], v66, s[40:43], s52 offen sc0 sc1
    s_add_u32 s52, s52, 16384
    s_waitcnt lgkmcnt(0)
    s_cmp_lg_u32 s22, 0
    s_cbranch_scc1 gemm1kernel_h2s_2
    buffer_store_dwordx4 v[112:115], v66, s[40:43], s52 offen sc0 sc1
    s_add_u32 s52, s52, 16384
gemm1kernel_h2s_2:
    s_add_u32 s48, s4, 0x3e80000
    s_addc_u32 s49, s5, 0
    s_mov_b32 s50, 0x98000
    s_mov_b32 s51, 0x00020000
    s_lshl_b32 s46, s47, 7
    s_add_u32 s46, s46, 163840
    s_waitcnt vmcnt(0)
    v_mov_b32 v4, 0
    v_mov_b32 v5, 1
    s_barrier
    s_cmp_lg_u32 s22, 0
    s_cbranch_scc1 gemm1kernel_nf_5
    s_mov_b64 exec, 1
    buffer_store_dword v5, v4, s[48:51], s46 offen sc0 sc1
    s_mov_b64 exec, -1
gemm1kernel_nf_5:
    s_add_u32 m0, s25, 36864
    s_add_u32 s26, s31, 128
    buffer_load_dwordx4 v2, s[12:15], s26 offen lds
    s_add_u32 m0, s25, 40960
    s_add_u32 s26, s31, 147584
    buffer_load_dwordx4 v2, s[12:15], s26 offen lds
    s_add_u32 m0, s25, 45056
    s_add_u32 s26, s31, 295040
    buffer_load_dwordx4 v2, s[12:15], s26 offen lds
    s_add_u32 m0, s25, 49152
    s_add_u32 s26, s31, 442496
    buffer_load_dwordx4 v2, s[12:15], s26 offen lds
    s_add_u32 m0, s25, 53248
    s_add_u32 s26, s31, 589952
    buffer_load_dwordx4 v2, s[12:15], s26 offen lds
    s_add_u32 m0, s25, 57344
    s_add_u32 s26, s31, 737408
    buffer_load_dwordx4 v2, s[12:15], s26 offen lds
    s_add_u32 m0, s25, 61440
    s_add_u32 s26, s31, 884864
    buffer_load_dwordx4 v2, s[12:15], s26 offen lds
    s_add_u32 m0, s25, 65536
    s_add_u32 s26, s31, 1032320
    buffer_load_dwordx4 v2, s[12:15], s26 offen lds
    s_add_u32 m0, s25, 69632
    s_add_u32 s26, s31, 1179776
    buffer_load_dwordx4 v2, s[12:15], s26 offen lds
    s_cmp_lg_u32 s22, 0
    s_cbranch_scc1 gemm1kernel_w0_3
    s_lshl_b32 s46, s21, 12
    s_add_u32 s46, s46, 163840
    v_and_b32 v4, 31, v0
    v_lshlrev_b32 v4, 7, v4
    s_mov_b32 s55, 0
gemm1kernel_p0_4:
    buffer_load_dword v5, v4, s[48:51], s46 offen sc0 sc1
    s_waitcnt vmcnt(0)
    v_cmp_ne_u32 vcc, 1, v5
    s_add_u32 s55, s55, 1
    s_cbranch_vccz gemm1kernel_w0_3
    s_sleep 1
    s_cmp_lt_u32 s55, 0x40000
    s_cbranch_scc1 gemm1kernel_p0_4
gemm1kernel_w0_3:
    s_barrier
    s_add_u32 s28, s27, 0
    buffer_load_dwordx4 a[96:99], v1, s[8:11], s28 offen sc0 sc1
    s_add_u32 s28, s27, 36864
    buffer_load_dwordx4 a[100:103], v1, s[8:11], s28 offen sc0 sc1
    s_add_u32 s28, s27, 1024
    buffer_load_dwordx4 a[104:107], v1, s[8:11], s28 offen sc0 sc1
    s_add_u32 s28, s27, 37888
    buffer_load_dwordx4 a[108:111], v1, s[8:11], s28 offen sc0 sc1
    s_add_u32 s28, s27, 2048
    buffer_load_dwordx4 a[112:115], v1, s[8:11], s28 offen sc0 sc1
    s_add_u32 s28, s27, 38912
    buffer_load_dwordx4 a[116:119], v1, s[8:11], s28 offen sc0 sc1
    s_add_u32 s28, s27, 3072
    buffer_load_dwordx4 a[120:123], v1, s[8:11], s28 offen sc0 sc1
    s_add_u32 s28, s27, 39936
    buffer_load_dwordx4 a[124:127], v1, s[8:11], s28 offen sc0 sc1
    s_add_u32 s28, s27, 4096
    buffer_load_dwordx4 a[128:131], v1, s[8:11], s28 offen sc0 sc1
    s_add_u32 s28, s27, 40960
    buffer_load_dwordx4 a[132:135], v1, s[8:11], s28 offen sc0 sc1
    s_add_u32 s28, s27, 5120
    buffer_load_dwordx4 a[136:139], v1, s[8:11], s28 offen sc0 sc1
    s_add_u32 s28, s27, 41984
    buffer_load_dwordx4 a[140:143], v1, s[8:11], s28 offen sc0 sc1
    s_barrier
    ds_read_b64_tr_b16 v[216:217], v8 offset:0
    ds_read_b64_tr_b16 v[218:219], v8 offset:512
    ds_read_b64_tr_b16 v[220:221], v11 offset:0
    ds_read_b64_tr_b16 v[222:223], v11 offset:512
    ds_read_b64_tr_b16 v[224:225], v14 offset:0
    ds_read_b64_tr_b16 v[226:227], v14 offset:512
    ds_read_b64_tr_b16 v[228:229], v17 offset:0
    ds_read_b64_tr_b16 v[230:231], v17 offset:512
    ds_read_b64_tr_b16 v[232:233], v8 offset:4096
    ds_read_b64_tr_b16 v[234:235], v8 offset:4608
    s_waitcnt vmcnt(10)
    s_waitcnt lgkmcnt(8)
    v_mfma_f32_32x32x16_bf16 a[0:15], v[216:219], a[96:99], 0
    ds_read_b64_tr_b16 v[236:237], v11 offset:4096
    v_mfma_f32_32x32x16_bf16 a[16:31], v[216:219], a[100:103], 0
    ds_read_b64_tr_b16 v[238:239], v11 offset:4608
    s_waitcnt lgkmcnt(8)
    v_mfma_f32_32x32x16_bf16 a[32:47], v[220:223], a[96:99], 0
    ds_read_b64_tr_b16 v[216:217], v14 offset:4096
    s_add_u32 s28, s27, 6144
    buffer_load_dwordx4 a[144:147], v1, s[8:11], s28 offen sc0 sc1
    s_add_u32 s28, s27, 43008
    buffer_load_dwordx4 a[148:151], v1, s[8:11], s28 offen sc0 sc1
    v_mfma_f32_32x32x16_bf16 a[48:63], v[220:223], a[100:103], 0
    ds_read_b64_tr_b16 v[218:219], v14 offset:4608
    s_waitcnt lgkmcnt(8)
    v_mfma_f32_32x32x16_bf16 a[64:79], v[224:227], a[96:99], 0
    ds_read_b64_tr_b16 v[220:221], v17 offset:4096
    v_mfma_f32_32x32x16_bf16 a[80:95], v[224:227], a[100:103], 0
    ds_read_b64_tr_b16 v[222:223], v17 offset:4608
    s_barrier
    s_waitcnt lgkmcnt(8)
    v_mfma_f32_32x32x16_bf16 v[24:39], v[228:231], a[96:99], 0
    ds_read_b64_tr_b16 v[224:225], v8 offset:8192
    s_add_u32 m0, s25, 73728
    s_add_u32 s26, s32, 0
    buffer_load_dwordx4 v3, s[12:15], s26 offen lds
    v_mfma_f32_32x32x16_bf16 v[40:55], v[228:231], a[100:103], 0
    ds_read_b64_tr_b16 v[226:227], v8 offset:8704
    s_waitcnt vmcnt(11)
    s_waitcnt lgkmcnt(8)
    v_mfma_f32_32x32x16_bf16 a[0:15], v[232:235], a[104:107], a[0:15]
    ds_read_b64_tr_b16 v[228:229], v11 offset:8192
    v_mfma_f32_32x32x16_bf16 a[16:31], v[232:235], a[108:111], a[16:31]
    ds_read_b64_tr_b16 v[230:231], v11 offset:8704
    s_waitcnt lgkmcnt(8)
    v_mfma_f32_32x32x16_bf16 a[32:47], v[236:239], a[104:107], a[32:47]
    ds_read_b64_tr_b16 v[232:233], v14 offset:8192
    s_add_u32 s28, s27, 7168
    buffer_load_dwordx4 a[152:155], v1, s[8:11], s28 offen sc0 sc1
    s_add_u32 s28, s27, 44032
    buffer_load_dwordx4 a[156:159], v1, s[8:11], s28 offen sc0 sc1
    v_mfma_f32_32x32x16_bf16 a[48:63], v[236:239], a[108:111], a[48:63]
    ds_read_b64_tr_b16 v[234:235], v14 offset:8704
    s_waitcnt lgkmcnt(8)
    v_mfma_f32_32x32x16_bf16 a[64:79], v[216:219], a[104:107], a[64:79]
    ds_read_b64_tr_b16 v[236:237], v17 offset:8192
    v_mfma_f32_32x32x16_bf16 a[80:95], v[216:219], a[108:111], a[80:95]
    ds_read_b64_tr_b16 v[238:239], v17 offset:8704
    s_waitcnt lgkmcnt(8)
    v_mfma_f32_32x32x16_bf16 v[24:39], v[220:223], a[104:107], v[24:39]
    ds_read_b64_tr_b16 v[216:217], v8 offset:12288
    s_add_u32 m0, s25, 77824
    s_add_u32 s26, s32, 589824
    buffer_load_dwordx4 v3, s[12:15], s26 offen lds
    v_mfma_f32_32x32x16_bf16 v[40:55], v[220:223], a[108:111], v[40:55]
    ds_read_b64_tr_b16 v[218:219], v8 offset:12800
    s_waitcnt vmcnt(12)
    s_waitcnt lgkmcnt(8)
    v_mfma_f32_32x32x16_bf16 a[0:15], v[224:227], a[112:115], a[0:15]
    ds_read_b64_tr_b16 v[220:221], v11 offset:12288
    v_mfma_f32_32x32x16_bf16 a[16:31], v[224:227], a[116:119], a[16:31]
    ds_read_b64_tr_b16 v[222:223], v11 offset:12800
    s_waitcnt lgkmcnt(8)
    v_mfma_f32_32x32x16_bf16 a[32:47], v[228:231], a[112:115], a[32:47]
    ds_read_b64_tr_b16 v[224:225], v14 offset:12288
    s_add_u32 s28, s27, 8192
    buffer_load_dwordx4 a[160:163], v1, s[8:11], s28 offen sc0 sc1
    s_add_u32 s28, s27, 45056
    buffer_load_dwordx4 a[164:167], v1, s[8:11], s28 offen sc0 sc1
    v_mfma_f32_32x32x16_bf16 a[48:63], v[228:231], a[116:119], a[48:63]
    ds_read_b64_tr_b16 v[226:227], v14 offset:12800
    s_waitcnt lgkmcnt(8)
    v_mfma_f32_32x32x16_bf16 a[64:79], v[232:235], a[112:115], a[64:79]
    ds_read_b64_tr_b16 v[228:229], v17 offset:12288
    v_mfma_f32_32x32x16_bf16 a[80:95], v[232:235], a[116:119], a[80:95]
    ds_read_b64_tr_b16 v[230:231], v17 offset:12800
    s_barrier
    s_waitcnt lgkmcnt(8)
    v_mfma_f32_32x32x16_bf16 v[24:39], v[236:239], a[112:115], v[24:39]
    ds_read_b64_tr_b16 v[232:233], v8 offset:16384
    s_add_u32 m0, s25, 81920
    s_add_u32 s26, s32, 1179648
    buffer_load_dwordx4 v3, s[12:15], s26 offen lds
    v_mfma_f32_32x32x16_bf16 v[40:55], v[236:239], a[116:119], v[40:55]
    ds_read_b64_tr_b16 v[234:235], v8 offset:16896
    s_waitcnt vmcnt(13)
    s_waitcnt lgkmcnt(8)
    v_mfma_f32_32x32x16_bf16 a[0:15], v[216:219], a[120:123], a[0:15]
    ds_read_b64_tr_b16 v[236:237], v11 offset:16384
    v_mfma_f32_32x32x16_bf16 a[16:31], v[216:219], a[124:127], a[16:31]
    ds_read_b64_tr_b16 v[238:239], v11 offset:16896
    s_waitcnt lgkmcnt(8)
    v_mfma_f32_32x32x16_bf16 a[32:47], v[220:223], a[120:123], a[32:47]
    ds_read_b64_tr_b16 v[216:217], v14 offset:16384
    s_add_u32 m0, s25, 86016
    s_add_u32 s26, s31, 1327104
    buffer_load_dwordx4 v2, s[12:15], s26 offen lds
    v_mfma_f32_32x32x16_bf16 a[48:63], v[220:223], a[124:127], a[48:63]
    ds_read_b64_tr_b16 v[218:219], v14 offset:16896
    s_waitcnt lgkmcnt(8)
    v_mfma_f32_32x32x16_bf16 a[64:79], v[224:227], a[120:123], a[64:79]
    ds_read_b64_tr_b16 v[220:221], v17 offset:16384
    v_mfma_f32_32x32x16_bf16 a[80:95], v[224:227], a[124:127], a[80:95]
    ds_read_b64_tr_b16 v[222:223], v17 offset:16896
    s_waitcnt lgkmcnt(8)
    v_mfma_f32_32x32x16_bf16 v[24:39], v[228:231], a[120:123], v[24:39]
    ds_read_b64_tr_b16 v[224:225], v8 offset:20480
    s_add_u32 m0, s25, 90112
    s_add_u32 s26, s31, 1474560
    buffer_load_dwordx4 v2, s[12:15], s26 offen lds
    v_mfma_f32_32x32x16_bf16 v[40:55], v[228:231], a[124:127], v[40:55]
    ds_read_b64_tr_b16 v[226:227], v8 offset:20992
    s_waitcnt vmcnt(13)
    s_waitcnt lgkmcnt(8)
    v_mfma_f32_32x32x16_bf16 a[0:15], v[232:235], a[128:131], a[0:15]
    ds_read_b64_tr_b16 v[228:229], v11 offset:20480
    v_mfma_f32_32x32x16_bf16 a[16:31], v[232:235], a[132:135], a[16:31]
    ds_read_b64_tr_b16 v[230:231], v11 offset:20992
    s_waitcnt lgkmcnt(8)
    v_mfma_f32_32x32x16_bf16 a[32:47], v[236:239], a[128:131], a[32:47]
    ds_read_b64_tr_b16 v[232:233], v14 offset:20480
    s_add_u32 m0, s25, 94208
    s_add_u32 s26, s31, 1622016
    buffer_load_dwordx4 v2, s[12:15], s26 offen lds
    v_mfma_f32_32x32x16_bf16 a[48:63], v[236:239], a[132:135], a[48:63]
    ds_read_b64_tr_b16 v[234:235], v14 offset:20992
    s_waitcnt lgkmcnt(8)
    v_mfma_f32_32x32x16_bf16 a[64:79], v[216:219], a[128:131], a[64:79]
    ds_read_b64_tr_b16 v[236:237], v17 offset:20480
    v_mfma_f32_32x32x16_bf16 a[80:95], v[216:219], a[132:135], a[80:95]
    ds_read_b64_tr_b16 v[238:239], v17 offset:20992
    s_barrier
    s_waitcnt lgkmcnt(8)
    v_mfma_f32_32x32x16_bf16 v[24:39], v[220:223], a[128:131], v[24:39]
    ds_read_b64_tr_b16 v[216:217], v8 offset:24576
    s_add_u32 m0, s25, 98304
    s_add_u32 s26, s31, 1769472
    buffer_load_dwordx4 v2, s[12:15], s26 offen lds
    v_mfma_f32_32x32x16_bf16 v[40:55], v[220:223], a[132:135], v[40:55]
    ds_read_b64_tr_b16 v[218:219], v8 offset:25088
    s_waitcnt vmcnt(13)
    s_waitcnt lgkmcnt(8)
    v_mfma_f32_32x32x16_bf16 a[0:15], v[224:227], a[136:139], a[0:15]
    ds_read_b64_tr_b16 v[220:221], v11 offset:24576
    v_mfma_f32_32x32x16_bf16 a[16:31], v[224:227], a[140:143], a[16:31]
    ds_read_b64_tr_b16 v[222:223], v11 offset:25088
    s_waitcnt lgkmcnt(8)
    v_mfma_f32_32x32x16_bf16 a[32:47], v[228:231], a[136:139], a[32:47]
    ds_read_b64_tr_b16 v[224:225], v14 offset:24576
    s_add_u32 m0, s25, 102400
    s_add_u32 s26, s31, 1916928
    buffer_load_dwordx4 v2, s[12:15], s26 offen lds
    v_mfma_f32_32x32x16_bf16 a[48:63], v[228:231], a[140:143], a[48:63]
    ds_read_b64_tr_b16 v[226:227], v14 offset:25088
    s_waitcnt lgkmcnt(8)
    v_mfma_f32_32x32x16_bf16 a[64:79], v[232:235], a[136:139], a[64:79]
    ds_read_b64_tr_b16 v[228:229], v17 offset:24576
    v_mfma_f32_32x32x16_bf16 a[80:95], v[232:235], a[140:143], a[80:95]
    ds_read_b64_tr_b16 v[230:231], v17 offset:25088
    s_waitcnt lgkmcnt(8)
    v_mfma_f32_32x32x16_bf16 v[24:39], v[236:239], a[136:139], v[24:39]
    ds_read_b64_tr_b16 v[232:233], v8 offset:28672
    s_add_u32 m0, s25, 106496
    s_add_u32 s26, s31, 2064384
    buffer_load_dwordx4 v2, s[12:15], s26 offen lds
    v_mfma_f32_32x32x16_bf16 v[40:55], v[236:239], a[140:143], v[40:55]
    ds_read_b64_tr_b16 v[234:235], v8 offset:29184
    s_waitcnt vmcnt(13)
    s_waitcnt lgkmcnt(8)
    v_mfma_f32_32x32x16_bf16 a[0:15], v[216:219], a[144:147], a[0:15]
    ds_read_b64_tr_b16 v[236:237], v11 offset:28672
    v_mfma_f32_32x32x16_bf16 a[16:31], v[216:219], a[148:151], a[16:31]
    ds_read_b64_tr_b16 v[238:239], v11 offset:29184
    s_waitcnt lgkmcnt(8)
    v_mfma_f32_32x32x16_bf16 a[32:47], v[220:223], a[144:147], a[32:47]
    ds_read_b64_tr_b16 v[216:217], v14 offset:28672
    s_add_u32 m0, s25, 110592
    s_add_u32 s26, s31, 2211840
    buffer_load_dwordx4 v2, s[12:15], s26 offen lds
    v_mfma_f32_32x32x16_bf16 a[48:63], v[220:223], a[148:151], a[48:63]
    ds_read_b64_tr_b16 v[218:219], v14 offset:29184
    s_waitcnt lgkmcnt(8)
    v_mfma_f32_32x32x16_bf16 a[64:79], v[224:227], a[144:147], a[64:79]
    ds_read_b64_tr_b16 v[220:221], v17 offset:28672
    v_mfma_f32_32x32x16_bf16 a[80:95], v[224:227], a[148:151], a[80:95]
    ds_read_b64_tr_b16 v[222:223], v17 offset:29184
    s_waitcnt lgkmcnt(8)
    v_mfma_f32_32x32x16_bf16 v[24:39], v[228:231], a[144:147], v[24:39]
    ds_read_b64_tr_b16 v[224:225], v8 offset:32768
    s_add_u32 m0, s25, 114688
    s_add_u32 s26, s31, 2359296
    buffer_load_dwordx4 v2, s[12:15], s26 offen lds
    v_mfma_f32_32x32x16_bf16 v[40:55], v[228:231], a[148:151], v[40:55]
    ds_read_b64_tr_b16 v[226:227], v8 offset:33280
    s_waitcnt vmcnt(12)
    s_waitcnt lgkmcnt(8)
    v_mfma_f32_32x32x16_bf16 a[0:15], v[232:235], a[152:155], a[0:15]
    ds_read_b64_tr_b16 v[228:229], v11 offset:32768
    v_mfma_f32_32x32x16_bf16 a[16:31], v[232:235], a[156:159], a[16:31]
    ds_read_b64_tr_b16 v[230:231], v11 offset:33280
    s_waitcnt lgkmcnt(8)
    v_mfma_f32_32x32x16_bf16 a[32:47], v[236:239], a[152:155], a[32:47]
    ds_read_b64_tr_b16 v[232:233], v14 offset:32768
    s_add_u32 m0, s25, 118784
    s_add_u32 s26, s31, 2506752
    buffer_load_dwordx4 v2, s[12:15], s26 offen lds
    v_mfma_f32_32x32x16_bf16 a[48:63], v[236:239], a[156:159], a[48:63]
    ds_read_b64_tr_b16 v[234:235], v14 offset:33280
    s_waitcnt lgkmcnt(8)
    v_mfma_f32_32x32x16_bf16 a[64:79], v[216:219], a[152:155], a[64:79]
    ds_read_b64_tr_b16 v[236:237], v17 offset:32768
    v_mfma_f32_32x32x16_bf16 a[80:95], v[216:219], a[156:159], a[80:95]
    ds_read_b64_tr_b16 v[238:239], v17 offset:33280
    s_barrier
    s_waitcnt lgkmcnt(8)
    v_mfma_f32_32x32x16_bf16 v[24:39], v[220:223], a[152:155], v[24:39]
    ds_read_b64_tr_b16 v[216:217], v8 offset:36864
    s_add_u32 m0, s25, 122880
    s_add_u32 s26, s31, 1327232
    buffer_load_dwordx4 v2, s[12:15], s26 offen lds
    v_mfma_f32_32x32x16_bf16 v[40:55], v[220:223], a[156:159], v[40:55]
    ds_read_b64_tr_b16 v[218:219], v8 offset:37376
    s_waitcnt vmcnt(11)
    s_waitcnt lgkmcnt(8)
    v_mfma_f32_32x32x16_bf16 a[0:15], v[224:227], a[160:163], a[0:15]
    ds_read_b64_tr_b16 v[220:221], v8 offset:40960
    v_mfma_f32_32x32x16_bf16 a[16:31], v[224:227], a[164:167], a[16:31]
    ds_read_b64_tr_b16 v[222:223], v8 offset:41472
    s_waitcnt lgkmcnt(8)
    v_mfma_f32_32x32x16_bf16 a[32:47], v[228:231], a[160:163], a[32:47]
    ds_read_b64_tr_b16 v[224:225], v8 offset:45056
    s_add_u32 m0, s25, 126976
    s_add_u32 s26, s31, 1474688
    buffer_load_dwordx4 v2, s[12:15], s26 offen lds
    v_mfma_f32_32x32x16_bf16 a[48:63], v[228:231], a[164:167], a[48:63]
    ds_read_b64_tr_b16 v[226:227], v8 offset:45568
    s_waitcnt lgkmcnt(8)
    v_mfma_f32_32x32x16_bf16 a[64:79], v[232:235], a[160:163], a[64:79]
    ds_read_b64_tr_b16 v[228:229], v8 offset:49152
    v_mfma_f32_32x32x16_bf16 a[80:95], v[232:235], a[164:167], a[80:95]
    ds_read_b64_tr_b16 v[230:231], v8 offset:49664
    s_waitcnt lgkmcnt(8)
    v_mfma_f32_32x32x16_bf16 v[24:39], v[236:239], a[160:163], v[24:39]
    ds_read_b64_tr_b16 v[232:233], v8 offset:53248
    s_add_u32 m0, s25, 131072
    s_add_u32 s26, s31, 1622144
    buffer_load_dwordx4 v2, s[12:15], s26 offen lds
    v_mfma_f32_32x32x16_bf16 v[40:55], v[236:239], a[164:167], v[40:55]
    ds_read_b64_tr_b16 v[234:235], v8 offset:53760
    s_waitcnt lgkmcnt(8)
    v_mfma_f32_32x32x16_bf16 v[56:71], v[216:219], a[96:99], 0
    ds_read_b64_tr_b16 v[236:237], v8 offset:57344
    v_mfma_f32_32x32x16_bf16 v[72:87], v[216:219], a[100:103], 0
    ds_read_b64_tr_b16 v[238:239], v8 offset:57856
    s_waitcnt lgkmcnt(8)
    v_mfma_f32_32x32x16_bf16 v[56:71], v[220:223], a[104:107], v[56:71]
    ds_read_b64_tr_b16 v[216:217], v8 offset:61440
    s_add_u32 m0, s25, 135168
    s_add_u32 s26, s31, 1769600
    buffer_load_dwordx4 v2, s[12:15], s26 offen lds
    v_mfma_f32_32x32x16_bf16 v[72:87], v[220:223], a[108:111], v[72:87]
    ds_read_b64_tr_b16 v[218:219], v8 offset:61952
    s_waitcnt lgkmcnt(8)
    v_mfma_f32_32x32x16_bf16 v[56:71], v[224:227], a[112:115], v[56:71]
    ds_read_b64_tr_b16 v[220:221], v9 offset:0
    v_mfma_f32_32x32x16_bf16 v[72:87], v[224:227], a[116:119], v[72:87]
    ds_read_b64_tr_b16 v[222:223], v9 offset:512
    s_waitcnt lgkmcnt(8)
    v_mfma_f32_32x32x16_bf16 v[56:71], v[228:231], a[120:123], v[56:71]
    ds_read_b64_tr_b16 v[224:225], v9 offset:4096
    s_add_u32 s28, s27, 9216
    buffer_load_dwordx4 a[168:171], v1, s[8:11], s28 offen sc0 sc1
    v_mfma_f32_32x32x16_bf16 v[72:87], v[228:231], a[124:127], v[72:87]
    ds_read_b64_tr_b16 v[226:227], v9 offset:4608
    s_waitcnt lgkmcnt(8)
    v_mfma_f32_32x32x16_bf16 v[56:71], v[232:235], a[128:131], v[56:71]
    ds_read_b64_tr_b16 v[228:229], v11 offset:36864
    s_add_u32 s28, s27, 46080
    buffer_load_dwordx4 a[172:175], v1, s[8:11], s28 offen sc0 sc1
    v_mfma_f32_32x32x16_bf16 v[72:87], v[232:235], a[132:135], v[72:87]
    ds_read_b64_tr_b16 v[230:231], v11 offset:37376
    s_waitcnt lgkmcnt(8)
    v_mfma_f32_32x32x16_bf16 v[56:71], v[236:239], a[136:139], v[56:71]
    ds_read_b64_tr_b16 v[232:233], v11 offset:40960
    s_add_u32 m0, s25, 139264
    s_add_u32 s26, s31, 1917056
    buffer_load_dwordx4 v2, s[12:15], s26 offen lds
    v_mfma_f32_32x32x16_bf16 v[72:87], v[236:239], a[140:143], v[72:87]
    ds_read_b64_tr_b16 v[234:235], v11 offset:41472
    s_waitcnt lgkmcnt(8)
    v_mfma_f32_32x32x16_bf16 v[56:71], v[216:219], a[144:147], v[56:71]
    ds_read_b64_tr_b16 v[236:237], v11 offset:45056
    v_mfma_f32_32x32x16_bf16 v[72:87], v[216:219], a[148:151], v[72:87]
    ds_read_b64_tr_b16 v[238:239], v11 offset:45568
    s_waitcnt lgkmcnt(8)
    v_mfma_f32_32x32x16_bf16 v[56:71], v[220:223], a[152:155], v[56:71]
    ds_read_b64_tr_b16 v[216:217], v11 offset:49152
    s_add_u32 s28, s27, 10240
    buffer_load_dwordx4 a[176:179], v1, s[8:11], s28 offen sc0 sc1
    v_mfma_f32_32x32x16_bf16 v[72:87], v[220:223], a[156:159], v[72:87]
    ds_read_b64_tr_b16 v[218:219], v11 offset:49664
    s_waitcnt lgkmcnt(8)
    v_mfma_f32_32x32x16_bf16 v[56:71], v[224:227], a[160:163], v[56:71]
    ds_read_b64_tr_b16 v[220:221], v11 offset:53248
    s_add_u32 s28, s27, 47104
    buffer_load_dwordx4 a[180:183], v1, s[8:11], s28 offen sc0 sc1
    v_mfma_f32_32x32x16_bf16 v[72:87], v[224:227], a[164:167], v[72:87]
    ds_read_b64_tr_b16 v[222:223], v11 offset:53760
    s_waitcnt lgkmcnt(8)
    v_mfma_f32_32x32x16_bf16 v[88:103], v[228:231], a[96:99], 0
    ds_read_b64_tr_b16 v[224:225], v11 offset:57344
    s_add_u32 m0, s25, 143360
    s_add_u32 s26, s31, 2064512
    buffer_load_dwordx4 v2, s[12:15], s26 offen lds
    v_mfma_f32_32x32x16_bf16 v[104:119], v[228:231], a[100:103], 0
    ds_read_b64_tr_b16 v[226:227], v11 offset:57856
    s_waitcnt lgkmcnt(8)
    v_mfma_f32_32x32x16_bf16 v[88:103], v[232:235], a[104:107], v[88:103]
    ds_read_b64_tr_b16 v[228:229], v11 offset:61440
    v_mfma_f32_32x32x16_bf16 v[104:119], v[232:235], a[108:111], v[104:119]
    ds_read_b64_tr_b16 v[230:231], v11 offset:61952
    s_waitcnt lgkmcnt(8)
    v_mfma_f32_32x32x16_bf16 v[88:103], v[236:239], a[112:115], v[88:103]
    ds_read_b64_tr_b16 v[232:233], v12 offset:0
    s_add_u32 s28, s27, 11264
    buffer_load_dwordx4 a[184:187], v1, s[8:11], s28 offen sc0 sc1
    v_mfma_f32_32x32x16_bf16 v[104:119], v[236:239], a[116:119], v[104:119]
    ds_read_b64_tr_b16 v[234:235], v12 offset:512
    s_waitcnt lgkmcnt(8)
    v_mfma_f32_32x32x16_bf16 v[88:103], v[216:219], a[120:123], v[88:103]
    ds_read_b64_tr_b16 v[236:237], v12 offset:4096
    s_add_u32 s28, s27, 48128
    buffer_load_dwordx4 a[188:191], v1, s[8:11], s28 offen sc0 sc1
    v_mfma_f32_32x32x16_bf16 v[104:119], v[216:219], a[124:127], v[104:119]
    ds_read_b64_tr_b16 v[238:239], v12 offset:4608
    s_waitcnt lgkmcnt(8)
    v_mfma_f32_32x32x16_bf16 v[88:103], v[220:223], a[128:131], v[88:103]
    ds_read_b64_tr_b16 v[216:217], v14 offset:36864
    s_add_u32 m0, s25, 0
    s_add_u32 s26, s31, 2211968
    buffer_load_dwordx4 v2, s[12:15], s26 offen lds
    v_mfma_f32_32x32x16_bf16 v[104:119], v[220:223], a[132:135], v[104:119]
    ds_read_b64_tr_b16 v[218:219], v14 offset:37376
    s_waitcnt lgkmcnt(8)
    v_mfma_f32_32x32x16_bf16 v[88:103], v[224:227], a[136:139], v[88:103]
    ds_read_b64_tr_b16 v[220:221], v14 offset:40960
    v_mfma_f32_32x32x16_bf16 v[104:119], v[224:227], a[140:143], v[104:119]
    ds_read_b64_tr_b16 v[222:223], v14 offset:41472
    s_waitcnt lgkmcnt(8)
    v_mfma_f32_32x32x16_bf16 v[88:103], v[228:231], a[144:147], v[88:103]
    ds_read_b64_tr_b16 v[224:225], v14 offset:45056
    s_add_u32 s28, s27, 12288
    buffer_load_dwordx4 a[192:195], v1, s[8:11], s28 offen sc0 sc1
    v_mfma_f32_32x32x16_bf16 v[104:119], v[228:231], a[148:151], v[104:119]
    ds_read_b64_tr_b16 v[226:227], v14 offset:45568
    s_waitcnt lgkmcnt(8)
    v_mfma_f32_32x32x16_bf16 v[88:103], v[232:235], a[152:155], v[88:103]
    ds_read_b64_tr_b16 v[228:229], v14 offset:49152
    s_add_u32 s28, s27, 49152
    buffer_load_dwordx4 a[196:199], v1, s[8:11], s28 offen sc0 sc1
    v_mfma_f32_32x32x16_bf16 v[104:119], v[232:235], a[156:159], v[104:119]
    ds_read_b64_tr_b16 v[230:231], v14 offset:49664
    s_waitcnt lgkmcnt(8)
    v_mfma_f32_32x32x16_bf16 v[88:103], v[236:239], a[160:163], v[88:103]
    ds_read_b64_tr_b16 v[232:233], v14 offset:53248
    s_add_u32 m0, s25, 4096
    s_add_u32 s26, s31, 2359424
    buffer_load_dwordx4 v2, s[12:15], s26 offen lds
    v_mfma_f32_32x32x16_bf16 v[104:119], v[236:239], a[164:167], v[104:119]
    ds_read_b64_tr_b16 v[234:235], v14 offset:53760
    s_waitcnt lgkmcnt(8)
    v_mfma_f32_32x32x16_bf16 v[120:135], v[216:219], a[96:99], 0
    ds_read_b64_tr_b16 v[236:237], v14 offset:57344
    v_mfma_f32_32x32x16_bf16 v[136:151], v[216:219], a[100:103], 0
    ds_read_b64_tr_b16 v[238:239], v14 offset:57856
    s_waitcnt lgkmcnt(8)
    v_mfma_f32_32x32x16_bf16 v[120:135], v[220:223], a[104:107], v[120:135]
    ds_read_b64_tr_b16 v[216:217], v14 offset:61440
    s_add_u32 s28, s27, 13312
    buffer_load_dwordx4 a[200:203], v1, s[8:11], s28 offen sc0 sc1
    v_mfma_f32_32x32x16_bf16 v[136:151], v[220:223], a[108:111], v[136:151]
    ds_read_b64_tr_b16 v[218:219], v14 offset:61952
    s_waitcnt lgkmcnt(8)
    v_mfma_f32_32x32x16_bf16 v[120:135], v[224:227], a[112:115], v[120:135]
    ds_read_b64_tr_b16 v[220:221], v15 offset:0
    s_add_u32 s28, s27, 50176
    buffer_load_dwordx4 a[204:207], v1, s[8:11], s28 offen sc0 sc1
    v_mfma_f32_32x32x16_bf16 v[136:151], v[224:227], a[116:119], v[136:151]
    ds_read_b64_tr_b16 v[222:223], v15 offset:512
    s_waitcnt lgkmcnt(8)
    v_mfma_f32_32x32x16_bf16 v[120:135], v[228:231], a[120:123], v[120:135]
    ds_read_b64_tr_b16 v[224:225], v15 offset:4096
    s_add_u32 m0, s25, 8192
    s_add_u32 s26, s31, 2506880
    buffer_load_dwordx4 v2, s[12:15], s26 offen lds
    v_mfma_f32_32x32x16_bf16 v[136:151], v[228:231], a[124:127], v[136:151]
    ds_read_b64_tr_b16 v[226:227], v15 offset:4608
    s_waitcnt lgkmcnt(8)
    v_mfma_f32_32x32x16_bf16 v[120:135], v[232:235], a[128:131], v[120:135]
    ds_read_b64_tr_b16 v[228:229], v17 offset:36864
    v_mfma_f32_32x32x16_bf16 v[136:151], v[232:235], a[132:135], v[136:151]
    ds_read_b64_tr_b16 v[230:231], v17 offset:37376
    s_waitcnt lgkmcnt(8)
    v_mfma_f32_32x32x16_bf16 v[120:135], v[236:239], a[136:139], v[120:135]
    ds_read_b64_tr_b16 v[232:233], v17 offset:40960
    s_add_u32 s28, s27, 14336
    buffer_load_dwordx4 a[208:211], v1, s[8:11], s28 offen sc0 sc1
    v_mfma_f32_32x32x16_bf16 v[136:151], v[236:239], a[140:143], v[136:151]
    ds_read_b64_tr_b16 v[234:235], v17 offset:41472
    s_waitcnt lgkmcnt(8)
    v_mfma_f32_32x32x16_bf16 v[120:135], v[216:219], a[144:147], v[120:135]
    ds_read_b64_tr_b16 v[236:237], v17 offset:45056
    s_add_u32 s28, s27, 51200
    buffer_load_dwordx4 a[212:215], v1, s[8:11], s28 offen sc0 sc1
    v_mfma_f32_32x32x16_bf16 v[136:151], v[216:219], a[148:151], v[136:151]
    ds_read_b64_tr_b16 v[238:239], v17 offset:45568
    s_waitcnt lgkmcnt(8)
    v_mfma_f32_32x32x16_bf16 v[120:135], v[220:223], a[152:155], v[120:135]
    ds_read_b64_tr_b16 v[216:217], v17 offset:49152
    s_add_u32 m0, s25, 12288
    s_add_u32 s26, s32, 1769472
    buffer_load_dwordx4 v3, s[12:15], s26 offen lds
    v_mfma_f32_32x32x16_bf16 v[136:151], v[220:223], a[156:159], v[136:151]
    ds_read_b64_tr_b16 v[218:219], v17 offset:49664
    s_waitcnt lgkmcnt(8)
    v_mfma_f32_32x32x16_bf16 v[120:135], v[224:227], a[160:163], v[120:135]
    ds_read_b64_tr_b16 v[220:221], v17 offset:53248
    s_add_u32 s28, s27, 15360
    buffer_load_dwordx4 a[216:219], v1, s[8:11], s28 offen sc0 sc1
    v_mfma_f32_32x32x16_bf16 v[136:151], v[224:227], a[164:167], v[136:151]
    ds_read_b64_tr_b16 v[222:223], v17 offset:53760
    s_waitcnt lgkmcnt(8)
    v_mfma_f32_32x32x16_bf16 v[152:167], v[228:231], a[96:99], 0
    ds_read_b64_tr_b16 v[224:225], v17 offset:57344
    s_add_u32 s28, s27, 52224
    buffer_load_dwordx4 a[220:223], v1, s[8:11], s28 offen sc0 sc1
    v_mfma_f32_32x32x16_bf16 v[168:183], v[228:231], a[100:103], 0
    ds_read_b64_tr_b16 v[226:227], v17 offset:57856
    s_waitcnt lgkmcnt(8)
    v_mfma_f32_32x32x16_bf16 v[152:167], v[232:235], a[104:107], v[152:167]
    ds_read_b64_tr_b16 v[228:229], v17 offset:61440
    v_mfma_f32_32x32x16_bf16 v[168:183], v[232:235], a[108:111], v[168:183]
    ds_read_b64_tr_b16 v[230:231], v17 offset:61952
    s_waitcnt lgkmcnt(8)
    v_mfma_f32_32x32x16_bf16 v[152:167], v[236:239], a[112:115], v[152:167]
    ds_read_b64_tr_b16 v[232:233], v18 offset:0
    s_add_u32 m0, s25, 16384
    s_add_u32 s26, s32, 2359296
    buffer_load_dwordx4 v3, s[12:15], s26 offen lds
    v_mfma_f32_32x32x16_bf16 v[168:183], v[236:239], a[116:119], v[168:183]
    ds_read_b64_tr_b16 v[234:235], v18 offset:512
    s_waitcnt lgkmcnt(8)
    v_mfma_f32_32x32x16_bf16 v[152:167], v[216:219], a[120:123], v[152:167]
    ds_read_b64_tr_b16 v[236:237], v18 offset:4096
    s_add_u32 s28, s27, 16384
    buffer_load_dwordx4 a[224:227], v1, s[8:11], s28 offen sc0 sc1
    v_mfma_f32_32x32x16_bf16 v[168:183], v[216:219], a[124:127], v[168:183]
    ds_read_b64_tr_b16 v[238:239], v18 offset:4608
    s_waitcnt vmcnt(35)
    s_barrier
    s_waitcnt lgkmcnt(8)
    v_mfma_f32_32x32x16_bf16 v[152:167], v[220:223], a[128:131], v[152:167]
    ds_read_b64_tr_b16 v[216:217], v21 offset:8192
    s_add_u32 s28, s27, 53248
    buffer_load_dwordx4 a[228:231], v1, s[8:11], s28 offen sc0 sc1
    v_mfma_f32_32x32x16_bf16 v[168:183], v[220:223], a[132:135], v[168:183]
    ds_read_b64_tr_b16 v[218:219], v21 offset:8320
    s_waitcnt lgkmcnt(8)
    v_mfma_f32_32x32x16_bf16 v[152:167], v[224:227], a[136:139], v[152:167]
    ds_read_b64_tr_b16 v[220:221], v21 offset:8704
    v_mfma_f32_32x32x16_bf16 v[168:183], v[224:227], a[140:143], v[168:183]
    ds_read_b64_tr_b16 v[222:223], v21 offset:8832
    s_waitcnt lgkmcnt(8)
    v_mfma_f32_32x32x16_bf16 v[152:167], v[228:231], a[144:147], v[152:167]
    ds_read_b64_tr_b16 v[224:225], v21 offset:9216
    s_add_u32 m0, s25, 20480
    s_add_u32 s26, s31, 2654208
    buffer_load_dwordx4 v2, s[12:15], s26 offen lds
    v_mfma_f32_32x32x16_bf16 v[168:183], v[228:231], a[148:151], v[168:183]
    ds_read_b64_tr_b16 v[226:227], v21 offset:9344
    s_waitcnt lgkmcnt(8)
    v_mfma_f32_32x32x16_bf16 v[152:167], v[232:235], a[152:155], v[152:167]
    ds_read_b64_tr_b16 v[228:229], v21 offset:9728
    s_add_u32 s28, s27, 17408
    buffer_load_dwordx4 a[232:235], v1, s[8:11], s28 offen sc0 sc1
    v_mfma_f32_32x32x16_bf16 v[168:183], v[232:235], a[156:159], v[168:183]
    ds_read_b64_tr_b16 v[230:231], v21 offset:9856
    s_waitcnt lgkmcnt(8)
    v_mfma_f32_32x32x16_bf16 v[152:167], v[236:239], a[160:163], v[152:167]
    ds_read_b64_tr_b16 v[232:233], v21 offset:12288
    s_add_u32 s28, s27, 54272
    buffer_load_dwordx4 a[236:239], v1, s[8:11], s28 offen sc0 sc1
    v_mfma_f32_32x32x16_bf16 v[168:183], v[236:239], a[164:167], v[168:183]
    ds_read_b64_tr_b16 v[234:235], v21 offset:12416
    s_waitcnt lgkmcnt(8)
    v_mfma_f32_32x32x16_bf16 v[184:199], v[216:219], a[96:99], 0
    ds_read_b64_tr_b16 v[236:237], v21 offset:12800
    v_mfma_f32_32x32x16_bf16 v[200:215], v[216:219], a[100:103], 0
    ds_read_b64_tr_b16 v[238:239], v21 offset:12928
    s_waitcnt lgkmcnt(8)
    v_mfma_f32_32x32x16_bf16 v[184:199], v[220:223], a[104:107], v[184:199]
    ds_read_b64_tr_b16 v[216:217], v21 offset:13312
    s_add_u32 m0, s25, 24576
    s_add_u32 s26, s31, 2801664
    buffer_load_dwordx4 v2, s[12:15], s26 offen lds
    v_mfma_f32_32x32x16_bf16 v[200:215], v[220:223], a[108:111], v[200:215]
    ds_read_b64_tr_b16 v[218:219], v21 offset:13440
    s_waitcnt lgkmcnt(8)
    v_mfma_f32_32x32x16_bf16 v[184:199], v[224:227], a[112:115], v[184:199]
    ds_read_b64_tr_b16 v[220:221], v21 offset:13824
    v_mfma_f32_32x32x16_bf16 v[200:215], v[224:227], a[116:119], v[200:215]
    ds_read_b64_tr_b16 v[222:223], v21 offset:13952
    s_waitcnt lgkmcnt(8)
    v_mfma_f32_32x32x16_bf16 v[184:199], v[228:231], a[120:123], v[184:199]
    ds_read_b64_tr_b16 v[224:225], v21 offset:16384
    s_add_u32 m0, s25, 28672
    s_add_u32 s26, s31, 2949120
    buffer_load_dwordx4 v2, s[12:15], s26 offen lds
    v_mfma_f32_32x32x16_bf16 v[200:215], v[228:231], a[124:127], v[200:215]
    ds_read_b64_tr_b16 v[226:227], v21 offset:16512
    s_waitcnt vmcnt(32)
    s_barrier
    s_waitcnt lgkmcnt(8)
    v_mfma_f32_32x32x16_bf16 v[184:199], v[232:235], a[128:131], v[184:199]
    ds_read_b64_tr_b16 v[228:229], v9 offset:20480
    v_mfma_f32_32x32x16_bf16 v[200:215], v[232:235], a[132:135], v[200:215]
    ds_read_b64_tr_b16 v[230:231], v9 offset:20992
    s_waitcnt lgkmcnt(8)
    v_mfma_f32_32x32x16_bf16 v[184:199], v[236:239], a[136:139], v[184:199]
    ds_read_b64_tr_b16 v[232:233], v9 offset:24576
    s_add_u32 m0, s25, 32768
    s_add_u32 s26, s31, 3096576
    buffer_load_dwordx4 v2, s[12:15], s26 offen lds
    v_mfma_f32_32x32x16_bf16 v[200:215], v[236:239], a[140:143], v[200:215]
    ds_read_b64_tr_b16 v[234:235], v9 offset:25088
    s_waitcnt lgkmcnt(8)
    v_mfma_f32_32x32x16_bf16 v[184:199], v[216:219], a[144:147], v[184:199]
    ds_read_b64_tr_b16 v[236:237], v9 offset:28672
    v_mfma_f32_32x32x16_bf16 v[200:215], v[216:219], a[148:151], v[200:215]
    ds_read_b64_tr_b16 v[238:239], v9 offset:29184
    s_waitcnt lgkmcnt(8)
    v_mfma_f32_32x32x16_bf16 v[184:199], v[220:223], a[152:155], v[184:199]
    ds_read_b64_tr_b16 v[216:217], v9 offset:32768
    s_add_u32 m0, s25, 36864
    s_add_u32 s26, s31, 3244032
    buffer_load_dwordx4 v2, s[12:15], s26 offen lds
    v_mfma_f32_32x32x16_bf16 v[200:215], v[220:223], a[156:159], v[200:215]
    ds_read_b64_tr_b16 v[218:219], v9 offset:33280
    s_waitcnt lgkmcnt(8)
    v_mfma_f32_32x32x16_bf16 v[184:199], v[224:227], a[160:163], v[184:199]
    ds_read_b64_tr_b16 v[220:221], v9 offset:36864
    v_mfma_f32_32x32x16_bf16 v[200:215], v[224:227], a[164:167], v[200:215]
    ds_read_b64_tr_b16 v[222:223], v9 offset:37376
    s_waitcnt vmcnt(28)
    s_waitcnt lgkmcnt(8)
    v_mfma_f32_32x32x16_bf16 a[0:15], v[228:231], a[168:171], a[0:15]
    ds_read_b64_tr_b16 v[224:225], v9 offset:40960
    s_add_u32 m0, s25, 40960
    s_add_u32 s26, s31, 3391488
    buffer_load_dwordx4 v2, s[12:15], s26 offen lds
    v_mfma_f32_32x32x16_bf16 a[16:31], v[228:231], a[172:175], a[16:31]
    ds_read_b64_tr_b16 v[226:227], v9 offset:41472
    s_waitcnt vmcnt(26)
    s_waitcnt lgkmcnt(8)
    v_mfma_f32_32x32x16_bf16 a[0:15], v[232:235], a[176:179], a[0:15]
    ds_read_b64_tr_b16 v[228:229], v9 offset:45056
    v_mfma_f32_32x32x16_bf16 a[16:31], v[232:235], a[180:183], a[16:31]
    ds_read_b64_tr_b16 v[230:231], v9 offset:45568
    s_waitcnt vmcnt(23)
    s_waitcnt lgkmcnt(8)
    v_mfma_f32_32x32x16_bf16 a[0:15], v[236:239], a[184:187], a[0:15]
    ds_read_b64_tr_b16 v[232:233], v9 offset:49152
    s_add_u32 m0, s25, 45056
    s_add_u32 s26, s31, 3538944
    buffer_load_dwordx4 v2, s[12:15], s26 offen lds
    v_mfma_f32_32x32x16_bf16 a[16:31], v[236:239], a[188:191], a[16:31]
    ds_read_b64_tr_b16 v[234:235], v9 offset:49664
    s_waitcnt vmcnt(21)
    s_waitcnt lgkmcnt(8)
    v_mfma_f32_32x32x16_bf16 a[0:15], v[216:219], a[192:195], a[0:15]
    ds_read_b64_tr_b16 v[236:237], v9 offset:53248
    v_mfma_f32_32x32x16_bf16 a[16:31], v[216:219], a[196:199], a[16:31]
    ds_read_b64_tr_b16 v[238:239], v9 offset:53760
    s_waitcnt vmcnt(18)
    s_waitcnt lgkmcnt(8)
    v_mfma_f32_32x32x16_bf16 a[0:15], v[220:223], a[200:203], a[0:15]
    ds_read_b64_tr_b16 v[216:217], v12 offset:20480
    s_add_u32 m0, s25, 49152
    s_add_u32 s26, s31, 3686400
    buffer_load_dwordx4 v2, s[12:15], s26 offen lds
    v_mfma_f32_32x32x16_bf16 a[16:31], v[220:223], a[204:207], a[16:31]
    ds_read_b64_tr_b16 v[218:219], v12 offset:20992
    s_waitcnt vmcnt(16)
    s_waitcnt lgkmcnt(8)
    v_mfma_f32_32x32x16_bf16 a[0:15], v[224:227], a[208:211], a[0:15]
    ds_read_b64_tr_b16 v[220:221], v12 offset:24576
    v_mfma_f32_32x32x16_bf16 a[16:31], v[224:227], a[212:215], a[16:31]
    ds_read_b64_tr_b16 v[222:223], v12 offset:25088
    s_waitcnt vmcnt(13)
    s_waitcnt lgkmcnt(8)
    v_mfma_f32_32x32x16_bf16 a[0:15], v[228:231], a[216:219], a[0:15]
    ds_read_b64_tr_b16 v[224:225], v12 offset:28672
    s_add_u32 s28, s27, 18432
    buffer_load_dwordx4 a[96:99], v1, s[8:11], s28 offen sc0 sc1
    v_mfma_f32_32x32x16_bf16 a[16:31], v[228:231], a[220:223], a[16:31]
    ds_read_b64_tr_b16 v[226:227], v12 offset:29184
    s_waitcnt vmcnt(11)
    s_waitcnt lgkmcnt(8)
    v_mfma_f32_32x32x16_bf16 a[0:15], v[232:235], a[224:227], a[0:15]
    ds_read_b64_tr_b16 v[228:229], v12 offset:32768
    s_add_u32 s28, s27, 55296
    buffer_load_dwordx4 a[100:103], v1, s[8:11], s28 offen sc0 sc1
    v_mfma_f32_32x32x16_bf16 a[16:31], v[232:235], a[228:231], a[16:31]
    ds_read_b64_tr_b16 v[230:231], v12 offset:33280
    s_waitcnt vmcnt(9)
    s_waitcnt lgkmcnt(8)
    v_mfma_f32_32x32x16_bf16 a[0:15], v[236:239], a[232:235], a[0:15]
    ds_read_b64_tr_b16 v[232:233], v12 offset:36864
    s_add_u32 m0, s25, 53248
    s_add_u32 s26, s31, 3833856
    buffer_load_dwordx4 v2, s[12:15], s26 offen lds
    v_mfma_f32_32x32x16_bf16 a[16:31], v[236:239], a[236:239], a[16:31]
    ds_read_b64_tr_b16 v[234:235], v12 offset:37376
    s_waitcnt lgkmcnt(8)
    v_mfma_f32_32x32x16_bf16 a[32:47], v[216:219], a[168:171], a[32:47]
    ds_read_b64_tr_b16 v[236:237], v12 offset:40960
    v_mfma_f32_32x32x16_bf16 a[48:63], v[216:219], a[172:175], a[48:63]
    ds_read_b64_tr_b16 v[238:239], v12 offset:41472
    s_waitcnt lgkmcnt(8)
    v_mfma_f32_32x32x16_bf16 a[32:47], v[220:223], a[176:179], a[32:47]
    ds_read_b64_tr_b16 v[216:217], v12 offset:45056
    s_add_u32 m0, s25, 57344
    s_add_u32 s26, s31, 2654336
    buffer_load_dwordx4 v2, s[12:15], s26 offen lds
    v_mfma_f32_32x32x16_bf16 a[48:63], v[220:223], a[180:183], a[48:63]
    ds_read_b64_tr_b16 v[218:219], v12 offset:45568
    s_waitcnt lgkmcnt(8)
    v_mfma_f32_32x32x16_bf16 a[32:47], v[224:227], a[184:187], a[32:47]
    ds_read_b64_tr_b16 v[220:221], v12 offset:49152
    v_mfma_f32_32x32x16_bf16 a[48:63], v[224:227], a[188:191], a[48:63]
    ds_read_b64_tr_b16 v[222:223], v12 offset:49664
    s_waitcnt lgkmcnt(8)
    v_mfma_f32_32x32x16_bf16 a[32:47], v[228:231], a[192:195], a[32:47]
    ds_read_b64_tr_b16 v[224:225], v12 offset:53248
    s_add_u32 m0, s25, 61440
    s_add_u32 s26, s31, 2801792
    buffer_load_dwordx4 v2, s[12:15], s26 offen lds
    v_mfma_f32_32x32x16_bf16 a[48:63], v[228:231], a[196:199], a[48:63]
    ds_read_b64_tr_b16 v[226:227], v12 offset:53760
    s_waitcnt lgkmcnt(8)
    v_mfma_f32_32x32x16_bf16 a[32:47], v[232:235], a[200:203], a[32:47]
    ds_read_b64_tr_b16 v[228:229], v15 offset:20480
    s_add_u32 s28, s27, 19456
    buffer_load_dwordx4 a[104:107], v1, s[8:11], s28 offen sc0 sc1
    v_mfma_f32_32x32x16_bf16 a[48:63], v[232:235], a[204:207], a[48:63]
    ds_read_b64_tr_b16 v[230:231], v15 offset:20992
    s_waitcnt lgkmcnt(8)
    v_mfma_f32_32x32x16_bf16 a[32:47], v[236:239], a[208:211], a[32:47]
    ds_read_b64_tr_b16 v[232:233], v15 offset:24576
    s_add_u32 s28, s27, 56320
    buffer_load_dwordx4 a[108:111], v1, s[8:11], s28 offen sc0 sc1
    v_mfma_f32_32x32x16_bf16 a[48:63], v[236:239], a[212:215], a[48:63]
    ds_read_b64_tr_b16 v[234:235], v15 offset:25088
    s_waitcnt lgkmcnt(8)
    v_mfma_f32_32x32x16_bf16 a[32:47], v[216:219], a[216:219], a[32:47]
    ds_read_b64_tr_b16 v[236:237], v15 offset:28672
    v_mfma_f32_32x32x16_bf16 a[48:63], v[216:219], a[220:223], a[48:63]
    ds_read_b64_tr_b16 v[238:239], v15 offset:29184
    s_waitcnt lgkmcnt(8)
    v_mfma_f32_32x32x16_bf16 a[32:47], v[220:223], a[224:227], a[32:47]
    ds_read_b64_tr_b16 v[216:217], v15 offset:32768
    s_add_u32 m0, s25, 65536
    s_add_u32 s26, s31, 2949248
    buffer_load_dwordx4 v2, s[12:15], s26 offen lds
    v_mfma_f32_32x32x16_bf16 a[48:63], v[220:223], a[228:231], a[48:63]
    ds_read_b64_tr_b16 v[218:219], v15 offset:33280
    s_waitcnt lgkmcnt(8)
    v_mfma_f32_32x32x16_bf16 a[32:47], v[224:227], a[232:235], a[32:47]
    ds_read_b64_tr_b16 v[220:221], v15 offset:36864
    v_mfma_f32_32x32x16_bf16 a[48:63], v[224:227], a[236:239], a[48:63]
    ds_read_b64_tr_b16 v[222:223], v15 offset:37376
    s_waitcnt lgkmcnt(8)
    v_mfma_f32_32x32x16_bf16 a[64:79], v[228:231], a[168:171], a[64:79]
    ds_read_b64_tr_b16 v[224:225], v15 offset:40960
    s_add_u32 m0, s25, 69632
    s_add_u32 s26, s31, 3096704
    buffer_load_dwordx4 v2, s[12:15], s26 offen lds
    v_mfma_f32_32x32x16_bf16 a[80:95], v[228:231], a[172:175], a[80:95]
    ds_read_b64_tr_b16 v[226:227], v15 offset:41472
    s_waitcnt lgkmcnt(8)
    v_mfma_f32_32x32x16_bf16 a[64:79], v[232:235], a[176:179], a[64:79]
    ds_read_b64_tr_b16 v[228:229], v15 offset:45056
    v_mfma_f32_32x32x16_bf16 a[80:95], v[232:235], a[180:183], a[80:95]
    ds_read_b64_tr_b16 v[230:231], v15 offset:45568
    s_waitcnt lgkmcnt(8)
    v_mfma_f32_32x32x16_bf16 a[64:79], v[236:239], a[184:187], a[64:79]
    ds_read_b64_tr_b16 v[232:233], v15 offset:49152
    s_add_u32 s28, s27, 20480
    buffer_load_dwordx4 a[112:115], v1, s[8:11], s28 offen sc0 sc1
    v_mfma_f32_32x32x16_bf16 a[80:95], v[236:239], a[188:191], a[80:95]
    ds_read_b64_tr_b16 v[234:235], v15 offset:49664
    s_waitcnt lgkmcnt(8)
    v_mfma_f32_32x32x16_bf16 a[64:79], v[216:219], a[192:195], a[64:79]
    ds_read_b64_tr_b16 v[236:237], v15 offset:53248
    s_add_u32 s28, s27, 57344
    buffer_load_dwordx4 a[116:119], v1, s[8:11], s28 offen sc0 sc1
    v_mfma_f32_32x32x16_bf16 a[80:95], v[216:219], a[196:199], a[80:95]
    ds_read_b64_tr_b16 v[238:239], v15 offset:53760
    s_waitcnt lgkmcnt(8)
    v_mfma_f32_32x32x16_bf16 a[64:79], v[220:223], a[200:203], a[64:79]
    ds_read_b64_tr_b16 v[216:217], v18 offset:20480
    s_add_u32 m0, s25, 73728
    s_add_u32 s26, s31, 3244160
    buffer_load_dwordx4 v2, s[12:15], s26 offen lds
    v_mfma_f32_32x32x16_bf16 a[80:95], v[220:223], a[204:207], a[80:95]
    ds_read_b64_tr_b16 v[218:219], v18 offset:20992
    s_waitcnt lgkmcnt(8)
    v_mfma_f32_32x32x16_bf16 a[64:79], v[224:227], a[208:211], a[64:79]
    ds_read_b64_tr_b16 v[220:221], v18 offset:24576
    v_mfma_f32_32x32x16_bf16 a[80:95], v[224:227], a[212:215], a[80:95]
    ds_read_b64_tr_b16 v[222:223], v18 offset:25088
    s_waitcnt lgkmcnt(8)
    v_mfma_f32_32x32x16_bf16 a[64:79], v[228:231], a[216:219], a[64:79]
    ds_read_b64_tr_b16 v[224:225], v18 offset:28672
    v_mfma_f32_32x32x16_bf16 a[80:95], v[228:231], a[220:223], a[80:95]
    ds_read_b64_tr_b16 v[226:227], v18 offset:29184
    s_waitcnt lgkmcnt(8)
    v_mfma_f32_32x32x16_bf16 a[64:79], v[232:235], a[224:227], a[64:79]
    ds_read_b64_tr_b16 v[228:229], v18 offset:32768
    v_mfma_f32_32x32x16_bf16 a[80:95], v[232:235], a[228:231], a[80:95]
    ds_read_b64_tr_b16 v[230:231], v18 offset:33280
    s_waitcnt lgkmcnt(8)
    v_mfma_f32_32x32x16_bf16 a[64:79], v[236:239], a[232:235], a[64:79]
    ds_read_b64_tr_b16 v[232:233], v18 offset:36864
    v_mfma_f32_32x32x16_bf16 a[80:95], v[236:239], a[236:239], a[80:95]
    ds_read_b64_tr_b16 v[234:235], v18 offset:37376
    s_waitcnt lgkmcnt(8)
    v_mfma_f32_32x32x16_bf16 v[24:39], v[216:219], a[168:171], v[24:39]
    ds_read_b64_tr_b16 v[236:237], v18 offset:40960
    s_add_u32 s28, s27, 21504
    buffer_load_dwordx4 a[120:123], v1, s[8:11], s28 offen sc0 sc1
    v_mfma_f32_32x32x16_bf16 v[40:55], v[216:219], a[172:175], v[40:55]
    ds_read_b64_tr_b16 v[238:239], v18 offset:41472
    s_waitcnt lgkmcnt(8)
    v_mfma_f32_32x32x16_bf16 v[24:39], v[220:223], a[176:179], v[24:39]
    ds_read_b64_tr_b16 v[216:217], v18 offset:45056
    s_add_u32 s28, s27, 58368
    buffer_load_dwordx4 a[124:127], v1, s[8:11], s28 offen sc0 sc1
    v_mfma_f32_32x32x16_bf16 v[40:55], v[220:223], a[180:183], v[40:55]
    ds_read_b64_tr_b16 v[218:219], v18 offset:45568
    s_waitcnt lgkmcnt(8)
    v_mfma_f32_32x32x16_bf16 v[24:39], v[224:227], a[184:187], v[24:39]
    ds_read_b64_tr_b16 v[220:221], v18 offset:49152
    v_mfma_f32_32x32x16_bf16 v[40:55], v[224:227], a[188:191], v[40:55]
    ds_read_b64_tr_b16 v[222:223], v18 offset:49664
    s_waitcnt lgkmcnt(8)
    v_mfma_f32_32x32x16_bf16 v[24:39], v[228:231], a[192:195], v[24:39]
    ds_read_b64_tr_b16 v[224:225], v18 offset:53248
    v_mfma_f32_32x32x16_bf16 v[40:55], v[228:231], a[196:199], v[40:55]
    ds_read_b64_tr_b16 v[226:227], v18 offset:53760
    s_barrier
    s_waitcnt lgkmcnt(8)
    v_mfma_f32_32x32x16_bf16 v[24:39], v[232:235], a[200:203], v[24:39]
    ds_read_b64_tr_b16 v[228:229], v9 offset:57344
    v_mfma_f32_32x32x16_bf16 v[40:55], v[232:235], a[204:207], v[40:55]
    ds_read_b64_tr_b16 v[230:231], v9 offset:57856
    s_waitcnt lgkmcnt(8)
    v_mfma_f32_32x32x16_bf16 v[24:39], v[236:239], a[208:211], v[24:39]
    ds_read_b64_tr_b16 v[232:233], v9 offset:61440
    s_add_u32 m0, s25, 77824
    s_add_u32 s26, s31, 3391616
    buffer_load_dwordx4 v2, s[12:15], s26 offen lds
    v_mfma_f32_32x32x16_bf16 v[40:55], v[236:239], a[212:215], v[40:55]
    ds_read_b64_tr_b16 v[234:235], v9 offset:61952
    s_waitcnt lgkmcnt(8)
    v_mfma_f32_32x32x16_bf16 v[24:39], v[216:219], a[216:219], v[24:39]
    ds_read_b64_tr_b16 v[236:237], v10 offset:0
    v_mfma_f32_32x32x16_bf16 v[40:55], v[216:219], a[220:223], v[40:55]
    ds_read_b64_tr_b16 v[238:239], v10 offset:512
    s_waitcnt lgkmcnt(8)
    v_mfma_f32_32x32x16_bf16 v[24:39], v[220:223], a[224:227], v[24:39]
    ds_read_b64_tr_b16 v[216:217], v10 offset:4096
    s_add_u32 s28, s27, 22528
    buffer_load_dwordx4 a[128:131], v1, s[8:11], s28 offen sc0 sc1
    v_mfma_f32_32x32x16_bf16 v[40:55], v[220:223], a[228:231], v[40:55]
    ds_read_b64_tr_b16 v[218:219], v10 offset:4608
    s_waitcnt lgkmcnt(8)
    v_mfma_f32_32x32x16_bf16 v[24:39], v[224:227], a[232:235], v[24:39]
    ds_read_b64_tr_b16 v[220:221], v10 offset:8192
    s_add_u32 s28, s27, 59392
    buffer_load_dwordx4 a[132:135], v1, s[8:11], s28 offen sc0 sc1
    v_mfma_f32_32x32x16_bf16 v[40:55], v[224:227], a[236:239], v[40:55]
    ds_read_b64_tr_b16 v[222:223], v10 offset:8704
    s_waitcnt lgkmcnt(8)
    v_mfma_f32_32x32x16_bf16 v[56:71], v[228:231], a[168:171], v[56:71]
    ds_read_b64_tr_b16 v[224:225], v10 offset:12288
    v_mfma_f32_32x32x16_bf16 v[72:87], v[228:231], a[172:175], v[72:87]
    ds_read_b64_tr_b16 v[226:227], v10 offset:12800
    s_waitcnt lgkmcnt(8)
    v_mfma_f32_32x32x16_bf16 v[56:71], v[232:235], a[176:179], v[56:71]
    ds_read_b64_tr_b16 v[228:229], v8 offset:0
    v_mfma_f32_32x32x16_bf16 v[72:87], v[232:235], a[180:183], v[72:87]
    ds_read_b64_tr_b16 v[230:231], v8 offset:512
    s_waitcnt lgkmcnt(8)
    v_mfma_f32_32x32x16_bf16 v[56:71], v[236:239], a[184:187], v[56:71]
    ds_read_b64_tr_b16 v[232:233], v8 offset:4096
    v_mfma_f32_32x32x16_bf16 v[72:87], v[236:239], a[188:191], v[72:87]
    ds_read_b64_tr_b16 v[234:235], v8 offset:4608
    s_waitcnt lgkmcnt(8)
    v_mfma_f32_32x32x16_bf16 v[56:71], v[216:219], a[192:195], v[56:71]
    ds_read_b64_tr_b16 v[236:237], v8 offset:8192
    v_mfma_f32_32x32x16_bf16 v[72:87], v[216:219], a[196:199], v[72:87]
    ds_read_b64_tr_b16 v[238:239], v8 offset:8704
    s_waitcnt lgkmcnt(8)
    v_mfma_f32_32x32x16_bf16 v[56:71], v[220:223], a[200:203], v[56:71]
    ds_read_b64_tr_b16 v[216:217], v12 offset:57344
    v_mfma_f32_32x32x16_bf16 v[72:87], v[220:223], a[204:207], v[72:87]
    ds_read_b64_tr_b16 v[218:219], v12 offset:57856
    s_waitcnt lgkmcnt(8)
    v_mfma_f32_32x32x16_bf16 v[56:71], v[224:227], a[208:211], v[56:71]
    ds_read_b64_tr_b16 v[220:221], v12 offset:61440
    s_add_u32 s28, s27, 23552
    buffer_load_dwordx4 a[136:139], v1, s[8:11], s28 offen sc0 sc1
    v_mfma_f32_32x32x16_bf16 v[72:87], v[224:227], a[212:215], v[72:87]
    ds_read_b64_tr_b16 v[222:223], v12 offset:61952
    s_waitcnt lgkmcnt(8)
    v_mfma_f32_32x32x16_bf16 v[56:71], v[228:231], a[216:219], v[56:71]
    ds_read_b64_tr_b16 v[224:225], v13 offset:0
    s_add_u32 s28, s27, 60416
    buffer_load_dwordx4 a[140:143], v1, s[8:11], s28 offen sc0 sc1
    v_mfma_f32_32x32x16_bf16 v[72:87], v[228:231], a[220:223], v[72:87]
    ds_read_b64_tr_b16 v[226:227], v13 offset:512
    s_waitcnt lgkmcnt(8)
    v_mfma_f32_32x32x16_bf16 v[56:71], v[232:235], a[224:227], v[56:71]
    ds_read_b64_tr_b16 v[228:229], v13 offset:4096
    v_mfma_f32_32x32x16_bf16 v[72:87], v[232:235], a[228:231], v[72:87]
    ds_read_b64_tr_b16 v[230:231], v13 offset:4608
    s_waitcnt lgkmcnt(8)
    v_mfma_f32_32x32x16_bf16 v[56:71], v[236:239], a[232:235], v[56:71]
    ds_read_b64_tr_b16 v[232:233], v13 offset:8192
    v_mfma_f32_32x32x16_bf16 v[72:87], v[236:239], a[236:239], v[72:87]
    ds_read_b64_tr_b16 v[234:235], v13 offset:8704
    s_waitcnt lgkmcnt(8)
    v_mfma_f32_32x32x16_bf16 v[88:103], v[216:219], a[168:171], v[88:103]
    ds_read_b64_tr_b16 v[236:237], v13 offset:12288
    v_mfma_f32_32x32x16_bf16 v[104:119], v[216:219], a[172:175], v[104:119]
    ds_read_b64_tr_b16 v[238:239], v13 offset:12800
    s_waitcnt lgkmcnt(8)
    v_mfma_f32_32x32x16_bf16 v[88:103], v[220:223], a[176:179], v[88:103]
    ds_read_b64_tr_b16 v[216:217], v11 offset:0
    v_mfma_f32_32x32x16_bf16 v[104:119], v[220:223], a[180:183], v[104:119]
    ds_read_b64_tr_b16 v[218:219], v11 offset:512
    s_waitcnt lgkmcnt(8)
    v_mfma_f32_32x32x16_bf16 v[88:103], v[224:227], a[184:187], v[88:103]
    ds_read_b64_tr_b16 v[220:221], v11 offset:4096
    v_mfma_f32_32x32x16_bf16 v[104:119], v[224:227], a[188:191], v[104:119]
    ds_read_b64_tr_b16 v[222:223], v11 offset:4608
    s_waitcnt lgkmcnt(8)
    v_mfma_f32_32x32x16_bf16 v[88:103], v[228:231], a[192:195], v[88:103]
    ds_read_b64_tr_b16 v[224:225], v11 offset:8192
    s_add_u32 s28, s27, 24576
    buffer_load_dwordx4 a[144:147], v1, s[8:11], s28 offen sc0 sc1
    v_mfma_f32_32x32x16_bf16 v[104:119], v[228:231], a[196:199], v[104:119]
    ds_read_b64_tr_b16 v[226:227], v11 offset:8704
    s_waitcnt lgkmcnt(8)
    v_mfma_f32_32x32x16_bf16 v[88:103], v[232:235], a[200:203], v[88:103]
    ds_read_b64_tr_b16 v[228:229], v15 offset:57344
    s_add_u32 s28, s27, 61440
    buffer_load_dwordx4 a[148:151], v1, s[8:11], s28 offen sc0 sc1
    v_mfma_f32_32x32x16_bf16 v[104:119], v[232:235], a[204:207], v[104:119]
    ds_read_b64_tr_b16 v[230:231], v15 offset:57856
    s_waitcnt lgkmcnt(8)
    v_mfma_f32_32x32x16_bf16 v[88:103], v[236:239], a[208:211], v[88:103]
    ds_read_b64_tr_b16 v[232:233], v15 offset:61440
    v_mfma_f32_32x32x16_bf16 v[104:119], v[236:239], a[212:215], v[104:119]
    ds_read_b64_tr_b16 v[234:235], v15 offset:61952
    s_waitcnt lgkmcnt(8)
    v_mfma_f32_32x32x16_bf16 v[88:103], v[216:219], a[216:219], v[88:103]
    ds_read_b64_tr_b16 v[236:237], v16 offset:0
    v_mfma_f32_32x32x16_bf16 v[104:119], v[216:219], a[220:223], v[104:119]
    ds_read_b64_tr_b16 v[238:239], v16 offset:512
    s_waitcnt lgkmcnt(8)
    v_mfma_f32_32x32x16_bf16 v[88:103], v[220:223], a[224:227], v[88:103]
    ds_read_b64_tr_b16 v[216:217], v16 offset:4096
    v_mfma_f32_32x32x16_bf16 v[104:119], v[220:223], a[228:231], v[104:119]
    ds_read_b64_tr_b16 v[218:219], v16 offset:4608
    s_waitcnt lgkmcnt(8)
    v_mfma_f32_32x32x16_bf16 v[88:103], v[224:227], a[232:235], v[88:103]
    ds_read_b64_tr_b16 v[220:221], v16 offset:8192
    v_mfma_f32_32x32x16_bf16 v[104:119], v[224:227], a[236:239], v[104:119]
    ds_read_b64_tr_b16 v[222:223], v16 offset:8704
    s_waitcnt lgkmcnt(8)
    v_mfma_f32_32x32x16_bf16 v[120:135], v[228:231], a[168:171], v[120:135]
    ds_read_b64_tr_b16 v[224:225], v16 offset:12288
    v_mfma_f32_32x32x16_bf16 v[136:151], v[228:231], a[172:175], v[136:151]
    ds_read_b64_tr_b16 v[226:227], v16 offset:12800
    s_waitcnt lgkmcnt(8)
    v_mfma_f32_32x32x16_bf16 v[120:135], v[232:235], a[176:179], v[120:135]
    ds_read_b64_tr_b16 v[228:229], v14 offset:0
    s_add_u32 s28, s27, 25600
    buffer_load_dwordx4 a[152:155], v1, s[8:11], s28 offen sc0 sc1
    v_mfma_f32_32x32x16_bf16 v[136:151], v[232:235], a[180:183], v[136:151]
    ds_read_b64_tr_b16 v[230:231], v14 offset:512
    s_waitcnt lgkmcnt(8)
    v_mfma_f32_32x32x16_bf16 v[120:135], v[236:239], a[184:187], v[120:135]
    ds_read_b64_tr_b16 v[232:233], v14 offset:4096
    s_add_u32 s28, s27, 62464
    buffer_load_dwordx4 a[156:159], v1, s[8:11], s28 offen sc0 sc1
    v_mfma_f32_32x32x16_bf16 v[136:151], v[236:239], a[188:191], v[136:151]
    ds_read_b64_tr_b16 v[234:235], v14 offset:4608
    s_waitcnt lgkmcnt(8)
    v_mfma_f32_32x32x16_bf16 v[120:135], v[216:219], a[192:195], v[120:135]
    ds_read_b64_tr_b16 v[236:237], v14 offset:8192
    v_mfma_f32_32x32x16_bf16 v[136:151], v[216:219], a[196:199], v[136:151]
    ds_read_b64_tr_b16 v[238:239], v14 offset:8704
    s_waitcnt lgkmcnt(8)
    v_mfma_f32_32x32x16_bf16 v[120:135], v[220:223], a[200:203], v[120:135]
    ds_read_b64_tr_b16 v[216:217], v18 offset:57344
    v_mfma_f32_32x32x16_bf16 v[136:151], v[220:223], a[204:207], v[136:151]
    ds_read_b64_tr_b16 v[218:219], v18 offset:57856
    s_waitcnt lgkmcnt(8)
    v_mfma_f32_32x32x16_bf16 v[120:135], v[224:227], a[208:211], v[120:135]
    ds_read_b64_tr_b16 v[220:221], v18 offset:61440
    v_mfma_f32_32x32x16_bf16 v[136:151], v[224:227], a[212:215], v[136:151]
    ds_read_b64_tr_b16 v[222:223], v18 offset:61952
    s_waitcnt lgkmcnt(8)
    v_mfma_f32_32x32x16_bf16 v[120:135], v[228:231], a[216:219], v[120:135]
    ds_read_b64_tr_b16 v[224:225], v19 offset:0
    v_mfma_f32_32x32x16_bf16 v[136:151], v[228:231], a[220:223], v[136:151]
    ds_read_b64_tr_b16 v[226:227], v19 offset:512
    s_waitcnt lgkmcnt(8)
    v_mfma_f32_32x32x16_bf16 v[120:135], v[232:235], a[224:227], v[120:135]
    ds_read_b64_tr_b16 v[228:229], v19 offset:4096
    v_mfma_f32_32x32x16_bf16 v[136:151], v[232:235], a[228:231], v[136:151]
    ds_read_b64_tr_b16 v[230:231], v19 offset:4608
    s_waitcnt lgkmcnt(8)
    v_mfma_f32_32x32x16_bf16 v[120:135], v[236:239], a[232:235], v[120:135]
    ds_read_b64_tr_b16 v[232:233], v19 offset:8192
    s_add_u32 s28, s27, 26624
    buffer_load_dwordx4 a[160:163], v1, s[8:11], s28 offen sc0 sc1
    v_mfma_f32_32x32x16_bf16 v[136:151], v[236:239], a[236:239], v[136:151]
    ds_read_b64_tr_b16 v[234:235], v19 offset:8704
    s_waitcnt lgkmcnt(8)
    v_mfma_f32_32x32x16_bf16 v[152:167], v[216:219], a[168:171], v[152:167]
    ds_read_b64_tr_b16 v[236:237], v19 offset:12288
    s_add_u32 s28, s27, 63488
    buffer_load_dwordx4 a[164:167], v1, s[8:11], s28 offen sc0 sc1
    v_mfma_f32_32x32x16_bf16 v[168:183], v[216:219], a[172:175], v[168:183]
    ds_read_b64_tr_b16 v[238:239], v19 offset:12800
    s_waitcnt lgkmcnt(8)
    v_mfma_f32_32x32x16_bf16 v[152:167], v[220:223], a[176:179], v[152:167]
    ds_read_b64_tr_b16 v[216:217], v17 offset:0
    v_mfma_f32_32x32x16_bf16 v[168:183], v[220:223], a[180:183], v[168:183]
    ds_read_b64_tr_b16 v[218:219], v17 offset:512
    s_waitcnt lgkmcnt(8)
    v_mfma_f32_32x32x16_bf16 v[152:167], v[224:227], a[184:187], v[152:167]
    ds_read_b64_tr_b16 v[220:221], v17 offset:4096
    v_mfma_f32_32x32x16_bf16 v[168:183], v[224:227], a[188:191], v[168:183]
    ds_read_b64_tr_b16 v[222:223], v17 offset:4608
    s_waitcnt lgkmcnt(8)
    v_mfma_f32_32x32x16_bf16 v[152:167], v[228:231], a[192:195], v[152:167]
    ds_read_b64_tr_b16 v[224:225], v17 offset:8192
    v_mfma_f32_32x32x16_bf16 v[168:183], v[228:231], a[196:199], v[168:183]
    ds_read_b64_tr_b16 v[226:227], v17 offset:8704
    s_barrier
    s_waitcnt lgkmcnt(8)
    v_mfma_f32_32x32x16_bf16 v[152:167], v[232:235], a[200:203], v[152:167]
    ds_read_b64_tr_b16 v[228:229], v21 offset:16896
    v_mfma_f32_32x32x16_bf16 v[168:183], v[232:235], a[204:207], v[168:183]
    ds_read_b64_tr_b16 v[230:231], v21 offset:17024
    s_waitcnt lgkmcnt(8)
    v_mfma_f32_32x32x16_bf16 v[152:167], v[236:239], a[208:211], v[152:167]
    ds_read_b64_tr_b16 v[232:233], v21 offset:17408
    v_mfma_f32_32x32x16_bf16 v[168:183], v[236:239], a[212:215], v[168:183]
    ds_read_b64_tr_b16 v[234:235], v21 offset:17536
    s_waitcnt lgkmcnt(8)
    v_mfma_f32_32x32x16_bf16 v[152:167], v[216:219], a[216:219], v[152:167]
    ds_read_b64_tr_b16 v[236:237], v21 offset:17920
    v_mfma_f32_32x32x16_bf16 v[168:183], v[216:219], a[220:223], v[168:183]
    ds_read_b64_tr_b16 v[238:239], v21 offset:18048
    s_waitcnt lgkmcnt(8)
    v_mfma_f32_32x32x16_bf16 v[152:167], v[220:223], a[224:227], v[152:167]
    ds_read_b64_tr_b16 v[216:217], v20 offset:12288
    v_mfma_f32_32x32x16_bf16 v[168:183], v[220:223], a[228:231], v[168:183]
    ds_read_b64_tr_b16 v[218:219], v20 offset:12416
    s_waitcnt lgkmcnt(8)
    v_mfma_f32_32x32x16_bf16 v[152:167], v[224:227], a[232:235], v[152:167]
    ds_read_b64_tr_b16 v[220:221], v20 offset:12800
    v_mfma_f32_32x32x16_bf16 v[168:183], v[224:227], a[236:239], v[168:183]
    ds_read_b64_tr_b16 v[222:223], v20 offset:12928
    s_waitcnt lgkmcnt(8)
    v_mfma_f32_32x32x16_bf16 v[184:199], v[228:231], a[168:171], v[184:199]
    ds_read_b64_tr_b16 v[224:225], v20 offset:13312
    v_mfma_f32_32x32x16_bf16 v[200:215], v[228:231], a[172:175], v[200:215]
    ds_read_b64_tr_b16 v[226:227], v20 offset:13440
    s_waitcnt lgkmcnt(8)
    v_mfma_f32_32x32x16_bf16 v[184:199], v[232:235], a[176:179], v[184:199]
    ds_read_b64_tr_b16 v[228:229], v20 offset:13824
    v_mfma_f32_32x32x16_bf16 v[200:215], v[232:235], a[180:183], v[200:215]
    ds_read_b64_tr_b16 v[230:231], v20 offset:13952
    s_waitcnt lgkmcnt(8)
    v_mfma_f32_32x32x16_bf16 v[184:199], v[236:239], a[184:187], v[184:199]
    ds_read_b64_tr_b16 v[232:233], v20 offset:16384
    v_mfma_f32_32x32x16_bf16 v[200:215], v[236:239], a[188:191], v[200:215]
    ds_read_b64_tr_b16 v[234:235], v20 offset:16512
    s_waitcnt lgkmcnt(8)
    v_mfma_f32_32x32x16_bf16 v[184:199], v[216:219], a[192:195], v[184:199]
    ds_read_b64_tr_b16 v[236:237], v20 offset:16896
    v_mfma_f32_32x32x16_bf16 v[200:215], v[216:219], a[196:199], v[200:215]
    ds_read_b64_tr_b16 v[238:239], v20 offset:17024
    s_waitcnt vmcnt(22)
    s_barrier
    s_waitcnt lgkmcnt(8)
    v_mfma_f32_32x32x16_bf16 v[184:199], v[220:223], a[200:203], v[184:199]
    ds_read_b64_tr_b16 v[216:217], v8 offset:20480
    s_add_u32 m0, s25, 81920
    s_add_u32 s26, s31, 3539072
    buffer_load_dwordx4 v2, s[12:15], s26 offen lds
    v_mfma_f32_32x32x16_bf16 v[200:215], v[220:223], a[204:207], v[200:215]
    ds_read_b64_tr_b16 v[218:219], v8 offset:20992
    s_waitcnt lgkmcnt(8)
    v_mfma_f32_32x32x16_bf16 v[184:199], v[224:227], a[208:211], v[184:199]
    ds_read_b64_tr_b16 v[220:221], v8 offset:24576
    v_mfma_f32_32x32x16_bf16 v[200:215], v[224:227], a[212:215], v[200:215]
    ds_read_b64_tr_b16 v[222:223], v8 offset:25088
    s_waitcnt lgkmcnt(8)
    v_mfma_f32_32x32x16_bf16 v[184:199], v[228:231], a[216:219], v[184:199]
    ds_read_b64_tr_b16 v[224:225], v8 offset:28672
    s_add_u32 m0, s25, 86016
    s_add_u32 s26, s31, 3686528
    buffer_load_dwordx4 v2, s[12:15], s26 offen lds
    v_mfma_f32_32x32x16_bf16 v[200:215], v[228:231], a[220:223], v[200:215]
    ds_read_b64_tr_b16 v[226:227], v8 offset:29184
    s_waitcnt lgkmcnt(8)
    v_mfma_f32_32x32x16_bf16 v[184:199], v[232:235], a[224:227], v[184:199]
    ds_read_b64_tr_b16 v[228:229], v8 offset:32768
    v_mfma_f32_32x32x16_bf16 v[200:215], v[232:235], a[228:231], v[200:215]
    ds_read_b64_tr_b16 v[230:231], v8 offset:33280
    s_waitcnt lgkmcnt(8)
    v_mfma_f32_32x32x16_bf16 v[184:199], v[236:239], a[232:235], v[184:199]
    ds_read_b64_tr_b16 v[232:233], v8 offset:36864
    s_add_u32 m0, s25, 90112
    s_add_u32 s26, s31, 3833984
    buffer_load_dwordx4 v2, s[12:15], s26 offen lds
    v_mfma_f32_32x32x16_bf16 v[200:215], v[236:239], a[236:239], v[200:215]
    ds_read_b64_tr_b16 v[234:235], v8 offset:37376
    s_waitcnt lgkmcnt(8)
    v_mfma_f32_32x32x16_bf16 a[0:15], v[216:219], a[96:99], a[0:15]
    ds_read_b64_tr_b16 v[236:237], v8 offset:40960
    v_mfma_f32_32x32x16_bf16 a[16:31], v[216:219], a[100:103], a[16:31]
    ds_read_b64_tr_b16 v[238:239], v8 offset:41472
    s_waitcnt vmcnt(21)
    s_waitcnt lgkmcnt(8)
    v_mfma_f32_32x32x16_bf16 a[0:15], v[220:223], a[104:107], a[0:15]
    ds_read_b64_tr_b16 v[216:217], v8 offset:45056
    s_add_u32 m0, s25, 94208
    s_add_u32 s26, s32, 2949120
    buffer_load_dwordx4 v3, s[12:15], s26 offen lds
    v_mfma_f32_32x32x16_bf16 a[16:31], v[220:223], a[108:111], a[16:31]
    ds_read_b64_tr_b16 v[218:219], v8 offset:45568
    s_waitcnt vmcnt(18)
    s_waitcnt lgkmcnt(8)
    v_mfma_f32_32x32x16_bf16 a[0:15], v[224:227], a[112:115], a[0:15]
    ds_read_b64_tr_b16 v[220:221], v8 offset:49152
    v_mfma_f32_32x32x16_bf16 a[16:31], v[224:227], a[116:119], a[16:31]
    ds_read_b64_tr_b16 v[222:223], v8 offset:49664
    s_waitcnt vmcnt(15)
    s_waitcnt lgkmcnt(8)
    v_mfma_f32_32x32x16_bf16 a[0:15], v[228:231], a[120:123], a[0:15]
    ds_read_b64_tr_b16 v[224:225], v8 offset:53248
    s_add_u32 m0, s25, 98304
    s_add_u32 s26, s32, 3538944
    buffer_load_dwordx4 v3, s[12:15], s26 offen lds
    v_mfma_f32_32x32x16_bf16 a[16:31], v[228:231], a[124:127], a[16:31]
    ds_read_b64_tr_b16 v[226:227], v8 offset:53760
    s_waitcnt vmcnt(13)
    s_waitcnt lgkmcnt(8)
    v_mfma_f32_32x32x16_bf16 a[0:15], v[232:235], a[128:131], a[0:15]
    ds_read_b64_tr_b16 v[228:229], v11 offset:20480
    v_mfma_f32_32x32x16_bf16 a[16:31], v[232:235], a[132:135], a[16:31]
    ds_read_b64_tr_b16 v[230:231], v11 offset:20992
    s_waitcnt vmcnt(11)
    s_waitcnt lgkmcnt(8)
    v_mfma_f32_32x32x16_bf16 a[0:15], v[236:239], a[136:139], a[0:15]
    ds_read_b64_tr_b16 v[232:233], v11 offset:24576
    s_add_u32 m0, s25, 102400
    s_add_u32 s26, s31, 3981312
    buffer_load_dwordx4 v2, s[12:15], s26 offen lds
    v_mfma_f32_32x32x16_bf16 a[16:31], v[236:239], a[140:143], a[16:31]
    ds_read_b64_tr_b16 v[234:235], v11 offset:25088
    s_waitcnt vmcnt(10)
    s_waitcnt lgkmcnt(8)
    v_mfma_f32_32x32x16_bf16 a[0:15], v[216:219], a[144:147], a[0:15]
    ds_read_b64_tr_b16 v[236:237], v11 offset:28672
    s_add_u32 s28, s27, 27648
    buffer_load_dwordx4 a[168:171], v1, s[8:11], s28 offen sc0 sc1
    v_mfma_f32_32x32x16_bf16 a[16:31], v[216:219], a[148:151], a[16:31]
    ds_read_b64_tr_b16 v[238:239], v11 offset:29184
    s_waitcnt vmcnt(9)
    s_waitcnt lgkmcnt(8)
    v_mfma_f32_32x32x16_bf16 a[0:15], v[220:223], a[152:155], a[0:15]
    ds_read_b64_tr_b16 v[216:217], v11 offset:32768
    s_add_u32 s28, s27, 64512
    buffer_load_dwordx4 a[172:175], v1, s[8:11], s28 offen sc0 sc1
    v_mfma_f32_32x32x16_bf16 a[16:31], v[220:223], a[156:159], a[16:31]
    ds_read_b64_tr_b16 v[218:219], v11 offset:33280
    s_waitcnt vmcnt(8)
    s_waitcnt lgkmcnt(8)
    v_mfma_f32_32x32x16_bf16 a[0:15], v[224:227], a[160:163], a[0:15]
    ds_read_b64_tr_b16 v[220:221], v11 offset:36864
    v_mfma_f32_32x32x16_bf16 a[16:31], v[224:227], a[164:167], a[16:31]
    ds_read_b64_tr_b16 v[222:223], v11 offset:37376
    s_waitcnt lgkmcnt(8)
    v_mfma_f32_32x32x16_bf16 a[32:47], v[228:231], a[96:99], a[32:47]
    ds_read_b64_tr_b16 v[224:225], v11 offset:40960
    s_add_u32 m0, s25, 106496
    s_add_u32 s26, s31, 4128768
    buffer_load_dwordx4 v2, s[12:15], s26 offen lds
    v_mfma_f32_32x32x16_bf16 a[48:63], v[228:231], a[100:103], a[48:63]
    ds_read_b64_tr_b16 v[226:227], v11 offset:41472
    s_waitcnt lgkmcnt(8)
    v_mfma_f32_32x32x16_bf16 a[32:47], v[232:235], a[104:107], a[32:47]
    ds_read_b64_tr_b16 v[228:229], v11 offset:45056
    v_mfma_f32_32x32x16_bf16 a[48:63], v[232:235], a[108:111], a[48:63]
    ds_read_b64_tr_b16 v[230:231], v11 offset:45568
    s_waitcnt lgkmcnt(8)
    v_mfma_f32_32x32x16_bf16 a[32:47], v[236:239], a[112:115], a[32:47]
    ds_read_b64_tr_b16 v[232:233], v11 offset:49152
    s_add_u32 m0, s25, 110592
    s_add_u32 s26, s31, 4276224
    buffer_load_dwordx4 v2, s[12:15], s26 offen lds
    v_mfma_f32_32x32x16_bf16 a[48:63], v[236:239], a[116:119], a[48:63]
    ds_read_b64_tr_b16 v[234:235], v11 offset:49664
    s_waitcnt lgkmcnt(8)
    v_mfma_f32_32x32x16_bf16 a[32:47], v[216:219], a[120:123], a[32:47]
    ds_read_b64_tr_b16 v[236:237], v11 offset:53248
    v_mfma_f32_32x32x16_bf16 a[48:63], v[216:219], a[124:127], a[48:63]
    ds_read_b64_tr_b16 v[238:239], v11 offset:53760
    s_waitcnt lgkmcnt(8)
    v_mfma_f32_32x32x16_bf16 a[32:47], v[220:223], a[128:131], a[32:47]
    ds_read_b64_tr_b16 v[216:217], v14 offset:20480
    s_add_u32 s28, s27, 28672
    buffer_load_dwordx4 a[176:179], v1, s[8:11], s28 offen sc0 sc1
    v_mfma_f32_32x32x16_bf16 a[48:63], v[220:223], a[132:135], a[48:63]
    ds_read_b64_tr_b16 v[218:219], v14 offset:20992
    s_waitcnt lgkmcnt(8)
    v_mfma_f32_32x32x16_bf16 a[32:47], v[224:227], a[136:139], a[32:47]
    ds_read_b64_tr_b16 v[220:221], v14 offset:24576
    s_add_u32 s28, s27, 65536
    buffer_load_dwordx4 a[180:183], v1, s[8:11], s28 offen sc0 sc1
    v_mfma_f32_32x32x16_bf16 a[48:63], v[224:227], a[140:143], a[48:63]
    ds_read_b64_tr_b16 v[222:223], v14 offset:25088
    s_waitcnt lgkmcnt(8)
    v_mfma_f32_32x32x16_bf16 a[32:47], v[228:231], a[144:147], a[32:47]
    ds_read_b64_tr_b16 v[224:225], v14 offset:28672
    s_add_u32 m0, s25, 114688
    s_add_u32 s26, s31, 4423680
    buffer_load_dwordx4 v2, s[12:15], s26 offen lds
    v_mfma_f32_32x32x16_bf16 a[48:63], v[228:231], a[148:151], a[48:63]
    ds_read_b64_tr_b16 v[226:227], v14 offset:29184
    s_waitcnt lgkmcnt(8)
    v_mfma_f32_32x32x16_bf16 a[32:47], v[232:235], a[152:155], a[32:47]
    ds_read_b64_tr_b16 v[228:229], v14 offset:32768
    v_mfma_f32_32x32x16_bf16 a[48:63], v[232:235], a[156:159], a[48:63]
    ds_read_b64_tr_b16 v[230:231], v14 offset:33280
    s_waitcnt lgkmcnt(8)
    v_mfma_f32_32x32x16_bf16 a[32:47], v[236:239], a[160:163], a[32:47]
    ds_read_b64_tr_b16 v[232:233], v14 offset:36864
    s_add_u32 m0, s25, 118784
    s_add_u32 s26, s31, 4571136
    buffer_load_dwordx4 v2, s[12:15], s26 offen lds
    v_mfma_f32_32x32x16_bf16 a[48:63], v[236:239], a[164:167], a[48:63]
    ds_read_b64_tr_b16 v[234:235], v14 offset:37376
    s_waitcnt lgkmcnt(8)
    v_mfma_f32_32x32x16_bf16 a[64:79], v[216:219], a[96:99], a[64:79]
    ds_read_b64_tr_b16 v[236:237], v14 offset:40960
    v_mfma_f32_32x32x16_bf16 a[80:95], v[216:219], a[100:103], a[80:95]
    ds_read_b64_tr_b16 v[238:239], v14 offset:41472
    s_waitcnt lgkmcnt(8)
    v_mfma_f32_32x32x16_bf16 a[64:79], v[220:223], a[104:107], a[64:79]
    ds_read_b64_tr_b16 v[216:217], v14 offset:45056
    s_add_u32 m0, s25, 122880
    s_add_u32 s26, s31, 4718592
    buffer_load_dwordx4 v2, s[12:15], s26 offen lds
    v_mfma_f32_32x32x16_bf16 a[80:95], v[220:223], a[108:111], a[80:95]
    ds_read_b64_tr_b16 v[218:219], v14 offset:45568
    s_waitcnt lgkmcnt(8)
    v_mfma_f32_32x32x16_bf16 a[64:79], v[224:227], a[112:115], a[64:79]
    ds_read_b64_tr_b16 v[220:221], v14 offset:49152
    s_add_u32 s28, s27, 29696
    buffer_load_dwordx4 a[184:187], v1, s[8:11], s28 offen sc0 sc1
    v_mfma_f32_32x32x16_bf16 a[80:95], v[224:227], a[116:119], a[80:95]
    ds_read_b64_tr_b16 v[222:223], v14 offset:49664
    s_waitcnt lgkmcnt(8)
    v_mfma_f32_32x32x16_bf16 a[64:79], v[228:231], a[120:123], a[64:79]
    ds_read_b64_tr_b16 v[224:225], v14 offset:53248
    s_add_u32 s28, s27, 66560
    buffer_load_dwordx4 a[188:191], v1, s[8:11], s28 offen sc0 sc1
    v_mfma_f32_32x32x16_bf16 a[80:95], v[228:231], a[124:127], a[80:95]
    ds_read_b64_tr_b16 v[226:227], v14 offset:53760
    s_waitcnt lgkmcnt(8)
    v_mfma_f32_32x32x16_bf16 a[64:79], v[232:235], a[128:131], a[64:79]
    ds_read_b64_tr_b16 v[228:229], v17 offset:20480
    v_mfma_f32_32x32x16_bf16 a[80:95], v[232:235], a[132:135], a[80:95]
    ds_read_b64_tr_b16 v[230:231], v17 offset:20992
    s_waitcnt lgkmcnt(8)
    v_mfma_f32_32x32x16_bf16 a[64:79], v[236:239], a[136:139], a[64:79]
    ds_read_b64_tr_b16 v[232:233], v17 offset:24576
    s_add_u32 m0, s25, 126976
    s_add_u32 s26, s31, 4866048
    buffer_load_dwordx4 v2, s[12:15], s26 offen lds
    v_mfma_f32_32x32x16_bf16 a[80:95], v[236:239], a[140:143], a[80:95]
    ds_read_b64_tr_b16 v[234:235], v17 offset:25088
    s_waitcnt lgkmcnt(8)
    v_mfma_f32_32x32x16_bf16 a[64:79], v[216:219], a[144:147], a[64:79]
    ds_read_b64_tr_b16 v[236:237], v17 offset:28672
    v_mfma_f32_32x32x16_bf16 a[80:95], v[216:219], a[148:151], a[80:95]
    ds_read_b64_tr_b16 v[238:239], v17 offset:29184
    s_waitcnt lgkmcnt(8)
    v_mfma_f32_32x32x16_bf16 a[64:79], v[220:223], a[152:155], a[64:79]
    ds_read_b64_tr_b16 v[216:217], v17 offset:32768
    s_add_u32 m0, s25, 131072
    s_add_u32 s26, s31, 5013504
    buffer_load_dwordx4 v2, s[12:15], s26 offen lds
    v_mfma_f32_32x32x16_bf16 a[80:95], v[220:223], a[156:159], a[80:95]
    ds_read_b64_tr_b16 v[218:219], v17 offset:33280
    s_waitcnt lgkmcnt(8)
    v_mfma_f32_32x32x16_bf16 a[64:79], v[224:227], a[160:163], a[64:79]
    ds_read_b64_tr_b16 v[220:221], v17 offset:36864
    v_mfma_f32_32x32x16_bf16 a[80:95], v[224:227], a[164:167], a[80:95]
    ds_read_b64_tr_b16 v[222:223], v17 offset:37376
    s_waitcnt lgkmcnt(8)
    v_mfma_f32_32x32x16_bf16 v[24:39], v[228:231], a[96:99], v[24:39]
    ds_read_b64_tr_b16 v[224:225], v17 offset:40960
    s_add_u32 s28, s27, 30720
    buffer_load_dwordx4 a[192:195], v1, s[8:11], s28 offen sc0 sc1
    v_mfma_f32_32x32x16_bf16 v[40:55], v[228:231], a[100:103], v[40:55]
    ds_read_b64_tr_b16 v[226:227], v17 offset:41472
    s_waitcnt lgkmcnt(8)
    v_mfma_f32_32x32x16_bf16 v[24:39], v[232:235], a[104:107], v[24:39]
    ds_read_b64_tr_b16 v[228:229], v17 offset:45056
    s_add_u32 s28, s27, 67584
    buffer_load_dwordx4 a[196:199], v1, s[8:11], s28 offen sc0 sc1
    v_mfma_f32_32x32x16_bf16 v[40:55], v[232:235], a[108:111], v[40:55]
    ds_read_b64_tr_b16 v[230:231], v17 offset:45568
    s_waitcnt lgkmcnt(8)
    v_mfma_f32_32x32x16_bf16 v[24:39], v[236:239], a[112:115], v[24:39]
    ds_read_b64_tr_b16 v[232:233], v17 offset:49152
    s_add_u32 m0, s25, 135168
    s_add_u32 s26, s31, 5160960
    buffer_load_dwordx4 v2, s[12:15], s26 offen lds
    v_mfma_f32_32x32x16_bf16 v[40:55], v[236:239], a[116:119], v[40:55]
    ds_read_b64_tr_b16 v[234:235], v17 offset:49664
    s_waitcnt lgkmcnt(8)
    v_mfma_f32_32x32x16_bf16 v[24:39], v[216:219], a[120:123], v[24:39]
    ds_read_b64_tr_b16 v[236:237], v17 offset:53248
    v_mfma_f32_32x32x16_bf16 v[40:55], v[216:219], a[124:127], v[40:55]
    ds_read_b64_tr_b16 v[238:239], v17 offset:53760
    s_waitcnt vmcnt(19)
    s_barrier
    s_waitcnt lgkmcnt(8)
    v_mfma_f32_32x32x16_bf16 v[24:39], v[220:223], a[128:131], v[24:39]
    ds_read_b64_tr_b16 v[216:217], v8 offset:57344
    s_add_u32 m0, s25, 139264
    s_add_u32 s26, s31, 3981440
    buffer_load_dwordx4 v2, s[12:15], s26 offen lds
    v_mfma_f32_32x32x16_bf16 v[40:55], v[220:223], a[132:135], v[40:55]
    ds_read_b64_tr_b16 v[218:219], v8 offset:57856
    s_waitcnt lgkmcnt(8)
    v_mfma_f32_32x32x16_bf16 v[24:39], v[224:227], a[136:139], v[24:39]
    ds_read_b64_tr_b16 v[220:221], v8 offset:61440
    v_mfma_f32_32x32x16_bf16 v[40:55], v[224:227], a[140:143], v[40:55]
    ds_read_b64_tr_b16 v[222:223], v8 offset:61952
    s_waitcnt lgkmcnt(8)
    v_mfma_f32_32x32x16_bf16 v[24:39], v[228:231], a[144:147], v[24:39]
    ds_read_b64_tr_b16 v[224:225], v9 offset:0
    s_add_u32 m0, s25, 143360
    s_add_u32 s26, s31, 4128896
    buffer_load_dwordx4 v2, s[12:15], s26 offen lds
    v_mfma_f32_32x32x16_bf16 v[40:55], v[228:231], a[148:151], v[40:55]
    ds_read_b64_tr_b16 v[226:227], v9 offset:512
    s_waitcnt lgkmcnt(8)
    v_mfma_f32_32x32x16_bf16 v[24:39], v[232:235], a[152:155], v[24:39]
    ds_read_b64_tr_b16 v[228:229], v9 offset:4096
    s_add_u32 s28, s27, 31744
    buffer_load_dwordx4 a[200:203], v1, s[8:11], s28 offen sc0 sc1
    v_mfma_f32_32x32x16_bf16 v[40:55], v[232:235], a[156:159], v[40:55]
    ds_read_b64_tr_b16 v[230:231], v9 offset:4608
    s_waitcnt lgkmcnt(8)
    v_mfma_f32_32x32x16_bf16 v[24:39], v[236:239], a[160:163], v[24:39]
    ds_read_b64_tr_b16 v[232:233], v9 offset:8192
    s_add_u32 s28, s27, 68608
    buffer_load_dwordx4 a[204:207], v1, s[8:11], s28 offen sc0 sc1
    v_mfma_f32_32x32x16_bf16 v[40:55], v[236:239], a[164:167], v[40:55]
    ds_read_b64_tr_b16 v[234:235], v9 offset:8704
    s_waitcnt lgkmcnt(8)
    v_mfma_f32_32x32x16_bf16 v[56:71], v[216:219], a[96:99], v[56:71]
    ds_read_b64_tr_b16 v[236:237], v9 offset:12288
    v_mfma_f32_32x32x16_bf16 v[72:87], v[216:219], a[100:103], v[72:87]
    ds_read_b64_tr_b16 v[238:239], v9 offset:12800
    s_waitcnt lgkmcnt(8)
    v_mfma_f32_32x32x16_bf16 v[56:71], v[220:223], a[104:107], v[56:71]
    ds_read_b64_tr_b16 v[216:217], v9 offset:16384
    s_add_u32 m0, s25, 0
    s_add_u32 s26, s31, 4276352
    buffer_load_dwordx4 v2, s[12:15], s26 offen lds
    v_mfma_f32_32x32x16_bf16 v[72:87], v[220:223], a[108:111], v[72:87]
    ds_read_b64_tr_b16 v[218:219], v9 offset:16896
    s_waitcnt lgkmcnt(8)
    v_mfma_f32_32x32x16_bf16 v[56:71], v[224:227], a[112:115], v[56:71]
    ds_read_b64_tr_b16 v[220:221], v9 offset:20480
    v_mfma_f32_32x32x16_bf16 v[72:87], v[224:227], a[116:119], v[72:87]
    ds_read_b64_tr_b16 v[222:223], v9 offset:20992
    s_waitcnt lgkmcnt(8)
    v_mfma_f32_32x32x16_bf16 v[56:71], v[228:231], a[120:123], v[56:71]
    ds_read_b64_tr_b16 v[224:225], v9 offset:24576
    s_add_u32 m0, s25, 4096
    s_add_u32 s26, s31, 4423808
    buffer_load_dwordx4 v2, s[12:15], s26 offen lds
    v_mfma_f32_32x32x16_bf16 v[72:87], v[228:231], a[124:127], v[72:87]
    ds_read_b64_tr_b16 v[226:227], v9 offset:25088
    s_waitcnt lgkmcnt(8)
    v_mfma_f32_32x32x16_bf16 v[56:71], v[232:235], a[128:131], v[56:71]
    ds_read_b64_tr_b16 v[228:229], v11 offset:57344
    v_mfma_f32_32x32x16_bf16 v[72:87], v[232:235], a[132:135], v[72:87]
    ds_read_b64_tr_b16 v[230:231], v11 offset:57856
    s_waitcnt lgkmcnt(8)
    v_mfma_f32_32x32x16_bf16 v[56:71], v[236:239], a[136:139], v[56:71]
    ds_read_b64_tr_b16 v[232:233], v11 offset:61440
    s_add_u32 s28, s27, 32768
    buffer_load_dwordx4 a[208:211], v1, s[8:11], s28 offen sc0 sc1
    v_mfma_f32_32x32x16_bf16 v[72:87], v[236:239], a[140:143], v[72:87]
    ds_read_b64_tr_b16 v[234:235], v11 offset:61952
    s_waitcnt lgkmcnt(8)
    v_mfma_f32_32x32x16_bf16 v[56:71], v[216:219], a[144:147], v[56:71]
    ds_read_b64_tr_b16 v[236:237], v12 offset:0
    s_add_u32 s28, s27, 69632
    buffer_load_dwordx4 a[212:215], v1, s[8:11], s28 offen sc0 sc1
    v_mfma_f32_32x32x16_bf16 v[72:87], v[216:219], a[148:151], v[72:87]
    ds_read_b64_tr_b16 v[238:239], v12 offset:512
    s_waitcnt lgkmcnt(8)
    v_mfma_f32_32x32x16_bf16 v[56:71], v[220:223], a[152:155], v[56:71]
    ds_read_b64_tr_b16 v[216:217], v12 offset:4096
    s_add_u32 m0, s25, 8192
    s_add_u32 s26, s31, 4571264
    buffer_load_dwordx4 v2, s[12:15], s26 offen lds
    v_mfma_f32_32x32x16_bf16 v[72:87], v[220:223], a[156:159], v[72:87]
    ds_read_b64_tr_b16 v[218:219], v12 offset:4608
    s_waitcnt lgkmcnt(8)
    v_mfma_f32_32x32x16_bf16 v[56:71], v[224:227], a[160:163], v[56:71]
    ds_read_b64_tr_b16 v[220:221], v12 offset:8192
    v_mfma_f32_32x32x16_bf16 v[72:87], v[224:227], a[164:167], v[72:87]
    ds_read_b64_tr_b16 v[222:223], v12 offset:8704
    s_waitcnt lgkmcnt(8)
    v_mfma_f32_32x32x16_bf16 v[88:103], v[228:231], a[96:99], v[88:103]
    ds_read_b64_tr_b16 v[224:225], v12 offset:12288
    s_add_u32 m0, s25, 12288
    s_add_u32 s26, s31, 4718720
    buffer_load_dwordx4 v2, s[12:15], s26 offen lds
    v_mfma_f32_32x32x16_bf16 v[104:119], v[228:231], a[100:103], v[104:119]
    ds_read_b64_tr_b16 v[226:227], v12 offset:12800
    s_waitcnt lgkmcnt(8)
    v_mfma_f32_32x32x16_bf16 v[88:103], v[232:235], a[104:107], v[88:103]
    ds_read_b64_tr_b16 v[228:229], v12 offset:16384
    v_mfma_f32_32x32x16_bf16 v[104:119], v[232:235], a[108:111], v[104:119]
    ds_read_b64_tr_b16 v[230:231], v12 offset:16896
    s_waitcnt lgkmcnt(8)
    v_mfma_f32_32x32x16_bf16 v[88:103], v[236:239], a[112:115], v[88:103]
    ds_read_b64_tr_b16 v[232:233], v12 offset:20480
    v_mfma_f32_32x32x16_bf16 v[104:119], v[236:239], a[116:119], v[104:119]
    ds_read_b64_tr_b16 v[234:235], v12 offset:20992
    s_waitcnt lgkmcnt(8)
    v_mfma_f32_32x32x16_bf16 v[88:103], v[216:219], a[120:123], v[88:103]
    ds_read_b64_tr_b16 v[236:237], v12 offset:24576
    s_add_u32 s28, s27, 33792
    buffer_load_dwordx4 a[216:219], v1, s[8:11], s28 offen sc0 sc1
    v_mfma_f32_32x32x16_bf16 v[104:119], v[216:219], a[124:127], v[104:119]
    ds_read_b64_tr_b16 v[238:239], v12 offset:25088
    s_waitcnt lgkmcnt(8)
    v_mfma_f32_32x32x16_bf16 v[88:103], v[220:223], a[128:131], v[88:103]
    ds_read_b64_tr_b16 v[216:217], v14 offset:57344
    s_add_u32 s28, s27, 70656
    buffer_load_dwordx4 a[220:223], v1, s[8:11], s28 offen sc0 sc1
    v_mfma_f32_32x32x16_bf16 v[104:119], v[220:223], a[132:135], v[104:119]
    ds_read_b64_tr_b16 v[218:219], v14 offset:57856
    s_waitcnt lgkmcnt(8)
    v_mfma_f32_32x32x16_bf16 v[88:103], v[224:227], a[136:139], v[88:103]
    ds_read_b64_tr_b16 v[220:221], v14 offset:61440
    v_mfma_f32_32x32x16_bf16 v[104:119], v[224:227], a[140:143], v[104:119]
    ds_read_b64_tr_b16 v[222:223], v14 offset:61952
    s_waitcnt lgkmcnt(8)
    v_mfma_f32_32x32x16_bf16 v[88:103], v[228:231], a[144:147], v[88:103]
    ds_read_b64_tr_b16 v[224:225], v15 offset:0
    v_mfma_f32_32x32x16_bf16 v[104:119], v[228:231], a[148:151], v[104:119]
    ds_read_b64_tr_b16 v[226:227], v15 offset:512
    s_waitcnt lgkmcnt(8)
    v_mfma_f32_32x32x16_bf16 v[88:103], v[232:235], a[152:155], v[88:103]
    ds_read_b64_tr_b16 v[228:229], v15 offset:4096
    v_mfma_f32_32x32x16_bf16 v[104:119], v[232:235], a[156:159], v[104:119]
    ds_read_b64_tr_b16 v[230:231], v15 offset:4608
    s_waitcnt lgkmcnt(8)
    v_mfma_f32_32x32x16_bf16 v[88:103], v[236:239], a[160:163], v[88:103]
    ds_read_b64_tr_b16 v[232:233], v15 offset:8192
    v_mfma_f32_32x32x16_bf16 v[104:119], v[236:239], a[164:167], v[104:119]
    ds_read_b64_tr_b16 v[234:235], v15 offset:8704
    s_waitcnt lgkmcnt(8)
    v_mfma_f32_32x32x16_bf16 v[120:135], v[216:219], a[96:99], v[120:135]
    ds_read_b64_tr_b16 v[236:237], v15 offset:12288
    v_mfma_f32_32x32x16_bf16 v[136:151], v[216:219], a[100:103], v[136:151]
    ds_read_b64_tr_b16 v[238:239], v15 offset:12800
    s_waitcnt lgkmcnt(8)
    v_mfma_f32_32x32x16_bf16 v[120:135], v[220:223], a[104:107], v[120:135]
    ds_read_b64_tr_b16 v[216:217], v15 offset:16384
    s_add_u32 s28, s27, 34816
    buffer_load_dwordx4 a[224:227], v1, s[8:11], s28 offen sc0 sc1
    v_mfma_f32_32x32x16_bf16 v[136:151], v[220:223], a[108:111], v[136:151]
    ds_read_b64_tr_b16 v[218:219], v15 offset:16896
    s_waitcnt lgkmcnt(8)
    v_mfma_f32_32x32x16_bf16 v[120:135], v[224:227], a[112:115], v[120:135]
    ds_read_b64_tr_b16 v[220:221], v15 offset:20480
    s_add_u32 s28, s27, 71680
    buffer_load_dwordx4 a[228:231], v1, s[8:11], s28 offen sc0 sc1
    v_mfma_f32_32x32x16_bf16 v[136:151], v[224:227], a[116:119], v[136:151]
    ds_read_b64_tr_b16 v[222:223], v15 offset:20992
    s_waitcnt lgkmcnt(8)
    v_mfma_f32_32x32x16_bf16 v[120:135], v[228:231], a[120:123], v[120:135]
    ds_read_b64_tr_b16 v[224:225], v15 offset:24576
    v_mfma_f32_32x32x16_bf16 v[136:151], v[228:231], a[124:127], v[136:151]
    ds_read_b64_tr_b16 v[226:227], v15 offset:25088
    s_waitcnt lgkmcnt(8)
    v_mfma_f32_32x32x16_bf16 v[120:135], v[232:235], a[128:131], v[120:135]
    ds_read_b64_tr_b16 v[228:229], v17 offset:57344
    v_mfma_f32_32x32x16_bf16 v[136:151], v[232:235], a[132:135], v[136:151]
    ds_read_b64_tr_b16 v[230:231], v17 offset:57856
    s_waitcnt lgkmcnt(8)
    v_mfma_f32_32x32x16_bf16 v[120:135], v[236:239], a[136:139], v[120:135]
    ds_read_b64_tr_b16 v[232:233], v17 offset:61440
    v_mfma_f32_32x32x16_bf16 v[136:151], v[236:239], a[140:143], v[136:151]
    ds_read_b64_tr_b16 v[234:235], v17 offset:61952
    s_waitcnt lgkmcnt(8)
    v_mfma_f32_32x32x16_bf16 v[120:135], v[216:219], a[144:147], v[120:135]
    ds_read_b64_tr_b16 v[236:237], v18 offset:0
    v_mfma_f32_32x32x16_bf16 v[136:151], v[216:219], a[148:151], v[136:151]
    ds_read_b64_tr_b16 v[238:239], v18 offset:512
    s_waitcnt lgkmcnt(8)
    v_mfma_f32_32x32x16_bf16 v[120:135], v[220:223], a[152:155], v[120:135]
    ds_read_b64_tr_b16 v[216:217], v18 offset:4096
    v_mfma_f32_32x32x16_bf16 v[136:151], v[220:223], a[156:159], v[136:151]
    ds_read_b64_tr_b16 v[218:219], v18 offset:4608
    s_waitcnt lgkmcnt(8)
    v_mfma_f32_32x32x16_bf16 v[120:135], v[224:227], a[160:163], v[120:135]
    ds_read_b64_tr_b16 v[220:221], v18 offset:8192
    s_add_u32 s28, s27, 35840
    buffer_load_dwordx4 a[232:235], v1, s[8:11], s28 offen sc0 sc1
    v_mfma_f32_32x32x16_bf16 v[136:151], v[224:227], a[164:167], v[136:151]
    ds_read_b64_tr_b16 v[222:223], v18 offset:8704
    s_waitcnt lgkmcnt(8)
    v_mfma_f32_32x32x16_bf16 v[152:167], v[228:231], a[96:99], v[152:167]
    ds_read_b64_tr_b16 v[224:225], v18 offset:12288
    s_add_u32 s28, s27, 72704
    buffer_load_dwordx4 a[236:239], v1, s[8:11], s28 offen sc0 sc1
    v_mfma_f32_32x32x16_bf16 v[168:183], v[228:231], a[100:103], v[168:183]
    ds_read_b64_tr_b16 v[226:227], v18 offset:12800
    s_waitcnt lgkmcnt(8)
    v_mfma_f32_32x32x16_bf16 v[152:167], v[232:235], a[104:107], v[152:167]
    ds_read_b64_tr_b16 v[228:229], v18 offset:16384
    v_mfma_f32_32x32x16_bf16 v[168:183], v[232:235], a[108:111], v[168:183]
    ds_read_b64_tr_b16 v[230:231], v18 offset:16896
    s_waitcnt lgkmcnt(8)
    v_mfma_f32_32x32x16_bf16 v[152:167], v[236:239], a[112:115], v[152:167]
    ds_read_b64_tr_b16 v[232:233], v18 offset:20480
    v_mfma_f32_32x32x16_bf16 v[168:183], v[236:239], a[116:119], v[168:183]
    ds_read_b64_tr_b16 v[234:235], v18 offset:20992
    s_waitcnt lgkmcnt(8)
    v_mfma_f32_32x32x16_bf16 v[152:167], v[216:219], a[120:123], v[152:167]
    ds_read_b64_tr_b16 v[236:237], v18 offset:24576
    v_mfma_f32_32x32x16_bf16 v[168:183], v[216:219], a[124:127], v[168:183]
    ds_read_b64_tr_b16 v[238:239], v18 offset:25088
    s_waitcnt vmcnt(33)
    s_barrier
    s_waitcnt lgkmcnt(8)
    v_mfma_f32_32x32x16_bf16 v[152:167], v[220:223], a[128:131], v[152:167]
    ds_read_b64_tr_b16 v[216:217], v20 offset:17408
    v_mfma_f32_32x32x16_bf16 v[168:183], v[220:223], a[132:135], v[168:183]
    ds_read_b64_tr_b16 v[218:219], v20 offset:17536
    s_waitcnt lgkmcnt(8)
    v_mfma_f32_32x32x16_bf16 v[152:167], v[224:227], a[136:139], v[152:167]
    ds_read_b64_tr_b16 v[220:221], v20 offset:17920
    v_mfma_f32_32x32x16_bf16 v[168:183], v[224:227], a[140:143], v[168:183]
    ds_read_b64_tr_b16 v[222:223], v20 offset:18048
    s_waitcnt lgkmcnt(8)
    v_mfma_f32_32x32x16_bf16 v[152:167], v[228:231], a[144:147], v[152:167]
    ds_read_b64_tr_b16 v[224:225], v21 offset:28672
    v_mfma_f32_32x32x16_bf16 v[168:183], v[228:231], a[148:151], v[168:183]
    ds_read_b64_tr_b16 v[226:227], v21 offset:28800
    s_waitcnt lgkmcnt(8)
    v_mfma_f32_32x32x16_bf16 v[152:167], v[232:235], a[152:155], v[152:167]
    ds_read_b64_tr_b16 v[228:229], v21 offset:29184
    v_mfma_f32_32x32x16_bf16 v[168:183], v[232:235], a[156:159], v[168:183]
    ds_read_b64_tr_b16 v[230:231], v21 offset:29312
    s_waitcnt lgkmcnt(8)
    v_mfma_f32_32x32x16_bf16 v[152:167], v[236:239], a[160:163], v[152:167]
    ds_read_b64_tr_b16 v[232:233], v21 offset:29696
    v_mfma_f32_32x32x16_bf16 v[168:183], v[236:239], a[164:167], v[168:183]
    ds_read_b64_tr_b16 v[234:235], v21 offset:29824
    s_waitcnt lgkmcnt(8)
    v_mfma_f32_32x32x16_bf16 v[184:199], v[216:219], a[96:99], v[184:199]
    ds_read_b64_tr_b16 v[236:237], v21 offset:30208
    v_mfma_f32_32x32x16_bf16 v[200:215], v[216:219], a[100:103], v[200:215]
    ds_read_b64_tr_b16 v[238:239], v21 offset:30336
    s_waitcnt lgkmcnt(8)
    v_mfma_f32_32x32x16_bf16 v[184:199], v[220:223], a[104:107], v[184:199]
    ds_read_b64_tr_b16 v[216:217], v21 offset:32768
    v_mfma_f32_32x32x16_bf16 v[200:215], v[220:223], a[108:111], v[200:215]
    ds_read_b64_tr_b16 v[218:219], v21 offset:32896
    s_waitcnt lgkmcnt(8)
    v_mfma_f32_32x32x16_bf16 v[184:199], v[224:227], a[112:115], v[184:199]
    ds_read_b64_tr_b16 v[220:221], v21 offset:33280
    v_mfma_f32_32x32x16_bf16 v[200:215], v[224:227], a[116:119], v[200:215]
    ds_read_b64_tr_b16 v[222:223], v21 offset:33408
    s_waitcnt lgkmcnt(8)
    v_mfma_f32_32x32x16_bf16 v[184:199], v[228:231], a[120:123], v[184:199]
    ds_read_b64_tr_b16 v[224:225], v21 offset:33792
    v_mfma_f32_32x32x16_bf16 v[200:215], v[228:231], a[124:127], v[200:215]
    ds_read_b64_tr_b16 v[226:227], v21 offset:33920
    s_waitcnt vmcnt(16)
    s_barrier
    s_waitcnt lgkmcnt(8)
    v_mfma_f32_32x32x16_bf16 v[184:199], v[232:235], a[128:131], v[184:199]
    ds_read_b64_tr_b16 v[228:229], v9 offset:36864
    v_mfma_f32_32x32x16_bf16 v[200:215], v[232:235], a[132:135], v[200:215]
    ds_read_b64_tr_b16 v[230:231], v9 offset:37376
    s_waitcnt lgkmcnt(8)
    v_mfma_f32_32x32x16_bf16 v[184:199], v[236:239], a[136:139], v[184:199]
    ds_read_b64_tr_b16 v[232:233], v9 offset:40960
    s_add_u32 m0, s25, 16384
    s_add_u32 s26, s31, 4866176
    buffer_load_dwordx4 v2, s[12:15], s26 offen lds
    v_mfma_f32_32x32x16_bf16 v[200:215], v[236:239], a[140:143], v[200:215]
    ds_read_b64_tr_b16 v[234:235], v9 offset:41472
    s_waitcnt lgkmcnt(8)
    v_mfma_f32_32x32x16_bf16 v[184:199], v[216:219], a[144:147], v[184:199]
    ds_read_b64_tr_b16 v[236:237], v9 offset:45056
    v_mfma_f32_32x32x16_bf16 v[200:215], v[216:219], a[148:151], v[200:215]
    ds_read_b64_tr_b16 v[238:239], v9 offset:45568
    s_waitcnt lgkmcnt(8)
    v_mfma_f32_32x32x16_bf16 v[184:199], v[220:223], a[152:155], v[184:199]
    ds_read_b64_tr_b16 v[216:217], v9 offset:49152
    s_add_u32 m0, s25, 20480
    s_add_u32 s26, s31, 5013632
    buffer_load_dwordx4 v2, s[12:15], s26 offen lds
    v_mfma_f32_32x32x16_bf16 v[200:215], v[220:223], a[156:159], v[200:215]
    ds_read_b64_tr_b16 v[218:219], v9 offset:49664
    s_waitcnt lgkmcnt(8)
    v_mfma_f32_32x32x16_bf16 v[184:199], v[224:227], a[160:163], v[184:199]
    ds_read_b64_tr_b16 v[220:221], v9 offset:53248
    v_mfma_f32_32x32x16_bf16 v[200:215], v[224:227], a[164:167], v[200:215]
    ds_read_b64_tr_b16 v[222:223], v9 offset:53760
    s_waitcnt lgkmcnt(8)
    v_mfma_f32_32x32x16_bf16 a[0:15], v[228:231], a[168:171], a[0:15]
    ds_read_b64_tr_b16 v[224:225], v9 offset:57344
    s_add_u32 m0, s25, 24576
    s_add_u32 s26, s31, 5161088
    buffer_load_dwordx4 v2, s[12:15], s26 offen lds
    v_mfma_f32_32x32x16_bf16 a[16:31], v[228:231], a[172:175], a[16:31]
    ds_read_b64_tr_b16 v[226:227], v9 offset:57856
    s_waitcnt lgkmcnt(8)
    v_mfma_f32_32x32x16_bf16 a[0:15], v[232:235], a[176:179], a[0:15]
    ds_read_b64_tr_b16 v[228:229], v9 offset:61440
    v_mfma_f32_32x32x16_bf16 a[16:31], v[232:235], a[180:183], a[16:31]
    ds_read_b64_tr_b16 v[230:231], v9 offset:61952
    s_waitcnt lgkmcnt(8)
    v_mfma_f32_32x32x16_bf16 a[0:15], v[236:239], a[184:187], a[0:15]
    ds_read_b64_tr_b16 v[232:233], v10 offset:0
    s_add_u32 m0, s25, 28672
    s_add_u32 s26, s32, 4128768
    buffer_load_dwordx4 v3, s[12:15], s26 offen lds
    v_mfma_f32_32x32x16_bf16 a[16:31], v[236:239], a[188:191], a[16:31]
    ds_read_b64_tr_b16 v[234:235], v10 offset:512
    s_waitcnt lgkmcnt(8)
    v_mfma_f32_32x32x16_bf16 a[0:15], v[216:219], a[192:195], a[0:15]
    ds_read_b64_tr_b16 v[236:237], v10 offset:4096
    v_mfma_f32_32x32x16_bf16 a[16:31], v[216:219], a[196:199], a[16:31]
    ds_read_b64_tr_b16 v[238:239], v10 offset:4608
    s_waitcnt vmcnt(16)
    s_waitcnt lgkmcnt(8)
    v_mfma_f32_32x32x16_bf16 a[0:15], v[220:223], a[200:203], a[0:15]
    ds_read_b64_tr_b16 v[216:217], v12 offset:36864
    s_add_u32 m0, s25, 32768
    s_add_u32 s26, s32, 4718592
    buffer_load_dwordx4 v3, s[12:15], s26 offen lds
    v_mfma_f32_32x32x16_bf16 a[16:31], v[220:223], a[204:207], a[16:31]
    ds_read_b64_tr_b16 v[218:219], v12 offset:37376
    s_waitcnt vmcnt(13)
    s_waitcnt lgkmcnt(8)
    v_mfma_f32_32x32x16_bf16 a[0:15], v[224:227], a[208:211], a[0:15]
    ds_read_b64_tr_b16 v[220:221], v12 offset:40960
    v_mfma_f32_32x32x16_bf16 a[16:31], v[224:227], a[212:215], a[16:31]
    ds_read_b64_tr_b16 v[222:223], v12 offset:41472
    s_waitcnt vmcnt(9)
    s_waitcnt lgkmcnt(8)
    v_mfma_f32_32x32x16_bf16 a[0:15], v[228:231], a[216:219], a[0:15]
    ds_read_b64_tr_b16 v[224:225], v12 offset:45056
    v_mfma_f32_32x32x16_bf16 a[16:31], v[228:231], a[220:223], a[16:31]
    ds_read_b64_tr_b16 v[226:227], v12 offset:45568
    s_waitcnt vmcnt(7)
    s_waitcnt lgkmcnt(8)
    v_mfma_f32_32x32x16_bf16 a[0:15], v[232:235], a[224:227], a[0:15]
    ds_read_b64_tr_b16 v[228:229], v12 offset:49152
    v_mfma_f32_32x32x16_bf16 a[16:31], v[232:235], a[228:231], a[16:31]
    ds_read_b64_tr_b16 v[230:231], v12 offset:49664
    s_waitcnt vmcnt(5)
    s_waitcnt lgkmcnt(8)
    v_mfma_f32_32x32x16_bf16 a[0:15], v[236:239], a[232:235], a[0:15]
    ds_read_b64_tr_b16 v[232:233], v12 offset:53248
    v_mfma_f32_32x32x16_bf16 a[16:31], v[236:239], a[236:239], a[16:31]
    ds_read_b64_tr_b16 v[234:235], v12 offset:53760
    s_waitcnt lgkmcnt(8)
    v_mfma_f32_32x32x16_bf16 a[32:47], v[216:219], a[168:171], a[32:47]
    ds_read_b64_tr_b16 v[236:237], v12 offset:57344
    v_mfma_f32_32x32x16_bf16 a[48:63], v[216:219], a[172:175], a[48:63]
    ds_read_b64_tr_b16 v[238:239], v12 offset:57856
    s_waitcnt lgkmcnt(8)
    v_mfma_f32_32x32x16_bf16 a[32:47], v[220:223], a[176:179], a[32:47]
    ds_read_b64_tr_b16 v[216:217], v12 offset:61440
    s_nop 0
    v_accvgpr_read_b32 v248, a0
    v_accvgpr_read_b32 v249, a8
    v_cvt_pk_bf16_f32 v248, 0, v248
    v_cvt_pk_bf16_f32 v249, 0, v249
    v_mul_f32 v248, v248, v249
    v_mfma_f32_32x32x16_bf16 a[48:63], v[220:223], a[180:183], a[48:63]
    ds_read_b64_tr_b16 v[218:219], v12 offset:61952
    v_accvgpr_read_b32 v250, a1
    v_accvgpr_read_b32 v251, a9
    v_cvt_pk_bf16_f32 v250, 0, v250
    v_cvt_pk_bf16_f32 v251, 0, v251
    v_mul_f32 v250, v250, v251
    s_waitcnt lgkmcnt(8)
    v_mfma_f32_32x32x16_bf16 a[32:47], v[224:227], a[184:187], a[32:47]
    ds_read_b64_tr_b16 v[220:221], v13 offset:0
    v_cvt_pk_bf16_f32 v240, v248, v250
    v_accvgpr_read_b32 v248, a2
    v_accvgpr_read_b32 v249, a10
    v_cvt_pk_bf16_f32 v248, 0, v248
    v_cvt_pk_bf16_f32 v249, 0, v249
    v_mfma_f32_32x32x16_bf16 a[48:63], v[224:227], a[188:191], a[48:63]
    ds_read_b64_tr_b16 v[222:223], v13 offset:512
    v_mul_f32 v248, v248, v249
    v_accvgpr_read_b32 v250, a3
    v_accvgpr_read_b32 v251, a11
    v_cvt_pk_bf16_f32 v250, 0, v250
    v_cvt_pk_bf16_f32 v251, 0, v251
    s_waitcnt lgkmcnt(8)
    v_mfma_f32_32x32x16_bf16 a[32:47], v[228:231], a[192:195], a[32:47]
    ds_read_b64_tr_b16 v[224:225], v13 offset:4096
    v_mul_f32 v250, v250, v251
    v_cvt_pk_bf16_f32 v241, v248, v250
    v_accvgpr_read_b32 v248, a4
    v_accvgpr_read_b32 v249, a12
    v_cvt_pk_bf16_f32 v248, 0, v248
    v_mfma_f32_32x32x16_bf16 a[48:63], v[228:231], a[196:199], a[48:63]
    ds_read_b64_tr_b16 v[226:227], v13 offset:4608
    v_cvt_pk_bf16_f32 v249, 0, v249
    v_mul_f32 v248, v248, v249
    v_accvgpr_read_b32 v250, a5
    v_accvgpr_read_b32 v251, a13
    v_cvt_pk_bf16_f32 v250, 0, v250
    s_waitcnt lgkmcnt(8)
    v_mfma_f32_32x32x16_bf16 a[32:47], v[232:235], a[200:203], a[32:47]
    ds_read_b64_tr_b16 v[228:229], v15 offset:36864
    v_cvt_pk_bf16_f32 v251, 0, v251
    v_mul_f32 v250, v250, v251
    v_cvt_pk_bf16_f32 v242, v248, v250
    v_accvgpr_read_b32 v248, a6
    v_accvgpr_read_b32 v249, a14
    v_mfma_f32_32x32x16_bf16 a[48:63], v[232:235], a[204:207], a[48:63]
    ds_read_b64_tr_b16 v[230:231], v15 offset:37376
    v_cvt_pk_bf16_f32 v248, 0, v248
    v_cvt_pk_bf16_f32 v249, 0, v249
    v_mul_f32 v248, v248, v249
    v_accvgpr_read_b32 v250, a7
    v_accvgpr_read_b32 v251, a15
    s_waitcnt lgkmcnt(8)
    v_mfma_f32_32x32x16_bf16 a[32:47], v[236:239], a[208:211], a[32:47]
    ds_read_b64_tr_b16 v[232:233], v15 offset:40960
    v_cvt_pk_bf16_f32 v250, 0, v250
    v_cvt_pk_bf16_f32 v251, 0, v251
    v_mul_f32 v250, v250, v251
    v_cvt_pk_bf16_f32 v243, v248, v250
    s_add_u32 s30, s33, 0
    v_mfma_f32_32x32x16_bf16 a[48:63], v[236:239], a[212:215], a[48:63]
    ds_read_b64_tr_b16 v[234:235], v15 offset:41472
    buffer_store_dwordx4 v[240:243], v1, s[16:19], s30 offen sc0 sc1
    v_accvgpr_read_b32 v248, a16
    v_accvgpr_read_b32 v249, a24
    v_cvt_pk_bf16_f32 v248, 0, v248
    v_cvt_pk_bf16_f32 v249, 0, v249
    s_waitcnt lgkmcnt(8)
    v_mfma_f32_32x32x16_bf16 a[32:47], v[216:219], a[216:219], a[32:47]
    ds_read_b64_tr_b16 v[236:237], v15 offset:45056
    v_mul_f32 v248, v248, v249
    v_accvgpr_read_b32 v250, a17
    v_accvgpr_read_b32 v251, a25
    v_cvt_pk_bf16_f32 v250, 0, v250
    v_cvt_pk_bf16_f32 v251, 0, v251
    v_mfma_f32_32x32x16_bf16 a[48:63], v[216:219], a[220:223], a[48:63]
    ds_read_b64_tr_b16 v[238:239], v15 offset:45568
    v_mul_f32 v250, v250, v251
    v_cvt_pk_bf16_f32 v244, v248, v250
    v_accvgpr_read_b32 v248, a18
    v_accvgpr_read_b32 v249, a26
    v_cvt_pk_bf16_f32 v248, 0, v248
    s_waitcnt lgkmcnt(8)
    v_mfma_f32_32x32x16_bf16 a[32:47], v[220:223], a[224:227], a[32:47]
    ds_read_b64_tr_b16 v[216:217], v15 offset:49152
    v_cvt_pk_bf16_f32 v249, 0, v249
    v_mul_f32 v248, v248, v249
    v_accvgpr_read_b32 v250, a19
    v_accvgpr_read_b32 v251, a27
    v_cvt_pk_bf16_f32 v250, 0, v250
    v_mfma_f32_32x32x16_bf16 a[48:63], v[220:223], a[228:231], a[48:63]
    ds_read_b64_tr_b16 v[218:219], v15 offset:49664
    v_cvt_pk_bf16_f32 v251, 0, v251
    v_mul_f32 v250, v250, v251
    v_cvt_pk_bf16_f32 v245, v248, v250
    v_accvgpr_read_b32 v248, a20
    v_accvgpr_read_b32 v249, a28
    s_waitcnt lgkmcnt(8)
    v_mfma_f32_32x32x16_bf16 a[32:47], v[224:227], a[232:235], a[32:47]
    ds_read_b64_tr_b16 v[220:221], v15 offset:53248
    v_cvt_pk_bf16_f32 v248, 0, v248
    v_cvt_pk_bf16_f32 v249, 0, v249
    v_mul_f32 v248, v248, v249
    v_accvgpr_read_b32 v250, a21
    v_accvgpr_read_b32 v251, a29
    v_mfma_f32_32x32x16_bf16 a[48:63], v[224:227], a[236:239], a[48:63]
    ds_read_b64_tr_b16 v[222:223], v15 offset:53760
    v_cvt_pk_bf16_f32 v250, 0, v250
    v_cvt_pk_bf16_f32 v251, 0, v251
    v_mul_f32 v250, v250, v251
    v_cvt_pk_bf16_f32 v246, v248, v250
    v_accvgpr_read_b32 v248, a22
    s_waitcnt lgkmcnt(8)
    v_mfma_f32_32x32x16_bf16 a[64:79], v[228:231], a[168:171], a[64:79]
    ds_read_b64_tr_b16 v[224:225], v15 offset:57344
    v_mfma_f32_32x32x16_bf16 a[80:95], v[228:231], a[172:175], a[80:95]
    ds_read_b64_tr_b16 v[226:227], v15 offset:57856
    s_waitcnt lgkmcnt(8)
    v_mfma_f32_32x32x16_bf16 a[64:79], v[232:235], a[176:179], a[64:79]
    ds_read_b64_tr_b16 v[228:229], v15 offset:61440
    v_accvgpr_read_b32 v249, a30
    v_cvt_pk_bf16_f32 v248, 0, v248
    v_cvt_pk_bf16_f32 v249, 0, v249
    v_mul_f32 v248, v248, v249
    v_accvgpr_read_b32 v250, a23
    v_mfma_f32_32x32x16_bf16 a[80:95], v[232:235], a[180:183], a[80:95]
    ds_read_b64_tr_b16 v[230:231], v15 offset:61952
    v_accvgpr_read_b32 v251, a31
    v_cvt_pk_bf16_f32 v250, 0, v250
    v_cvt_pk_bf16_f32 v251, 0, v251
    v_mul_f32 v250, v250, v251
    v_cvt_pk_bf16_f32 v247, v248, v250
    s_waitcnt lgkmcnt(8)
    v_mfma_f32_32x32x16_bf16 a[64:79], v[236:239], a[184:187], a[64:79]
    ds_read_b64_tr_b16 v[232:233], v16 offset:0
    s_add_u32 s30, s33, 294912
    buffer_store_dwordx4 v[244:247], v1, s[16:19], s30 offen sc0 sc1
    v_accvgpr_read_b32 v248, a32
    v_accvgpr_read_b32 v249, a40
    v_cvt_pk_bf16_f32 v248, 0, v248
    v_mfma_f32_32x32x16_bf16 a[80:95], v[236:239], a[188:191], a[80:95]
    ds_read_b64_tr_b16 v[234:235], v16 offset:512
    v_cvt_pk_bf16_f32 v249, 0, v249
    v_mul_f32 v248, v248, v249
    v_accvgpr_read_b32 v250, a33
    v_accvgpr_read_b32 v251, a41
    v_cvt_pk_bf16_f32 v250, 0, v250
    s_waitcnt lgkmcnt(8)
    v_mfma_f32_32x32x16_bf16 a[64:79], v[216:219], a[192:195], a[64:79]
    ds_read_b64_tr_b16 v[236:237], v16 offset:4096
    v_cvt_pk_bf16_f32 v251, 0, v251
    v_mul_f32 v250, v250, v251
    v_cvt_pk_bf16_f32 v240, v248, v250
    v_accvgpr_read_b32 v248, a34
    v_accvgpr_read_b32 v249, a42
    v_mfma_f32_32x32x16_bf16 a[80:95], v[216:219], a[196:199], a[80:95]
    ds_read_b64_tr_b16 v[238:239], v16 offset:4608
    v_cvt_pk_bf16_f32 v248, 0, v248
    v_cvt_pk_bf16_f32 v249, 0, v249
    v_mul_f32 v248, v248, v249
    v_accvgpr_read_b32 v250, a35
    v_accvgpr_read_b32 v251, a43
    s_waitcnt lgkmcnt(8)
    v_mfma_f32_32x32x16_bf16 a[64:79], v[220:223], a[200:203], a[64:79]
    ds_read_b64_tr_b16 v[216:217], v18 offset:36864
    v_cvt_pk_bf16_f32 v250, 0, v250
    v_cvt_pk_bf16_f32 v251, 0, v251
    v_mul_f32 v250, v250, v251
    v_cvt_pk_bf16_f32 v241, v248, v250
    v_accvgpr_read_b32 v248, a36
    v_mfma_f32_32x32x16_bf16 a[80:95], v[220:223], a[204:207], a[80:95]
    ds_read_b64_tr_b16 v[218:219], v18 offset:37376
    v_accvgpr_read_b32 v249, a44
    v_cvt_pk_bf16_f32 v248, 0, v248
    v_cvt_pk_bf16_f32 v249, 0, v249
    v_mul_f32 v248, v248, v249
    v_accvgpr_read_b32 v250, a37
    s_waitcnt lgkmcnt(8)
    v_mfma_f32_32x32x16_bf16 a[64:79], v[224:227], a[208:211], a[64:79]
    ds_read_b64_tr_b16 v[220:221], v18 offset:40960
    v_accvgpr_read_b32 v251, a45
    v_cvt_pk_bf16_f32 v250, 0, v250
    v_cvt_pk_bf16_f32 v251, 0, v251
    v_mul_f32 v250, v250, v251
    v_cvt_pk_bf16_f32 v242, v248, v250
    v_mfma_f32_32x32x16_bf16 a[80:95], v[224:227], a[212:215], a[80:95]
    ds_read_b64_tr_b16 v[222:223], v18 offset:41472
    v_accvgpr_read_b32 v248, a38
    v_accvgpr_read_b32 v249, a46
    v_cvt_pk_bf16_f32 v248, 0, v248
    v_cvt_pk_bf16_f32 v249, 0, v249
    v_mul_f32 v248, v248, v249
    s_waitcnt lgkmcnt(8)
    v_mfma_f32_32x32x16_bf16 a[64:79], v[228:231], a[216:219], a[64:79]
    ds_read_b64_tr_b16 v[224:225], v18 offset:45056
    v_accvgpr_read_b32 v250, a39
    v_accvgpr_read_b32 v251, a47
    v_cvt_pk_bf16_f32 v250, 0, v250
    v_cvt_pk_bf16_f32 v251, 0, v251
    v_mul_f32 v250, v250, v251
    v_mfma_f32_32x32x16_bf16 a[80:95], v[228:231], a[220:223], a[80:95]
    ds_read_b64_tr_b16 v[226:227], v18 offset:45568
    v_cvt_pk_bf16_f32 v243, v248, v250
    s_add_u32 s30, s33, 1024
    buffer_store_dwordx4 v[240:243], v1, s[16:19], s30 offen sc0 sc1
    v_accvgpr_read_b32 v248, a48
    v_accvgpr_read_b32 v249, a56
    s_waitcnt lgkmcnt(8)
    v_mfma_f32_32x32x16_bf16 a[64:79], v[232:235], a[224:227], a[64:79]
    ds_read_b64_tr_b16 v[228:229], v18 offset:49152
    v_cvt_pk_bf16_f32 v248, 0, v248
    v_cvt_pk_bf16_f32 v249, 0, v249
    v_mul_f32 v248, v248, v249
    v_accvgpr_read_b32 v250, a49
    v_accvgpr_read_b32 v251, a57
    v_mfma_f32_32x32x16_bf16 a[80:95], v[232:235], a[228:231], a[80:95]
    ds_read_b64_tr_b16 v[230:231], v18 offset:49664
    v_cvt_pk_bf16_f32 v250, 0, v250
    v_cvt_pk_bf16_f32 v251, 0, v251
    v_mul_f32 v250, v250, v251
    v_cvt_pk_bf16_f32 v244, v248, v250
    v_accvgpr_read_b32 v248, a50
    s_waitcnt lgkmcnt(8)
    v_mfma_f32_32x32x16_bf16 a[64:79], v[236:239], a[232:235], a[64:79]
    ds_read_b64_tr_b16 v[232:233], v18 offset:53248
    v_accvgpr_read_b32 v249, a58
    v_cvt_pk_bf16_f32 v248, 0, v248
    v_cvt_pk_bf16_f32 v249, 0, v249
    v_mul_f32 v248, v248, v249
    v_accvgpr_read_b32 v250, a51
    v_mfma_f32_32x32x16_bf16 a[80:95], v[236:239], a[236:239], a[80:95]
    ds_read_b64_tr_b16 v[234:235], v18 offset:53760
    v_accvgpr_read_b32 v251, a59
    v_cvt_pk_bf16_f32 v250, 0, v250
    v_cvt_pk_bf16_f32 v251, 0, v251
    v_mul_f32 v250, v250, v251
    v_cvt_pk_bf16_f32 v245, v248, v250
    s_waitcnt lgkmcnt(8)
    v_mfma_f32_32x32x16_bf16 v[24:39], v[216:219], a[168:171], v[24:39]
    ds_read_b64_tr_b16 v[236:237], v18 offset:57344
    v_mfma_f32_32x32x16_bf16 v[40:55], v[216:219], a[172:175], v[40:55]
    ds_read_b64_tr_b16 v[238:239], v18 offset:57856
    s_waitcnt lgkmcnt(8)
    v_mfma_f32_32x32x16_bf16 v[24:39], v[220:223], a[176:179], v[24:39]
    ds_read_b64_tr_b16 v[216:217], v18 offset:61440
    v_accvgpr_read_b32 v248, a52
    v_accvgpr_read_b32 v249, a60
    v_cvt_pk_bf16_f32 v248, 0, v248
    v_cvt_pk_bf16_f32 v249, 0, v249
    v_mul_f32 v248, v248, v249
    v_mfma_f32_32x32x16_bf16 v[40:55], v[220:223], a[180:183], v[40:55]
    ds_read_b64_tr_b16 v[218:219], v18 offset:61952
    v_accvgpr_read_b32 v250, a53
    v_accvgpr_read_b32 v251, a61
    v_cvt_pk_bf16_f32 v250, 0, v250
    v_cvt_pk_bf16_f32 v251, 0, v251
    v_mul_f32 v250, v250, v251
    s_waitcnt lgkmcnt(8)
    v_mfma_f32_32x32x16_bf16 v[24:39], v[224:227], a[184:187], v[24:39]
    ds_read_b64_tr_b16 v[220:221], v19 offset:0
    v_cvt_pk_bf16_f32 v246, v248, v250
    v_accvgpr_read_b32 v248, a54
    v_accvgpr_read_b32 v249, a62
    v_cvt_pk_bf16_f32 v248, 0, v248
    v_cvt_pk_bf16_f32 v249, 0, v249
    v_mfma_f32_32x32x16_bf16 v[40:55], v[224:227], a[188:191], v[40:55]
    ds_read_b64_tr_b16 v[222:223], v19 offset:512
    v_mul_f32 v248, v248, v249
    v_accvgpr_read_b32 v250, a55
    v_accvgpr_read_b32 v251, a63
    v_cvt_pk_bf16_f32 v250, 0, v250
    v_cvt_pk_bf16_f32 v251, 0, v251
    s_waitcnt lgkmcnt(8)
    v_mfma_f32_32x32x16_bf16 v[24:39], v[228:231], a[192:195], v[24:39]
    ds_read_b64_tr_b16 v[224:225], v19 offset:4096
    v_mul_f32 v250, v250, v251
    v_cvt_pk_bf16_f32 v247, v248, v250
    s_add_u32 s30, s33, 295936
    buffer_store_dwordx4 v[244:247], v1, s[16:19], s30 offen sc0 sc1
    v_accvgpr_read_b32 v248, a64
    v_mfma_f32_32x32x16_bf16 v[40:55], v[228:231], a[196:199], v[40:55]
    ds_read_b64_tr_b16 v[226:227], v19 offset:4608
    v_accvgpr_read_b32 v249, a72
    v_cvt_pk_bf16_f32 v248, 0, v248
    v_cvt_pk_bf16_f32 v249, 0, v249
    v_mul_f32 v248, v248, v249
    v_accvgpr_read_b32 v250, a65
    s_waitcnt vmcnt(6)
    s_barrier
    s_waitcnt lgkmcnt(8)
    v_mfma_f32_32x32x16_bf16 v[24:39], v[232:235], a[200:203], v[24:39]
    ds_read_b64_tr_b16 v[228:229], v10 offset:8192
    v_accvgpr_read_b32 v251, a73
    v_cvt_pk_bf16_f32 v250, 0, v250
    v_cvt_pk_bf16_f32 v251, 0, v251
    v_mul_f32 v250, v250, v251
    v_cvt_pk_bf16_f32 v240, v248, v250
    v_mfma_f32_32x32x16_bf16 v[40:55], v[232:235], a[204:207], v[40:55]
    ds_read_b64_tr_b16 v[230:231], v10 offset:8704
    v_accvgpr_read_b32 v248, a66
    v_accvgpr_read_b32 v249, a74
    v_cvt_pk_bf16_f32 v248, 0, v248
    v_cvt_pk_bf16_f32 v249, 0, v249
    v_mul_f32 v248, v248, v249
    s_waitcnt lgkmcnt(8)
    v_mfma_f32_32x32x16_bf16 v[24:39], v[236:239], a[208:211], v[24:39]
    ds_read_b64_tr_b16 v[232:233], v10 offset:12288
    v_accvgpr_read_b32 v250, a67
    v_accvgpr_read_b32 v251, a75
    v_cvt_pk_bf16_f32 v250, 0, v250
    v_cvt_pk_bf16_f32 v251, 0, v251
    v_mul_f32 v250, v250, v251
    v_mfma_f32_32x32x16_bf16 v[40:55], v[236:239], a[212:215], v[40:55]
    ds_read_b64_tr_b16 v[234:235], v10 offset:12800
    v_cvt_pk_bf16_f32 v241, v248, v250
    v_accvgpr_read_b32 v248, a68
    v_accvgpr_read_b32 v249, a76
    v_cvt_pk_bf16_f32 v248, 0, v248
    v_cvt_pk_bf16_f32 v249, 0, v249
    s_waitcnt lgkmcnt(8)
    v_mfma_f32_32x32x16_bf16 v[24:39], v[216:219], a[216:219], v[24:39]
    ds_read_b64_tr_b16 v[236:237], v8 offset:0
    v_mul_f32 v248, v248, v249
    v_accvgpr_read_b32 v250, a69
    v_accvgpr_read_b32 v251, a77
    v_cvt_pk_bf16_f32 v250, 0, v250
    v_cvt_pk_bf16_f32 v251, 0, v251
    v_mfma_f32_32x32x16_bf16 v[40:55], v[216:219], a[220:223], v[40:55]
    ds_read_b64_tr_b16 v[238:239], v8 offset:512
    v_mul_f32 v250, v250, v251
    v_cvt_pk_bf16_f32 v242, v248, v250
    v_accvgpr_read_b32 v248, a70
    v_accvgpr_read_b32 v249, a78
    v_cvt_pk_bf16_f32 v248, 0, v248
    s_waitcnt lgkmcnt(8)
    v_mfma_f32_32x32x16_bf16 v[24:39], v[220:223], a[224:227], v[24:39]
    ds_read_b64_tr_b16 v[216:217], v8 offset:4096
    v_cvt_pk_bf16_f32 v249, 0, v249
    v_mul_f32 v248, v248, v249
    v_accvgpr_read_b32 v250, a71
    v_accvgpr_read_b32 v251, a79
    v_cvt_pk_bf16_f32 v250, 0, v250
    v_mfma_f32_32x32x16_bf16 v[40:55], v[220:223], a[228:231], v[40:55]
    ds_read_b64_tr_b16 v[218:219], v8 offset:4608
    v_cvt_pk_bf16_f32 v251, 0, v251
    v_mul_f32 v250, v250, v251
    v_cvt_pk_bf16_f32 v243, v248, v250
    s_add_u32 s30, s33, 2048
    buffer_store_dwordx4 v[240:243], v1, s[16:19], s30 offen sc0 sc1
    s_waitcnt lgkmcnt(8)
    v_mfma_f32_32x32x16_bf16 v[24:39], v[224:227], a[232:235], v[24:39]
    ds_read_b64_tr_b16 v[220:221], v8 offset:8192
    v_accvgpr_read_b32 v248, a80
    v_accvgpr_read_b32 v249, a88
    v_cvt_pk_bf16_f32 v248, 0, v248
    v_cvt_pk_bf16_f32 v249, 0, v249
    v_mul_f32 v248, v248, v249
    v_mfma_f32_32x32x16_bf16 v[40:55], v[224:227], a[236:239], v[40:55]
    ds_read_b64_tr_b16 v[222:223], v8 offset:8704
    v_accvgpr_read_b32 v250, a81
    v_accvgpr_read_b32 v251, a89
    v_cvt_pk_bf16_f32 v250, 0, v250
    v_cvt_pk_bf16_f32 v251, 0, v251
    v_mul_f32 v250, v250, v251
    s_waitcnt lgkmcnt(8)
    v_mfma_f32_32x32x16_bf16 v[56:71], v[228:231], a[168:171], v[56:71]
    ds_read_b64_tr_b16 v[224:225], v8 offset:12288
    v_mfma_f32_32x32x16_bf16 v[72:87], v[228:231], a[172:175], v[72:87]
    ds_read_b64_tr_b16 v[226:227], v8 offset:12800
    s_waitcnt lgkmcnt(8)
    v_mfma_f32_32x32x16_bf16 v[56:71], v[232:235], a[176:179], v[56:71]
    ds_read_b64_tr_b16 v[228:229], v8 offset:16384
    v_cvt_pk_bf16_f32 v244, v248, v250
    v_accvgpr_read_b32 v248, a82
    v_accvgpr_read_b32 v249, a90
    v_cvt_pk_bf16_f32 v248, 0, v248
    v_cvt_pk_bf16_f32 v249, 0, v249
    v_mfma_f32_32x32x16_bf16 v[72:87], v[232:235], a[180:183], v[72:87]
    ds_read_b64_tr_b16 v[230:231], v8 offset:16896
    v_mul_f32 v248, v248, v249
    v_accvgpr_read_b32 v250, a83
    v_accvgpr_read_b32 v251, a91
    v_cvt_pk_bf16_f32 v250, 0, v250
    v_cvt_pk_bf16_f32 v251, 0, v251
    s_waitcnt lgkmcnt(8)
    v_mfma_f32_32x32x16_bf16 v[56:71], v[236:239], a[184:187], v[56:71]
    ds_read_b64_tr_b16 v[232:233], v8 offset:20480
    v_mul_f32 v250, v250, v251
    v_cvt_pk_bf16_f32 v245, v248, v250
    v_accvgpr_read_b32 v248, a84
    v_accvgpr_read_b32 v249, a92
    v_cvt_pk_bf16_f32 v248, 0, v248
    v_mfma_f32_32x32x16_bf16 v[72:87], v[236:239], a[188:191], v[72:87]
    ds_read_b64_tr_b16 v[234:235], v8 offset:20992
    v_cvt_pk_bf16_f32 v249, 0, v249
    v_mul_f32 v248, v248, v249
    v_accvgpr_read_b32 v250, a85
    v_accvgpr_read_b32 v251, a93
    v_cvt_pk_bf16_f32 v250, 0, v250
    s_waitcnt lgkmcnt(8)
    v_mfma_f32_32x32x16_bf16 v[56:71], v[216:219], a[192:195], v[56:71]
    ds_read_b64_tr_b16 v[236:237], v8 offset:24576
    v_cvt_pk_bf16_f32 v251, 0, v251
    v_mul_f32 v250, v250, v251
    v_cvt_pk_bf16_f32 v246, v248, v250
    v_accvgpr_read_b32 v248, a86
    v_accvgpr_read_b32 v249, a94
    v_mfma_f32_32x32x16_bf16 v[72:87], v[216:219], a[196:199], v[72:87]
    ds_read_b64_tr_b16 v[238:239], v8 offset:25088
    v_cvt_pk_bf16_f32 v248, 0, v248
    v_cvt_pk_bf16_f32 v249, 0, v249
    v_mul_f32 v248, v248, v249
    v_accvgpr_read_b32 v250, a87
    v_accvgpr_read_b32 v251, a95
    s_waitcnt lgkmcnt(8)
    v_mfma_f32_32x32x16_bf16 v[56:71], v[220:223], a[200:203], v[56:71]
    ds_read_b64_tr_b16 v[216:217], v13 offset:8192
    v_cvt_pk_bf16_f32 v250, 0, v250
    v_cvt_pk_bf16_f32 v251, 0, v251
    v_mul_f32 v250, v250, v251
    v_cvt_pk_bf16_f32 v247, v248, v250
    s_add_u32 s30, s33, 296960
    v_mfma_f32_32x32x16_bf16 v[72:87], v[220:223], a[204:207], v[72:87]
    ds_read_b64_tr_b16 v[218:219], v13 offset:8704
    buffer_store_dwordx4 v[244:247], v1, s[16:19], s30 offen sc0 sc1
    v_cvt_pk_bf16_f32 v24, 0, v24
    v_cvt_pk_bf16_f32 v32, 0, v32
    v_mul_f32 v24, v24, v32
    v_cvt_pk_bf16_f32 v25, 0, v25
    s_waitcnt lgkmcnt(8)
    v_mfma_f32_32x32x16_bf16 v[56:71], v[224:227], a[208:211], v[56:71]
    ds_read_b64_tr_b16 v[220:221], v13 offset:12288
    v_cvt_pk_bf16_f32 v33, 0, v33
    v_mul_f32 v25, v25, v33
    v_cvt_pk_bf16_f32 v240, v24, v25
    v_cvt_pk_bf16_f32 v26, 0, v26
    v_cvt_pk_bf16_f32 v34, 0, v34
    v_mfma_f32_32x32x16_bf16 v[72:87], v[224:227], a[212:215], v[72:87]
    ds_read_b64_tr_b16 v[222:223], v13 offset:12800
    v_mul_f32 v26, v26, v34
    v_cvt_pk_bf16_f32 v27, 0, v27
    v_cvt_pk_bf16_f32 v35, 0, v35
    v_mul_f32 v27, v27, v35
    v_cvt_pk_bf16_f32 v241, v26, v27
    s_waitcnt lgkmcnt(8)
    v_mfma_f32_32x32x16_bf16 v[56:71], v[228:231], a[216:219], v[56:71]
    ds_read_b64_tr_b16 v[224:225], v11 offset:0
    v_cvt_pk_bf16_f32 v28, 0, v28
    v_cvt_pk_bf16_f32 v36, 0, v36
    v_mul_f32 v28, v28, v36
    v_cvt_pk_bf16_f32 v29, 0, v29
    v_cvt_pk_bf16_f32 v37, 0, v37
    v_mfma_f32_32x32x16_bf16 v[72:87], v[228:231], a[220:223], v[72:87]
    ds_read_b64_tr_b16 v[226:227], v11 offset:512
    v_mul_f32 v29, v29, v37
    v_cvt_pk_bf16_f32 v242, v28, v29
    v_cvt_pk_bf16_f32 v30, 0, v30
    v_cvt_pk_bf16_f32 v38, 0, v38
    v_mul_f32 v30, v30, v38
    s_waitcnt lgkmcnt(8)
    v_mfma_f32_32x32x16_bf16 v[56:71], v[232:235], a[224:227], v[56:71]
    ds_read_b64_tr_b16 v[228:229], v11 offset:4096
    v_cvt_pk_bf16_f32 v31, 0, v31
    v_cvt_pk_bf16_f32 v39, 0, v39
    v_mul_f32 v31, v31, v39
    v_cvt_pk_bf16_f32 v243, v30, v31
    s_add_u32 s30, s33, 3072
    v_mfma_f32_32x32x16_bf16 v[72:87], v[232:235], a[228:231], v[72:87]
    ds_read_b64_tr_b16 v[230:231], v11 offset:4608
    buffer_store_dwordx4 v[240:243], v1, s[16:19], s30 offen sc0 sc1
    v_cvt_pk_bf16_f32 v40, 0, v40
    v_cvt_pk_bf16_f32 v48, 0, v48
    v_mul_f32 v40, v40, v48
    v_cvt_pk_bf16_f32 v41, 0, v41
    s_waitcnt lgkmcnt(8)
    v_mfma_f32_32x32x16_bf16 v[56:71], v[236:239], a[232:235], v[56:71]
    ds_read_b64_tr_b16 v[232:233], v11 offset:8192
    v_cvt_pk_bf16_f32 v49, 0, v49
    v_mul_f32 v41, v41, v49
    v_cvt_pk_bf16_f32 v244, v40, v41
    v_cvt_pk_bf16_f32 v42, 0, v42
    v_cvt_pk_bf16_f32 v50, 0, v50
    v_mfma_f32_32x32x16_bf16 v[72:87], v[236:239], a[236:239], v[72:87]
    ds_read_b64_tr_b16 v[234:235], v11 offset:8704
    v_mul_f32 v42, v42, v50
    v_cvt_pk_bf16_f32 v43, 0, v43
    v_cvt_pk_bf16_f32 v51, 0, v51
    v_mul_f32 v43, v43, v51
    v_cvt_pk_bf16_f32 v245, v42, v43
    s_waitcnt lgkmcnt(8)
    v_mfma_f32_32x32x16_bf16 v[88:103], v[216:219], a[168:171], v[88:103]
    ds_read_b64_tr_b16 v[236:237], v11 offset:12288
    v_mfma_f32_32x32x16_bf16 v[104:119], v[216:219], a[172:175], v[104:119]
    ds_read_b64_tr_b16 v[238:239], v11 offset:12800
    s_waitcnt lgkmcnt(8)
    v_mfma_f32_32x32x16_bf16 v[88:103], v[220:223], a[176:179], v[88:103]
    ds_read_b64_tr_b16 v[216:217], v11 offset:16384
    v_cvt_pk_bf16_f32 v44, 0, v44
    v_cvt_pk_bf16_f32 v52, 0, v52
    v_mul_f32 v44, v44, v52
    v_cvt_pk_bf16_f32 v45, 0, v45
    v_cvt_pk_bf16_f32 v53, 0, v53
    v_mfma_f32_32x32x16_bf16 v[104:119], v[220:223], a[180:183], v[104:119]
    ds_read_b64_tr_b16 v[218:219], v11 offset:16896
    v_mul_f32 v45, v45, v53
    v_cvt_pk_bf16_f32 v246, v44, v45
    v_cvt_pk_bf16_f32 v46, 0, v46
    v_cvt_pk_bf16_f32 v54, 0, v54
    v_mul_f32 v46, v46, v54
    s_waitcnt lgkmcnt(8)
    v_mfma_f32_32x32x16_bf16 v[88:103], v[224:227], a[184:187], v[88:103]
    ds_read_b64_tr_b16 v[220:221], v11 offset:20480
    v_cvt_pk_bf16_f32 v47, 0, v47
    v_cvt_pk_bf16_f32 v55, 0, v55
    v_mul_f32 v47, v47, v55
    v_cvt_pk_bf16_f32 v247, v46, v47
    s_add_u32 s30, s33, 297984
    v_mfma_f32_32x32x16_bf16 v[104:119], v[224:227], a[188:191], v[104:119]
    ds_read_b64_tr_b16 v[222:223], v11 offset:20992
    buffer_store_dwordx4 v[244:247], v1, s[16:19], s30 offen sc0 sc1
    v_cvt_pk_bf16_f32 v56, 0, v56
    v_cvt_pk_bf16_f32 v64, 0, v64
    v_mul_f32 v56, v56, v64
    v_cvt_pk_bf16_f32 v57, 0, v57
    s_waitcnt lgkmcnt(8)
    v_mfma_f32_32x32x16_bf16 v[88:103], v[228:231], a[192:195], v[88:103]
    ds_read_b64_tr_b16 v[224:225], v11 offset:24576
    v_cvt_pk_bf16_f32 v65, 0, v65
    v_mul_f32 v57, v57, v65
    v_cvt_pk_bf16_f32 v240, v56, v57
    v_cvt_pk_bf16_f32 v58, 0, v58
    v_cvt_pk_bf16_f32 v66, 0, v66
    v_mfma_f32_32x32x16_bf16 v[104:119], v[228:231], a[196:199], v[104:119]
    ds_read_b64_tr_b16 v[226:227], v11 offset:25088
    v_mul_f32 v58, v58, v66
    v_cvt_pk_bf16_f32 v59, 0, v59
    v_cvt_pk_bf16_f32 v67, 0, v67
    v_mul_f32 v59, v59, v67
    v_cvt_pk_bf16_f32 v241, v58, v59
    s_waitcnt lgkmcnt(8)
    v_mfma_f32_32x32x16_bf16 v[88:103], v[232:235], a[200:203], v[88:103]
    ds_read_b64_tr_b16 v[228:229], v16 offset:8192
    v_cvt_pk_bf16_f32 v60, 0, v60
    v_cvt_pk_bf16_f32 v68, 0, v68
    v_mul_f32 v60, v60, v68
    v_cvt_pk_bf16_f32 v61, 0, v61
    v_cvt_pk_bf16_f32 v69, 0, v69
    v_mfma_f32_32x32x16_bf16 v[104:119], v[232:235], a[204:207], v[104:119]
    ds_read_b64_tr_b16 v[230:231], v16 offset:8704
    v_mul_f32 v61, v61, v69
    v_cvt_pk_bf16_f32 v242, v60, v61
    v_cvt_pk_bf16_f32 v62, 0, v62
    v_cvt_pk_bf16_f32 v70, 0, v70
    v_mul_f32 v62, v62, v70
    s_waitcnt lgkmcnt(8)
    v_mfma_f32_32x32x16_bf16 v[88:103], v[236:239], a[208:211], v[88:103]
    ds_read_b64_tr_b16 v[232:233], v16 offset:12288
    v_cvt_pk_bf16_f32 v63, 0, v63
    v_cvt_pk_bf16_f32 v71, 0, v71
    v_mul_f32 v63, v63, v71
    v_cvt_pk_bf16_f32 v243, v62, v63
    s_add_u32 s30, s33, 4096
    v_mfma_f32_32x32x16_bf16 v[104:119], v[236:239], a[212:215], v[104:119]
    ds_read_b64_tr_b16 v[234:235], v16 offset:12800
    buffer_store_dwordx4 v[240:243], v1, s[16:19], s30 offen sc0 sc1
    v_cvt_pk_bf16_f32 v72, 0, v72
    v_cvt_pk_bf16_f32 v80, 0, v80
    v_mul_f32 v72, v72, v80
    v_cvt_pk_bf16_f32 v73, 0, v73
    s_waitcnt lgkmcnt(8)
    v_mfma_f32_32x32x16_bf16 v[88:103], v[216:219], a[216:219], v[88:103]
    ds_read_b64_tr_b16 v[236:237], v14 offset:0
    v_cvt_pk_bf16_f32 v81, 0, v81
    v_mul_f32 v73, v73, v81
    v_cvt_pk_bf16_f32 v244, v72, v73
    v_cvt_pk_bf16_f32 v74, 0, v74
    v_cvt_pk_bf16_f32 v82, 0, v82
    v_mfma_f32_32x32x16_bf16 v[104:119], v[216:219], a[220:223], v[104:119]
    ds_read_b64_tr_b16 v[238:239], v14 offset:512
    v_mul_f32 v74, v74, v82
    v_cvt_pk_bf16_f32 v75, 0, v75
    v_cvt_pk_bf16_f32 v83, 0, v83
    v_mul_f32 v75, v75, v83
    v_cvt_pk_bf16_f32 v245, v74, v75
    s_waitcnt lgkmcnt(8)
    v_mfma_f32_32x32x16_bf16 v[88:103], v[220:223], a[224:227], v[88:103]
    ds_read_b64_tr_b16 v[216:217], v14 offset:4096
    v_cvt_pk_bf16_f32 v76, 0, v76
    v_cvt_pk_bf16_f32 v84, 0, v84
    v_mul_f32 v76, v76, v84
    v_cvt_pk_bf16_f32 v77, 0, v77
    v_cvt_pk_bf16_f32 v85, 0, v85
    v_mfma_f32_32x32x16_bf16 v[104:119], v[220:223], a[228:231], v[104:119]
    ds_read_b64_tr_b16 v[218:219], v14 offset:4608
    v_mul_f32 v77, v77, v85
    v_cvt_pk_bf16_f32 v246, v76, v77
    v_cvt_pk_bf16_f32 v78, 0, v78
    v_cvt_pk_bf16_f32 v86, 0, v86
    v_mul_f32 v78, v78, v86
    s_waitcnt lgkmcnt(8)
    v_mfma_f32_32x32x16_bf16 v[88:103], v[224:227], a[232:235], v[88:103]
    ds_read_b64_tr_b16 v[220:221], v14 offset:8192
    v_cvt_pk_bf16_f32 v79, 0, v79
    v_cvt_pk_bf16_f32 v87, 0, v87
    v_mul_f32 v79, v79, v87
    v_cvt_pk_bf16_f32 v247, v78, v79
    s_add_u32 s30, s33, 299008
    v_mfma_f32_32x32x16_bf16 v[104:119], v[224:227], a[236:239], v[104:119]
    ds_read_b64_tr_b16 v[222:223], v14 offset:8704
    buffer_store_dwordx4 v[244:247], v1, s[16:19], s30 offen sc0 sc1
    s_waitcnt lgkmcnt(8)
    v_mfma_f32_32x32x16_bf16 v[120:135], v[228:231], a[168:171], v[120:135]
    ds_read_b64_tr_b16 v[224:225], v14 offset:12288
    v_mfma_f32_32x32x16_bf16 v[136:151], v[228:231], a[172:175], v[136:151]
    ds_read_b64_tr_b16 v[226:227], v14 offset:12800
    s_waitcnt lgkmcnt(8)
    v_mfma_f32_32x32x16_bf16 v[120:135], v[232:235], a[176:179], v[120:135]
    ds_read_b64_tr_b16 v[228:229], v14 offset:16384
    v_cvt_pk_bf16_f32 v88, 0, v88
    v_cvt_pk_bf16_f32 v96, 0, v96
    v_mul_f32 v88, v88, v96
    v_cvt_pk_bf16_f32 v89, 0, v89
    v_cvt_pk_bf16_f32 v97, 0, v97
    v_mfma_f32_32x32x16_bf16 v[136:151], v[232:235], a[180:183], v[136:151]
    ds_read_b64_tr_b16 v[230:231], v14 offset:16896
    v_mul_f32 v89, v89, v97
    v_cvt_pk_bf16_f32 v240, v88, v89
    v_cvt_pk_bf16_f32 v90, 0, v90
    v_cvt_pk_bf16_f32 v98, 0, v98
    v_mul_f32 v90, v90, v98
    s_waitcnt lgkmcnt(8)
    v_mfma_f32_32x32x16_bf16 v[120:135], v[236:239], a[184:187], v[120:135]
    ds_read_b64_tr_b16 v[232:233], v14 offset:20480
    v_cvt_pk_bf16_f32 v91, 0, v91
    v_cvt_pk_bf16_f32 v99, 0, v99
    v_mul_f32 v91, v91, v99
    v_cvt_pk_bf16_f32 v241, v90, v91
    v_cvt_pk_bf16_f32 v92, 0, v92
    v_mfma_f32_32x32x16_bf16 v[136:151], v[236:239], a[188:191], v[136:151]
    ds_read_b64_tr_b16 v[234:235], v14 offset:20992
    v_cvt_pk_bf16_f32 v100, 0, v100
    v_mul_f32 v92, v92, v100
    v_cvt_pk_bf16_f32 v93, 0, v93
    v_cvt_pk_bf16_f32 v101, 0, v101
    v_mul_f32 v93, v93, v101
    s_waitcnt lgkmcnt(8)
    v_mfma_f32_32x32x16_bf16 v[120:135], v[216:219], a[192:195], v[120:135]
    ds_read_b64_tr_b16 v[236:237], v14 offset:24576
    v_cvt_pk_bf16_f32 v242, v92, v93
    v_cvt_pk_bf16_f32 v94, 0, v94
    v_cvt_pk_bf16_f32 v102, 0, v102
    v_mul_f32 v94, v94, v102
    v_cvt_pk_bf16_f32 v95, 0, v95
    v_mfma_f32_32x32x16_bf16 v[136:151], v[216:219], a[196:199], v[136:151]
    ds_read_b64_tr_b16 v[238:239], v14 offset:25088
    v_cvt_pk_bf16_f32 v103, 0, v103
    v_mul_f32 v95, v95, v103
    v_cvt_pk_bf16_f32 v243, v94, v95
    s_add_u32 s30, s33, 5120
    buffer_store_dwordx4 v[240:243], v1, s[16:19], s30 offen sc0 sc1
    s_waitcnt lgkmcnt(8)
    v_mfma_f32_32x32x16_bf16 v[120:135], v[220:223], a[200:203], v[120:135]
    ds_read_b64_tr_b16 v[216:217], v19 offset:8192
    v_cvt_pk_bf16_f32 v104, 0, v104
    v_cvt_pk_bf16_f32 v112, 0, v112
    v_mul_f32 v104, v104, v112
    v_cvt_pk_bf16_f32 v105, 0, v105
    v_cvt_pk_bf16_f32 v113, 0, v113
    v_mfma_f32_32x32x16_bf16 v[136:151], v[220:223], a[204:207], v[136:151]
    ds_read_b64_tr_b16 v[218:219], v19 offset:8704
    v_mul_f32 v105, v105, v113
    v_cvt_pk_bf16_f32 v244, v104, v105
    v_cvt_pk_bf16_f32 v106, 0, v106
    v_cvt_pk_bf16_f32 v114, 0, v114
    v_mul_f32 v106, v106, v114
    s_waitcnt lgkmcnt(8)
    v_mfma_f32_32x32x16_bf16 v[120:135], v[224:227], a[208:211], v[120:135]
    ds_read_b64_tr_b16 v[220:221], v19 offset:12288
    v_cvt_pk_bf16_f32 v107, 0, v107
    v_cvt_pk_bf16_f32 v115, 0, v115
    v_mul_f32 v107, v107, v115
    v_cvt_pk_bf16_f32 v245, v106, v107
    v_cvt_pk_bf16_f32 v108, 0, v108
    v_mfma_f32_32x32x16_bf16 v[136:151], v[224:227], a[212:215], v[136:151]
    ds_read_b64_tr_b16 v[222:223], v19 offset:12800
    v_cvt_pk_bf16_f32 v116, 0, v116
    v_mul_f32 v108, v108, v116
    v_cvt_pk_bf16_f32 v109, 0, v109
    v_cvt_pk_bf16_f32 v117, 0, v117
    v_mul_f32 v109, v109, v117
    s_waitcnt lgkmcnt(8)
    v_mfma_f32_32x32x16_bf16 v[120:135], v[228:231], a[216:219], v[120:135]
    ds_read_b64_tr_b16 v[224:225], v17 offset:0
    v_cvt_pk_bf16_f32 v246, v108, v109
    v_cvt_pk_bf16_f32 v110, 0, v110
    v_cvt_pk_bf16_f32 v118, 0, v118
    v_mul_f32 v110, v110, v118
    v_cvt_pk_bf16_f32 v111, 0, v111
    v_mfma_f32_32x32x16_bf16 v[136:151], v[228:231], a[220:223], v[136:151]
    ds_read_b64_tr_b16 v[226:227], v17 offset:512
    v_cvt_pk_bf16_f32 v119, 0, v119
    v_mul_f32 v111, v111, v119
    v_cvt_pk_bf16_f32 v247, v110, v111
    s_add_u32 s30, s33, 300032
    buffer_store_dwordx4 v[244:247], v1, s[16:19], s30 offen sc0 sc1
    s_waitcnt lgkmcnt(8)
    v_mfma_f32_32x32x16_bf16 v[120:135], v[232:235], a[224:227], v[120:135]
    ds_read_b64_tr_b16 v[228:229], v17 offset:4096
    v_mfma_f32_32x32x16_bf16 v[136:151], v[232:235], a[228:231], v[136:151]
    ds_read_b64_tr_b16 v[230:231], v17 offset:4608
    s_waitcnt lgkmcnt(8)
    v_mfma_f32_32x32x16_bf16 v[120:135], v[236:239], a[232:235], v[120:135]
    ds_read_b64_tr_b16 v[232:233], v17 offset:8192
    v_mfma_f32_32x32x16_bf16 v[136:151], v[236:239], a[236:239], v[136:151]
    ds_read_b64_tr_b16 v[234:235], v17 offset:8704
    s_waitcnt lgkmcnt(8)
    v_mfma_f32_32x32x16_bf16 v[152:167], v[216:219], a[168:171], v[152:167]
    ds_read_b64_tr_b16 v[236:237], v17 offset:12288
    v_mfma_f32_32x32x16_bf16 v[168:183], v[216:219], a[172:175], v[168:183]
    ds_read_b64_tr_b16 v[238:239], v17 offset:12800
    s_waitcnt lgkmcnt(8)
    v_mfma_f32_32x32x16_bf16 v[152:167], v[220:223], a[176:179], v[152:167]
    ds_read_b64_tr_b16 v[216:217], v17 offset:16384
    s_nop 0
    v_cvt_pk_bf16_f32 v120, 0, v120
    v_cvt_pk_bf16_f32 v128, 0, v128
    v_mul_f32 v120, v120, v128
    v_cvt_pk_bf16_f32 v121, 0, v121
    v_cvt_pk_bf16_f32 v129, 0, v129
    v_mfma_f32_32x32x16_bf16 v[168:183], v[220:223], a[180:183], v[168:183]
    ds_read_b64_tr_b16 v[218:219], v17 offset:16896
    v_mul_f32 v121, v121, v129
    v_cvt_pk_bf16_f32 v240, v120, v121
    v_cvt_pk_bf16_f32 v122, 0, v122
    v_cvt_pk_bf16_f32 v130, 0, v130
    v_mul_f32 v122, v122, v130
    s_waitcnt lgkmcnt(8)
    v_mfma_f32_32x32x16_bf16 v[152:167], v[224:227], a[184:187], v[152:167]
    ds_read_b64_tr_b16 v[220:221], v17 offset:20480
    v_cvt_pk_bf16_f32 v123, 0, v123
    v_cvt_pk_bf16_f32 v131, 0, v131
    v_mul_f32 v123, v123, v131
    v_cvt_pk_bf16_f32 v241, v122, v123
    v_cvt_pk_bf16_f32 v124, 0, v124
    v_mfma_f32_32x32x16_bf16 v[168:183], v[224:227], a[188:191], v[168:183]
    ds_read_b64_tr_b16 v[222:223], v17 offset:20992
    v_cvt_pk_bf16_f32 v132, 0, v132
    v_mul_f32 v124, v124, v132
    v_cvt_pk_bf16_f32 v125, 0, v125
    v_cvt_pk_bf16_f32 v133, 0, v133
    v_mul_f32 v125, v125, v133
    s_waitcnt lgkmcnt(8)
    v_mfma_f32_32x32x16_bf16 v[152:167], v[228:231], a[192:195], v[152:167]
    ds_read_b64_tr_b16 v[224:225], v17 offset:24576
    v_cvt_pk_bf16_f32 v242, v124, v125
    v_cvt_pk_bf16_f32 v126, 0, v126
    v_cvt_pk_bf16_f32 v134, 0, v134
    v_mul_f32 v126, v126, v134
    v_cvt_pk_bf16_f32 v127, 0, v127
    v_mfma_f32_32x32x16_bf16 v[168:183], v[228:231], a[196:199], v[168:183]
    ds_read_b64_tr_b16 v[226:227], v17 offset:25088
    v_cvt_pk_bf16_f32 v135, 0, v135
    v_mul_f32 v127, v127, v135
    v_cvt_pk_bf16_f32 v243, v126, v127
    s_add_u32 s30, s33, 6144
    buffer_store_dwordx4 v[240:243], v1, s[16:19], s30 offen sc0 sc1
    s_waitcnt vmcnt(13)
    s_barrier
    s_waitcnt lgkmcnt(8)
    v_mfma_f32_32x32x16_bf16 v[152:167], v[232:235], a[200:203], v[152:167]
    ds_read_b64_tr_b16 v[228:229], v21 offset:34304
    v_cvt_pk_bf16_f32 v136, 0, v136
    v_cvt_pk_bf16_f32 v144, 0, v144
    v_mul_f32 v136, v136, v144
    v_cvt_pk_bf16_f32 v137, 0, v137
    v_cvt_pk_bf16_f32 v145, 0, v145
    v_mfma_f32_32x32x16_bf16 v[168:183], v[232:235], a[204:207], v[168:183]
    ds_read_b64_tr_b16 v[230:231], v21 offset:34432
    v_mul_f32 v137, v137, v145
    v_cvt_pk_bf16_f32 v244, v136, v137
    v_cvt_pk_bf16_f32 v138, 0, v138
    v_cvt_pk_bf16_f32 v146, 0, v146
    v_mul_f32 v138, v138, v146
    s_waitcnt lgkmcnt(8)
    v_mfma_f32_32x32x16_bf16 v[152:167], v[236:239], a[208:211], v[152:167]
    ds_read_b64_tr_b16 v[232:233], v20 offset:28672
    v_cvt_pk_bf16_f32 v139, 0, v139
    v_cvt_pk_bf16_f32 v147, 0, v147
    v_mul_f32 v139, v139, v147
    v_cvt_pk_bf16_f32 v245, v138, v139
    v_cvt_pk_bf16_f32 v140, 0, v140
    v_mfma_f32_32x32x16_bf16 v[168:183], v[236:239], a[212:215], v[168:183]
    ds_read_b64_tr_b16 v[234:235], v20 offset:28800
    v_cvt_pk_bf16_f32 v148, 0, v148
    v_mul_f32 v140, v140, v148
    v_cvt_pk_bf16_f32 v141, 0, v141
    v_cvt_pk_bf16_f32 v149, 0, v149
    v_mul_f32 v141, v141, v149
    s_waitcnt lgkmcnt(8)
    v_mfma_f32_32x32x16_bf16 v[152:167], v[216:219], a[216:219], v[152:167]
    ds_read_b64_tr_b16 v[236:237], v20 offset:29184
    v_cvt_pk_bf16_f32 v246, v140, v141
    v_cvt_pk_bf16_f32 v142, 0, v142
    v_cvt_pk_bf16_f32 v150, 0, v150
    v_mul_f32 v142, v142, v150
    v_cvt_pk_bf16_f32 v143, 0, v143
    v_mfma_f32_32x32x16_bf16 v[168:183], v[216:219], a[220:223], v[168:183]
    ds_read_b64_tr_b16 v[238:239], v20 offset:29312
    v_cvt_pk_bf16_f32 v151, 0, v151
    v_mul_f32 v143, v143, v151
    v_cvt_pk_bf16_f32 v247, v142, v143
    s_add_u32 s30, s33, 301056
    buffer_store_dwordx4 v[244:247], v1, s[16:19], s30 offen sc0 sc1
    s_waitcnt lgkmcnt(8)
    v_mfma_f32_32x32x16_bf16 v[152:167], v[220:223], a[224:227], v[152:167]
    ds_read_b64_tr_b16 v[216:217], v20 offset:29696
    v_mfma_f32_32x32x16_bf16 v[168:183], v[220:223], a[228:231], v[168:183]
    ds_read_b64_tr_b16 v[218:219], v20 offset:29824
    s_waitcnt lgkmcnt(8)
    v_mfma_f32_32x32x16_bf16 v[152:167], v[224:227], a[232:235], v[152:167]
    ds_read_b64_tr_b16 v[220:221], v20 offset:30208
    v_mfma_f32_32x32x16_bf16 v[168:183], v[224:227], a[236:239], v[168:183]
    ds_read_b64_tr_b16 v[222:223], v20 offset:30336
    s_waitcnt lgkmcnt(8)
    v_mfma_f32_32x32x16_bf16 v[184:199], v[228:231], a[168:171], v[184:199]
    ds_read_b64_tr_b16 v[224:225], v20 offset:32768
    v_mfma_f32_32x32x16_bf16 v[200:215], v[228:231], a[172:175], v[200:215]
    ds_read_b64_tr_b16 v[226:227], v20 offset:32896
    s_waitcnt lgkmcnt(8)
    v_mfma_f32_32x32x16_bf16 v[184:199], v[232:235], a[176:179], v[184:199]
    ds_read_b64_tr_b16 v[228:229], v20 offset:33280
    s_nop 0
    v_cvt_pk_bf16_f32 v152, 0, v152
    v_cvt_pk_bf16_f32 v160, 0, v160
    v_mul_f32 v152, v152, v160
    v_cvt_pk_bf16_f32 v153, 0, v153
    v_cvt_pk_bf16_f32 v161, 0, v161
    v_mfma_f32_32x32x16_bf16 v[200:215], v[232:235], a[180:183], v[200:215]
    ds_read_b64_tr_b16 v[230:231], v20 offset:33408
    v_mul_f32 v153, v153, v161
    v_cvt_pk_bf16_f32 v240, v152, v153
    v_cvt_pk_bf16_f32 v154, 0, v154
    v_cvt_pk_bf16_f32 v162, 0, v162
    v_mul_f32 v154, v154, v162
    s_waitcnt lgkmcnt(8)
    v_mfma_f32_32x32x16_bf16 v[184:199], v[236:239], a[184:187], v[184:199]
    ds_read_b64_tr_b16 v[232:233], v20 offset:33792
    v_cvt_pk_bf16_f32 v155, 0, v155
    v_cvt_pk_bf16_f32 v163, 0, v163
    v_mul_f32 v155, v155, v163
    v_cvt_pk_bf16_f32 v241, v154, v155
    v_cvt_pk_bf16_f32 v156, 0, v156
    v_mfma_f32_32x32x16_bf16 v[200:215], v[236:239], a[188:191], v[200:215]
    ds_read_b64_tr_b16 v[234:235], v20 offset:33920
    v_cvt_pk_bf16_f32 v164, 0, v164
    v_mul_f32 v156, v156, v164
    v_cvt_pk_bf16_f32 v157, 0, v157
    v_cvt_pk_bf16_f32 v165, 0, v165
    v_mul_f32 v157, v157, v165
    s_waitcnt lgkmcnt(8)
    v_mfma_f32_32x32x16_bf16 v[184:199], v[216:219], a[192:195], v[184:199]
    ds_read_b64_tr_b16 v[236:237], v20 offset:34304
    v_cvt_pk_bf16_f32 v242, v156, v157
    v_cvt_pk_bf16_f32 v158, 0, v158
    v_cvt_pk_bf16_f32 v166, 0, v166
    v_mul_f32 v158, v158, v166
    v_cvt_pk_bf16_f32 v159, 0, v159
    v_mfma_f32_32x32x16_bf16 v[200:215], v[216:219], a[196:199], v[200:215]
    ds_read_b64_tr_b16 v[238:239], v20 offset:34432
    v_cvt_pk_bf16_f32 v167, 0, v167
    v_mul_f32 v159, v159, v167
    v_cvt_pk_bf16_f32 v243, v158, v159
    s_add_u32 s30, s33, 7168
    buffer_store_dwordx4 v[240:243], v1, s[16:19], s30 offen sc0 sc1
    s_waitcnt lgkmcnt(8)
    v_mfma_f32_32x32x16_bf16 v[184:199], v[220:223], a[200:203], v[184:199]
    v_cvt_pk_bf16_f32 v168, 0, v168
    v_cvt_pk_bf16_f32 v176, 0, v176
    v_mul_f32 v168, v168, v176
    v_cvt_pk_bf16_f32 v169, 0, v169
    v_cvt_pk_bf16_f32 v177, 0, v177
    v_mfma_f32_32x32x16_bf16 v[200:215], v[220:223], a[204:207], v[200:215]
    v_mul_f32 v169, v169, v177
    v_cvt_pk_bf16_f32 v244, v168, v169
    v_cvt_pk_bf16_f32 v170, 0, v170
    v_cvt_pk_bf16_f32 v178, 0, v178
    v_mul_f32 v170, v170, v178
    s_waitcnt lgkmcnt(6)
    v_mfma_f32_32x32x16_bf16 v[184:199], v[224:227], a[208:211], v[184:199]
    v_cvt_pk_bf16_f32 v171, 0, v171
    v_cvt_pk_bf16_f32 v179, 0, v179
    v_mul_f32 v171, v171, v179
    v_cvt_pk_bf16_f32 v245, v170, v171
    v_cvt_pk_bf16_f32 v172, 0, v172
    v_mfma_f32_32x32x16_bf16 v[200:215], v[224:227], a[212:215], v[200:215]
    v_cvt_pk_bf16_f32 v180, 0, v180
    v_mul_f32 v172, v172, v180
    v_cvt_pk_bf16_f32 v173, 0, v173
    v_cvt_pk_bf16_f32 v181, 0, v181
    v_mul_f32 v173, v173, v181
    s_waitcnt lgkmcnt(4)
    v_mfma_f32_32x32x16_bf16 v[184:199], v[228:231], a[216:219], v[184:199]
    v_cvt_pk_bf16_f32 v246, v172, v173
    v_cvt_pk_bf16_f32 v174, 0, v174
    v_cvt_pk_bf16_f32 v182, 0, v182
    v_mul_f32 v174, v174, v182
    v_cvt_pk_bf16_f32 v175, 0, v175
    v_mfma_f32_32x32x16_bf16 v[200:215], v[228:231], a[220:223], v[200:215]
    v_cvt_pk_bf16_f32 v183, 0, v183
    v_mul_f32 v175, v175, v183
    v_cvt_pk_bf16_f32 v247, v174, v175
    s_add_u32 s30, s33, 302080
    buffer_store_dwordx4 v[244:247], v1, s[16:19], s30 offen sc0 sc1
    s_waitcnt lgkmcnt(2)
    v_mfma_f32_32x32x16_bf16 v[184:199], v[232:235], a[224:227], v[184:199]
    v_mfma_f32_32x32x16_bf16 v[200:215], v[232:235], a[228:231], v[200:215]
    s_waitcnt lgkmcnt(0)
    v_mfma_f32_32x32x16_bf16 v[184:199], v[236:239], a[232:235], v[184:199]
    v_mfma_f32_32x32x16_bf16 v[200:215], v[236:239], a[236:239], v[200:215]
    s_nop 10
    v_cvt_pk_bf16_f32 v184, 0, v184
    v_cvt_pk_bf16_f32 v192, 0, v192
    v_mul_f32 v184, v184, v192
    v_cvt_pk_bf16_f32 v185, 0, v185
    v_cvt_pk_bf16_f32 v193, 0, v193
    v_mul_f32 v185, v185, v193
    v_cvt_pk_bf16_f32 v240, v184, v185
    v_cvt_pk_bf16_f32 v186, 0, v186
    v_cvt_pk_bf16_f32 v194, 0, v194
    v_mul_f32 v186, v186, v194
    v_cvt_pk_bf16_f32 v187, 0, v187
    v_cvt_pk_bf16_f32 v195, 0, v195
    v_mul_f32 v187, v187, v195
    v_cvt_pk_bf16_f32 v241, v186, v187
    v_cvt_pk_bf16_f32 v188, 0, v188
    v_cvt_pk_bf16_f32 v196, 0, v196
    v_mul_f32 v188, v188, v196
    v_cvt_pk_bf16_f32 v189, 0, v189
    v_cvt_pk_bf16_f32 v197, 0, v197
    v_mul_f32 v189, v189, v197
    v_cvt_pk_bf16_f32 v242, v188, v189
    v_cvt_pk_bf16_f32 v190, 0, v190
    v_cvt_pk_bf16_f32 v198, 0, v198
    v_mul_f32 v190, v190, v198
    v_cvt_pk_bf16_f32 v191, 0, v191
    v_cvt_pk_bf16_f32 v199, 0, v199
    v_mul_f32 v191, v191, v199
    v_cvt_pk_bf16_f32 v243, v190, v191
    s_add_u32 s30, s34, 0
    buffer_store_dwordx4 v[240:243], v1, s[16:19], s30 offen sc0 sc1
    v_cvt_pk_bf16_f32 v200, 0, v200
    v_cvt_pk_bf16_f32 v208, 0, v208
    v_mul_f32 v200, v200, v208
    v_cvt_pk_bf16_f32 v201, 0, v201
    v_cvt_pk_bf16_f32 v209, 0, v209
    v_mul_f32 v201, v201, v209
    v_cvt_pk_bf16_f32 v244, v200, v201
    v_cvt_pk_bf16_f32 v202, 0, v202
    v_cvt_pk_bf16_f32 v210, 0, v210
    v_mul_f32 v202, v202, v210
    v_cvt_pk_bf16_f32 v203, 0, v203
    v_cvt_pk_bf16_f32 v211, 0, v211
    v_mul_f32 v203, v203, v211
    v_cvt_pk_bf16_f32 v245, v202, v203
    v_cvt_pk_bf16_f32 v204, 0, v204
    v_cvt_pk_bf16_f32 v212, 0, v212
    v_mul_f32 v204, v204, v212
    v_cvt_pk_bf16_f32 v205, 0, v205
    v_cvt_pk_bf16_f32 v213, 0, v213
    v_mul_f32 v205, v205, v213
    v_cvt_pk_bf16_f32 v246, v204, v205
    v_cvt_pk_bf16_f32 v206, 0, v206
    v_cvt_pk_bf16_f32 v214, 0, v214
    v_mul_f32 v206, v206, v214
    v_cvt_pk_bf16_f32 v207, 0, v207
    v_cvt_pk_bf16_f32 v215, 0, v215
    v_mul_f32 v207, v207, v215
    v_cvt_pk_bf16_f32 v247, v206, v207
    s_add_u32 s30, s34, 294912
    buffer_store_dwordx4 v[244:247], v1, s[16:19], s30 offen sc0 sc1
g2_code_start:
    s_load_dwordx2 s[6:7], s[0:1], 120
    s_add_u32 s44, s4, 0x3e80000
    s_addc_u32 s45, s5, 0
    s_mov_b32 s46, 0x98000
    s_mov_b32 s47, 0x00020000
    s_lshl_b32 s29, s21, 5
    s_add_u32 s29, s29, s20
    s_lshl_b32 s29, s29, 7
    s_add_u32 s29, s29, 131072
    v_mov_b32 v10, 0
    v_mov_b32 v11, 1
    s_waitcnt vmcnt(0)
    s_barrier
    s_cmp_lg_u32 s22, 0
    s_cbranch_scc1 gemm1kernel_nf_6
    s_mov_b64 exec, 1
    buffer_store_dword v11, v10, s[44:47], s29 offen sc0 sc1
    s_mov_b64 exec, -1
gemm1kernel_nf_6:
    s_and_b32 s36, s2, 3
    s_bfe_u32 s37, s2, 0x10002
    s_lshl_b32 s37, s37, 3
    s_bfe_u32 s28, s2, 0x30003
    s_add_u32 s37, s37, s28
    s_lshr_b32 s38, s2, 6
    s_mov_b32 s39, s22
    v_lshlrev_b32 v1, 4, v0
    v_add_u32 v3, 0x10000, v1
    v_and_b32 v4, 15, v0
    v_lshrrev_b32 v5, 4, v0
    v_lshrrev_b32 v6, 1, v5
    v_lshlrev_b32 v6, 10, v6
    v_and_b32 v7, 1, v5
    v_lshlrev_b32 v7, 9, v7
    v_lshlrev_b32 v2, 4, v4
    v_add3_u32 v2, v2, v6, v7
    s_lshl_b32 s28, s37, 2
    s_add_u32 s28, s28, s39
    s_mul_i32 s28, s28, 294912
    s_lshl_b32 s29, s36, 13
    s_add_u32 s80, s28, s29
    s_add_u32 s80, s80, 196608
    s_lshl_b32 s29, s36, 16
    s_add_u32 s28, s28, s29
    s_mul_i32 s30, s38, 144
    s_lshl_b32 s29, s36, 2
    s_add_u32 s81, s30, s29
    s_add_u32 s81, s81, 96
    s_mul_i32 s81, s81, 9216
    s_lshl_b32 s29, s36, 5
    s_add_u32 s30, s30, s29
    s_mul_i32 s30, s30, 9216
    s_lshl_b32 s31, s39, 10
    s_add_u32 s30, s30, s31
    s_add_u32 s81, s81, s31
    s_waitcnt lgkmcnt(0)
    s_add_u32 s8, s4, 0x1a80000
    s_addc_u32 s9, s5, 0
    s_mov_b32 s10, 0x1200000
    s_mov_b32 s11, 0x00020000
    s_add_u32 s12, s4, 0x1570000
    s_addc_u32 s13, s5, 0
    s_mov_b32 s14, 0x510000
    s_mov_b32 s15, 0x00020000
    s_add_u32 m0, s31, 0
    s_add_u32 s29, s30, 0
    buffer_load_dwordx4 v1, s[12:15], s29 offen lds
    s_add_u32 m0, s31, 4096
    s_add_u32 s29, s30, 4096
    buffer_load_dwordx4 v1, s[12:15], s29 offen lds
    s_add_u32 m0, s31, 8192
    s_add_u32 s29, s30, 8192
    buffer_load_dwordx4 v1, s[12:15], s29 offen lds
    s_add_u32 m0, s31, 12288
    s_add_u32 s29, s30, 12288
    buffer_load_dwordx4 v1, s[12:15], s29 offen lds
    s_add_u32 m0, s31, 16384
    s_add_u32 s29, s30, 16384
    buffer_load_dwordx4 v1, s[12:15], s29 offen lds
    s_add_u32 m0, s31, 20480
    s_add_u32 s29, s30, 20480
    buffer_load_dwordx4 v1, s[12:15], s29 offen lds
    s_add_u32 m0, s31, 24576
    s_add_u32 s29, s30, 24576
    buffer_load_dwordx4 v1, s[12:15], s29 offen lds
    s_add_u32 m0, s31, 28672
    s_add_u32 s29, s30, 28672
    buffer_load_dwordx4 v1, s[12:15], s29 offen lds
    s_add_u32 m0, s31, 32768
    s_add_u32 s29, s30, 32768
    buffer_load_dwordx4 v1, s[12:15], s29 offen lds
    s_cmp_lg_u32 s39, 0
    s_cbranch_scc1 gemm1kernel_w0_7
    s_lshr_b32 s35, s37, 1
    s_lshl_b32 s35, s35, 2
    s_add_u32 s35, s35, s36
    s_lshl_b32 s35, s35, 10
    s_add_u32 s35, s35, 131072
    v_and_b32 v10, 7, v0
    v_lshlrev_b32 v10, 7, v10
    s_mov_b32 s53, 0
gemm1kernel_p0_8:
    buffer_load_dword v12, v10, s[44:47], s35 offen sc0 sc1
    s_waitcnt vmcnt(0)
    v_cmp_ne_u32 vcc, 1, v12
    s_add_u32 s53, s53, 1
    s_cbranch_vccz gemm1kernel_w0_7
    s_sleep 1
    s_cmp_lt_u32 s53, 0x40000
    s_cbranch_scc1 gemm1kernel_p0_8
gemm1kernel_w0_7:
    s_barrier
    s_add_u32 s29, s28, 0
    buffer_load_dwordx4 v[120:123], v2, s[8:11], s29 offen offset:0 sc0 sc1
    buffer_load_dwordx4 v[124:127], v2, s[8:11], s29 offen offset:256 sc0 sc1
    s_add_u32 s29, s28, 2048
    buffer_load_dwordx4 v[128:131], v2, s[8:11], s29 offen offset:0 sc0 sc1
    buffer_load_dwordx4 v[132:135], v2, s[8:11], s29 offen offset:256 sc0 sc1
    s_add_u32 s29, s28, 4096
    buffer_load_dwordx4 v[136:139], v2, s[8:11], s29 offen offset:0 sc0 sc1
    buffer_load_dwordx4 v[140:143], v2, s[8:11], s29 offen offset:256 sc0 sc1
    s_add_u32 s29, s28, 6144
    buffer_load_dwordx4 v[144:147], v2, s[8:11], s29 offen offset:0 sc0 sc1
    buffer_load_dwordx4 v[148:151], v2, s[8:11], s29 offen offset:256 sc0 sc1
    s_add_u32 s16, s4, 0x6d0000
    s_addc_u32 s17, s5, 0
    s_mov_b32 s18, 0x240000
    s_mov_b32 s19, 0x00020000
    s_mov_b32 s20, s6
    s_mov_b32 s21, s7
    s_mov_b32 s22, 0x240000
    s_mov_b32 s23, 0x00020000
    s_mov_b32 s24, s4
    s_mov_b32 s25, s5
    s_mov_b32 s26, 0x3600
    s_mov_b32 s27, 0x00020000
    s_add_u32 s40, s4, 0x2c80000
    s_addc_u32 s41, s5, 0
    s_mov_b32 s42, 0x1200000
    s_mov_b32 s43, 0x00020000
    s_add_u32 s44, s4, 0x3e80000
    s_addc_u32 s45, s5, 0
    s_mov_b32 s46, 0x98000
    s_mov_b32 s47, 0x00020000
    s_waitcnt vmcnt(14)
    s_barrier
    ds_read_b128 v[88:91], v1 offset:0
    ds_read_b128 v[92:95], v1 offset:1024
    ds_read_b128 v[96:99], v1 offset:2048
    ds_read_b128 v[100:103], v1 offset:3072
    ds_read_b128 v[104:107], v1 offset:4096
    ds_read_b128 v[108:111], v1 offset:5120
    ds_read_b128 v[112:115], v1 offset:6144
    s_waitcnt vmcnt(6)
    s_waitcnt lgkmcnt(4)
    v_mfma_f32_16x16x32_bf16 v[16:19], v[88:91], v[120:123], 0
    ds_read_b128 v[116:119], v1 offset:7168
    v_mfma_f32_16x16x32_bf16 v[52:55], v[88:91], v[124:127], 0
    s_add_u32 m0, s31, 36864
    s_add_u32 s29, s30, 36864
    buffer_load_dwordx4 v1, s[12:15], s29 offen lds
    v_mfma_f32_16x16x32_bf16 v[20:23], v[92:95], v[120:123], 0
    ds_read_b128 v[88:91], v1 offset:8192
    v_mfma_f32_16x16x32_bf16 v[56:59], v[92:95], v[124:127], 0
    s_add_u32 s29, s28, 8192
    buffer_load_dwordx4 v[152:155], v2, s[8:11], s29 offen offset:0 sc0 sc1
    buffer_load_dwordx4 v[156:159], v2, s[8:11], s29 offen offset:256 sc0 sc1
    s_barrier
    v_mfma_f32_16x16x32_bf16 v[24:27], v[96:99], v[120:123], 0
    ds_read_b128 v[92:95], v1 offset:9216
    v_mfma_f32_16x16x32_bf16 v[60:63], v[96:99], v[124:127], 0
    s_add_u32 m0, s31, 40960
    s_add_u32 s29, s30, 40960
    buffer_load_dwordx4 v1, s[12:15], s29 offen lds
    s_waitcnt lgkmcnt(4)
    v_mfma_f32_16x16x32_bf16 v[28:31], v[100:103], v[120:123], 0
    ds_read_b128 v[96:99], v1 offset:10240
    v_mfma_f32_16x16x32_bf16 v[64:67], v[100:103], v[124:127], 0
    s_add_u32 m0, s31, 45056
    s_add_u32 s29, s30, 45056
    buffer_load_dwordx4 v1, s[12:15], s29 offen lds
    v_mfma_f32_16x16x32_bf16 v[32:35], v[104:107], v[120:123], 0
    ds_read_b128 v[100:103], v1 offset:11264
    v_mfma_f32_16x16x32_bf16 v[68:71], v[104:107], v[124:127], 0
    v_mfma_f32_16x16x32_bf16 v[36:39], v[108:111], v[120:123], 0
    ds_read_b128 v[104:107], v1 offset:12288
    v_mfma_f32_16x16x32_bf16 v[72:75], v[108:111], v[124:127], 0
    s_add_u32 s29, s28, 10240
    buffer_load_dwordx4 v[160:163], v2, s[8:11], s29 offen offset:0 sc0 sc1
    buffer_load_dwordx4 v[164:167], v2, s[8:11], s29 offen offset:256 sc0 sc1
    s_waitcnt lgkmcnt(4)
    v_mfma_f32_16x16x32_bf16 v[40:43], v[112:115], v[120:123], 0
    ds_read_b128 v[108:111], v1 offset:13312
    v_mfma_f32_16x16x32_bf16 v[76:79], v[112:115], v[124:127], 0
    s_add_u32 m0, s31, 49152
    s_add_u32 s29, s30, 49152
    buffer_load_dwordx4 v1, s[12:15], s29 offen lds
    v_mfma_f32_16x16x32_bf16 v[44:47], v[116:119], v[120:123], 0
    ds_read_b128 v[112:115], v1 offset:14336
    v_mfma_f32_16x16x32_bf16 v[80:83], v[116:119], v[124:127], 0
    v_mfma_f32_16x16x32_bf16 v[48:51], v[88:91], v[120:123], 0
    ds_read_b128 v[116:119], v1 offset:15360
    v_mfma_f32_16x16x32_bf16 v[84:87], v[88:91], v[124:127], 0
    s_add_u32 m0, s31, 53248
    s_add_u32 s29, s30, 53248
    buffer_load_dwordx4 v1, s[12:15], s29 offen lds
    s_waitcnt vmcnt(13)
    s_waitcnt lgkmcnt(4)
    v_mfma_f32_16x16x32_bf16 v[16:19], v[92:95], v[128:131], v[16:19]
    ds_read_b128 v[88:91], v1 offset:16384
    v_mfma_f32_16x16x32_bf16 v[52:55], v[92:95], v[132:135], v[52:55]
    s_add_u32 m0, s31, 57344
    s_add_u32 s29, s30, 57344
    buffer_load_dwordx4 v1, s[12:15], s29 offen lds
    v_mfma_f32_16x16x32_bf16 v[20:23], v[96:99], v[128:131], v[20:23]
    ds_read_b128 v[92:95], v1 offset:17408
    v_mfma_f32_16x16x32_bf16 v[56:59], v[96:99], v[132:135], v[56:59]
    s_add_u32 s29, s28, 12288
    buffer_load_dwordx4 v[120:123], v2, s[8:11], s29 offen offset:0 sc0 sc1
    buffer_load_dwordx4 v[124:127], v2, s[8:11], s29 offen offset:256 sc0 sc1
    s_barrier
    v_mfma_f32_16x16x32_bf16 v[24:27], v[100:103], v[128:131], v[24:27]
    ds_read_b128 v[96:99], v1 offset:18432
    v_mfma_f32_16x16x32_bf16 v[60:63], v[100:103], v[132:135], v[60:63]
    s_add_u32 m0, s31, 61440
    s_add_u32 s29, s30, 61440
    buffer_load_dwordx4 v1, s[12:15], s29 offen lds
    s_waitcnt lgkmcnt(4)
    v_mfma_f32_16x16x32_bf16 v[28:31], v[104:107], v[128:131], v[28:31]
    ds_read_b128 v[100:103], v1 offset:19456
    v_mfma_f32_16x16x32_bf16 v[64:67], v[104:107], v[132:135], v[64:67]
    v_mfma_f32_16x16x32_bf16 v[32:35], v[108:111], v[128:131], v[32:35]
    ds_read_b128 v[104:107], v1 offset:20480
    v_mfma_f32_16x16x32_bf16 v[68:71], v[108:111], v[132:135], v[68:71]
    v_mfma_f32_16x16x32_bf16 v[36:39], v[112:115], v[128:131], v[36:39]
    ds_read_b128 v[108:111], v1 offset:21504
    v_mfma_f32_16x16x32_bf16 v[72:75], v[112:115], v[132:135], v[72:75]
    s_waitcnt lgkmcnt(4)
    v_mfma_f32_16x16x32_bf16 v[40:43], v[116:119], v[128:131], v[40:43]
    ds_read_b128 v[112:115], v1 offset:22528
    v_mfma_f32_16x16x32_bf16 v[76:79], v[116:119], v[132:135], v[76:79]
    s_add_u32 m0, s31, 65536
    s_add_u32 s29, s30, 65536
    buffer_load_dwordx4 v1, s[12:15], s29 offen lds
    v_mfma_f32_16x16x32_bf16 v[44:47], v[88:91], v[128:131], v[44:47]
    ds_read_b128 v[116:119], v1 offset:23552
    v_mfma_f32_16x16x32_bf16 v[80:83], v[88:91], v[132:135], v[80:83]
    v_mfma_f32_16x16x32_bf16 v[48:51], v[92:95], v[128:131], v[48:51]
    ds_read_b128 v[88:91], v1 offset:24576
    v_mfma_f32_16x16x32_bf16 v[84:87], v[92:95], v[132:135], v[84:87]
    s_add_u32 m0, s31, 69632
    s_add_u32 s29, s30, 69632
    buffer_load_dwordx4 v1, s[12:15], s29 offen lds
    s_waitcnt vmcnt(17)
    s_waitcnt lgkmcnt(4)
    v_mfma_f32_16x16x32_bf16 v[16:19], v[96:99], v[136:139], v[16:19]
    ds_read_b128 v[92:95], v1 offset:25600
    v_mfma_f32_16x16x32_bf16 v[52:55], v[96:99], v[140:143], v[52:55]
    s_add_u32 m0, s31, 0
    s_add_u32 s29, s30, 73728
    buffer_load_dwordx4 v1, s[12:15], s29 offen lds
    v_mfma_f32_16x16x32_bf16 v[20:23], v[100:103], v[136:139], v[20:23]
    ds_read_b128 v[96:99], v1 offset:26624
    v_mfma_f32_16x16x32_bf16 v[56:59], v[100:103], v[140:143], v[56:59]
    s_add_u32 s29, s28, 14336
    buffer_load_dwordx4 v[128:131], v2, s[8:11], s29 offen offset:0 sc0 sc1
    buffer_load_dwordx4 v[132:135], v2, s[8:11], s29 offen offset:256 sc0 sc1
    v_mfma_f32_16x16x32_bf16 v[24:27], v[104:107], v[136:139], v[24:27]
    ds_read_b128 v[100:103], v1 offset:27648
    v_mfma_f32_16x16x32_bf16 v[60:63], v[104:107], v[140:143], v[60:63]
    s_add_u32 m0, s31, 4096
    s_add_u32 s29, s30, 77824
    buffer_load_dwordx4 v1, s[12:15], s29 offen lds
    s_waitcnt lgkmcnt(4)
    v_mfma_f32_16x16x32_bf16 v[28:31], v[108:111], v[136:139], v[28:31]
    ds_read_b128 v[104:107], v1 offset:28672
    v_mfma_f32_16x16x32_bf16 v[64:67], v[108:111], v[140:143], v[64:67]
    v_mfma_f32_16x16x32_bf16 v[32:35], v[112:115], v[136:139], v[32:35]
    ds_read_b128 v[108:111], v1 offset:29696
    v_mfma_f32_16x16x32_bf16 v[68:71], v[112:115], v[140:143], v[68:71]
    v_mfma_f32_16x16x32_bf16 v[36:39], v[116:119], v[136:139], v[36:39]
    ds_read_b128 v[112:115], v1 offset:30720
    v_mfma_f32_16x16x32_bf16 v[72:75], v[116:119], v[140:143], v[72:75]
    s_waitcnt lgkmcnt(4)
    v_mfma_f32_16x16x32_bf16 v[40:43], v[88:91], v[136:139], v[40:43]
    ds_read_b128 v[116:119], v1 offset:31744
    v_mfma_f32_16x16x32_bf16 v[76:79], v[88:91], v[140:143], v[76:79]
    v_mfma_f32_16x16x32_bf16 v[44:47], v[92:95], v[136:139], v[44:47]
    ds_read_b128 v[88:91], v1 offset:32768
    v_mfma_f32_16x16x32_bf16 v[80:83], v[92:95], v[140:143], v[80:83]
    v_mfma_f32_16x16x32_bf16 v[48:51], v[96:99], v[136:139], v[48:51]
    ds_read_b128 v[92:95], v1 offset:33792
    v_mfma_f32_16x16x32_bf16 v[84:87], v[96:99], v[140:143], v[84:87]
    s_waitcnt vmcnt(19)
    s_waitcnt lgkmcnt(4)
    v_mfma_f32_16x16x32_bf16 v[16:19], v[100:103], v[144:147], v[16:19]
    ds_read_b128 v[96:99], v1 offset:34816
    v_mfma_f32_16x16x32_bf16 v[52:55], v[100:103], v[148:151], v[52:55]
    v_mfma_f32_16x16x32_bf16 v[20:23], v[104:107], v[144:147], v[20:23]
    ds_read_b128 v[100:103], v1 offset:35840
    v_mfma_f32_16x16x32_bf16 v[56:59], v[104:107], v[148:151], v[56:59]
    s_add_u32 s29, s28, 16384
    buffer_load_dwordx4 v[136:139], v2, s[8:11], s29 offen offset:0 sc0 sc1
    buffer_load_dwordx4 v[140:143], v2, s[8:11], s29 offen offset:256 sc0 sc1
    s_waitcnt vmcnt(12)
    s_barrier
    v_mfma_f32_16x16x32_bf16 v[24:27], v[108:111], v[144:147], v[24:27]
    ds_read_b128 v[104:107], v1 offset:36864
    v_mfma_f32_16x16x32_bf16 v[60:63], v[108:111], v[148:151], v[60:63]
    s_add_u32 m0, s31, 8192
    s_add_u32 s29, s30, 81920
    buffer_load_dwordx4 v1, s[12:15], s29 offen lds
    s_waitcnt lgkmcnt(4)
    v_mfma_f32_16x16x32_bf16 v[28:31], v[112:115], v[144:147], v[28:31]
    ds_read_b128 v[108:111], v1 offset:37888
    v_mfma_f32_16x16x32_bf16 v[64:67], v[112:115], v[148:151], v[64:67]
    v_mfma_f32_16x16x32_bf16 v[32:35], v[116:119], v[144:147], v[32:35]
    ds_read_b128 v[112:115], v1 offset:38912
    v_mfma_f32_16x16x32_bf16 v[68:71], v[116:119], v[148:151], v[68:71]
    v_mfma_f32_16x16x32_bf16 v[36:39], v[88:91], v[144:147], v[36:39]
    ds_read_b128 v[116:119], v1 offset:39936
    v_mfma_f32_16x16x32_bf16 v[72:75], v[88:91], v[148:151], v[72:75]
    s_waitcnt lgkmcnt(4)
    v_mfma_f32_16x16x32_bf16 v[40:43], v[92:95], v[144:147], v[40:43]
    ds_read_b128 v[88:91], v1 offset:40960
    v_mfma_f32_16x16x32_bf16 v[76:79], v[92:95], v[148:151], v[76:79]
    s_add_u32 m0, s31, 12288
    s_add_u32 s29, s30, 86016
    buffer_load_dwordx4 v1, s[12:15], s29 offen lds
    v_mfma_f32_16x16x32_bf16 v[44:47], v[96:99], v[144:147], v[44:47]
    ds_read_b128 v[92:95], v1 offset:41984
    v_mfma_f32_16x16x32_bf16 v[80:83], v[96:99], v[148:151], v[80:83]
    v_mfma_f32_16x16x32_bf16 v[48:51], v[100:103], v[144:147], v[48:51]
    ds_read_b128 v[96:99], v1 offset:43008
    v_mfma_f32_16x16x32_bf16 v[84:87], v[100:103], v[148:151], v[84:87]
    s_add_u32 m0, s31, 16384
    s_add_u32 s29, s30, 90112
    buffer_load_dwordx4 v1, s[12:15], s29 offen lds
    s_waitcnt lgkmcnt(4)
    v_mfma_f32_16x16x32_bf16 v[16:19], v[104:107], v[152:155], v[16:19]
    ds_read_b128 v[100:103], v1 offset:44032
    v_mfma_f32_16x16x32_bf16 v[52:55], v[104:107], v[156:159], v[52:55]
    s_add_u32 m0, s31, 20480
    s_add_u32 s29, s30, 94208
    buffer_load_dwordx4 v1, s[12:15], s29 offen lds
    v_mfma_f32_16x16x32_bf16 v[20:23], v[108:111], v[152:155], v[20:23]
    ds_read_b128 v[104:107], v1 offset:45056
    v_mfma_f32_16x16x32_bf16 v[56:59], v[108:111], v[156:159], v[56:59]
    s_add_u32 s29, s28, 18432
    buffer_load_dwordx4 v[144:147], v2, s[8:11], s29 offen offset:0 sc0 sc1
    buffer_load_dwordx4 v[148:151], v2, s[8:11], s29 offen offset:256 sc0 sc1
    v_mfma_f32_16x16x32_bf16 v[24:27], v[112:115], v[152:155], v[24:27]
    ds_read_b128 v[108:111], v1 offset:46080
    v_mfma_f32_16x16x32_bf16 v[60:63], v[112:115], v[156:159], v[60:63]
    s_add_u32 m0, s31, 24576
    s_add_u32 s29, s30, 98304
    buffer_load_dwordx4 v1, s[12:15], s29 offen lds
    s_waitcnt lgkmcnt(4)
    v_mfma_f32_16x16x32_bf16 v[28:31], v[116:119], v[152:155], v[28:31]
    ds_read_b128 v[112:115], v1 offset:47104
    v_mfma_f32_16x16x32_bf16 v[64:67], v[116:119], v[156:159], v[64:67]
    v_mfma_f32_16x16x32_bf16 v[32:35], v[88:91], v[152:155], v[32:35]
    ds_read_b128 v[116:119], v1 offset:48128
    v_mfma_f32_16x16x32_bf16 v[68:71], v[88:91], v[156:159], v[68:71]
    v_mfma_f32_16x16x32_bf16 v[36:39], v[92:95], v[152:155], v[36:39]
    ds_read_b128 v[88:91], v1 offset:49152
    v_mfma_f32_16x16x32_bf16 v[72:75], v[92:95], v[156:159], v[72:75]
    s_waitcnt lgkmcnt(4)
    v_mfma_f32_16x16x32_bf16 v[40:43], v[96:99], v[152:155], v[40:43]
    ds_read_b128 v[92:95], v1 offset:50176
    v_mfma_f32_16x16x32_bf16 v[76:79], v[96:99], v[156:159], v[76:79]
    v_mfma_f32_16x16x32_bf16 v[44:47], v[100:103], v[152:155], v[44:47]
    ds_read_b128 v[96:99], v1 offset:51200
    v_mfma_f32_16x16x32_bf16 v[80:83], v[100:103], v[156:159], v[80:83]
    v_mfma_f32_16x16x32_bf16 v[48:51], v[104:107], v[152:155], v[48:51]
    ds_read_b128 v[100:103], v1 offset:52224
    v_mfma_f32_16x16x32_bf16 v[84:87], v[104:107], v[156:159], v[84:87]
    s_waitcnt lgkmcnt(4)
    v_mfma_f32_16x16x32_bf16 v[16:19], v[108:111], v[160:163], v[16:19]
    ds_read_b128 v[104:107], v1 offset:53248
    v_mfma_f32_16x16x32_bf16 v[52:55], v[108:111], v[164:167], v[52:55]
    v_mfma_f32_16x16x32_bf16 v[20:23], v[112:115], v[160:163], v[20:23]
    ds_read_b128 v[108:111], v1 offset:54272
    v_mfma_f32_16x16x32_bf16 v[56:59], v[112:115], v[164:167], v[56:59]
    s_add_u32 s29, s28, 20480
    buffer_load_dwordx4 v[152:155], v2, s[8:11], s29 offen offset:0 sc0 sc1
    buffer_load_dwordx4 v[156:159], v2, s[8:11], s29 offen offset:256 sc0 sc1
    s_waitcnt vmcnt(15)
    s_barrier
    v_mfma_f32_16x16x32_bf16 v[24:27], v[116:119], v[160:163], v[24:27]
    ds_read_b128 v[112:115], v1 offset:55296
    v_mfma_f32_16x16x32_bf16 v[60:63], v[116:119], v[164:167], v[60:63]
    s_add_u32 m0, s31, 28672
    s_add_u32 s29, s30, 102400
    buffer_load_dwordx4 v1, s[12:15], s29 offen lds
    s_waitcnt lgkmcnt(4)
    v_mfma_f32_16x16x32_bf16 v[28:31], v[88:91], v[160:163], v[28:31]
    ds_read_b128 v[116:119], v1 offset:56320
    v_mfma_f32_16x16x32_bf16 v[64:67], v[88:91], v[164:167], v[64:67]
    v_mfma_f32_16x16x32_bf16 v[32:35], v[92:95], v[160:163], v[32:35]
    ds_read_b128 v[88:91], v1 offset:57344
    v_mfma_f32_16x16x32_bf16 v[68:71], v[92:95], v[164:167], v[68:71]
    v_mfma_f32_16x16x32_bf16 v[36:39], v[96:99], v[160:163], v[36:39]
    ds_read_b128 v[92:95], v1 offset:58368
    v_mfma_f32_16x16x32_bf16 v[72:75], v[96:99], v[164:167], v[72:75]
    s_waitcnt lgkmcnt(4)
    v_mfma_f32_16x16x32_bf16 v[40:43], v[100:103], v[160:163], v[40:43]
    ds_read_b128 v[96:99], v1 offset:59392
    v_mfma_f32_16x16x32_bf16 v[76:79], v[100:103], v[164:167], v[76:79]
    s_add_u32 m0, s31, 32768
    s_add_u32 s29, s30, 106496
    buffer_load_dwordx4 v1, s[12:15], s29 offen lds
    v_mfma_f32_16x16x32_bf16 v[44:47], v[104:107], v[160:163], v[44:47]
    ds_read_b128 v[100:103], v1 offset:60416
    v_mfma_f32_16x16x32_bf16 v[80:83], v[104:107], v[164:167], v[80:83]
    v_mfma_f32_16x16x32_bf16 v[48:51], v[108:111], v[160:163], v[48:51]
    ds_read_b128 v[104:107], v1 offset:61440
    v_mfma_f32_16x16x32_bf16 v[84:87], v[108:111], v[164:167], v[84:87]
    s_add_u32 m0, s31, 36864
    s_add_u32 s29, s30, 110592
    buffer_load_dwordx4 v1, s[12:15], s29 offen lds
    s_waitcnt lgkmcnt(4)
    v_mfma_f32_16x16x32_bf16 v[16:19], v[112:115], v[120:123], v[16:19]
    ds_read_b128 v[108:111], v1 offset:62464
    v_mfma_f32_16x16x32_bf16 v[52:55], v[112:115], v[124:127], v[52:55]
    s_add_u32 m0, s31, 40960
    s_add_u32 s29, s30, 114688
    buffer_load_dwordx4 v1, s[12:15], s29 offen lds
    v_mfma_f32_16x16x32_bf16 v[20:23], v[116:119], v[120:123], v[20:23]
    ds_read_b128 v[112:115], v1 offset:63488
    v_mfma_f32_16x16x32_bf16 v[56:59], v[116:119], v[124:127], v[56:59]
    s_add_u32 s29, s28, 22528
    buffer_load_dwordx4 v[160:163], v2, s[8:11], s29 offen offset:0 sc0 sc1
    buffer_load_dwordx4 v[164:167], v2, s[8:11], s29 offen offset:256 sc0 sc1
    v_mfma_f32_16x16x32_bf16 v[24:27], v[88:91], v[120:123], v[24:27]
    ds_read_b128 v[116:119], v1 offset:64512
    v_mfma_f32_16x16x32_bf16 v[60:63], v[88:91], v[124:127], v[60:63]
    s_waitcnt lgkmcnt(4)
    v_mfma_f32_16x16x32_bf16 v[28:31], v[92:95], v[120:123], v[28:31]
    ds_read_b128 v[88:91], v3 offset:0
    v_mfma_f32_16x16x32_bf16 v[64:67], v[92:95], v[124:127], v[64:67]
    v_mfma_f32_16x16x32_bf16 v[32:35], v[96:99], v[120:123], v[32:35]
    ds_read_b128 v[92:95], v3 offset:1024
    v_mfma_f32_16x16x32_bf16 v[68:71], v[96:99], v[124:127], v[68:71]
    v_mfma_f32_16x16x32_bf16 v[36:39], v[100:103], v[120:123], v[36:39]
    ds_read_b128 v[96:99], v3 offset:2048
    v_mfma_f32_16x16x32_bf16 v[72:75], v[100:103], v[124:127], v[72:75]
    s_waitcnt lgkmcnt(4)
    v_mfma_f32_16x16x32_bf16 v[40:43], v[104:107], v[120:123], v[40:43]
    ds_read_b128 v[100:103], v3 offset:3072
    v_mfma_f32_16x16x32_bf16 v[76:79], v[104:107], v[124:127], v[76:79]
    v_mfma_f32_16x16x32_bf16 v[44:47], v[108:111], v[120:123], v[44:47]
    ds_read_b128 v[104:107], v3 offset:4096
    v_mfma_f32_16x16x32_bf16 v[80:83], v[108:111], v[124:127], v[80:83]
    v_mfma_f32_16x16x32_bf16 v[48:51], v[112:115], v[120:123], v[48:51]
    ds_read_b128 v[108:111], v3 offset:5120
    v_mfma_f32_16x16x32_bf16 v[84:87], v[112:115], v[124:127], v[84:87]
    s_waitcnt vmcnt(18)
    s_waitcnt lgkmcnt(4)
    v_mfma_f32_16x16x32_bf16 v[16:19], v[116:119], v[128:131], v[16:19]
    ds_read_b128 v[112:115], v3 offset:6144
    v_mfma_f32_16x16x32_bf16 v[52:55], v[116:119], v[132:135], v[52:55]
    v_mfma_f32_16x16x32_bf16 v[20:23], v[88:91], v[128:131], v[20:23]
    ds_read_b128 v[116:119], v3 offset:7168
    v_mfma_f32_16x16x32_bf16 v[56:59], v[88:91], v[132:135], v[56:59]
    s_add_u32 s29, s28, 24576
    buffer_load_dwordx4 v[120:123], v2, s[8:11], s29 offen offset:0 sc0 sc1
    buffer_load_dwordx4 v[124:127], v2, s[8:11], s29 offen offset:256 sc0 sc1
    s_waitcnt vmcnt(14)
    s_barrier
    v_mfma_f32_16x16x32_bf16 v[24:27], v[92:95], v[128:131], v[24:27]
    ds_read_b128 v[88:91], v1 offset:0
    v_mfma_f32_16x16x32_bf16 v[60:63], v[92:95], v[132:135], v[60:63]
    s_add_u32 m0, s31, 45056
    s_add_u32 s29, s30, 118784
    buffer_load_dwordx4 v1, s[12:15], s29 offen lds
    s_waitcnt lgkmcnt(4)
    v_mfma_f32_16x16x32_bf16 v[28:31], v[96:99], v[128:131], v[28:31]
    ds_read_b128 v[92:95], v1 offset:1024
    v_mfma_f32_16x16x32_bf16 v[64:67], v[96:99], v[132:135], v[64:67]
    v_mfma_f32_16x16x32_bf16 v[32:35], v[100:103], v[128:131], v[32:35]
    ds_read_b128 v[96:99], v1 offset:2048
    v_mfma_f32_16x16x32_bf16 v[68:71], v[100:103], v[132:135], v[68:71]
    v_mfma_f32_16x16x32_bf16 v[36:39], v[104:107], v[128:131], v[36:39]
    ds_read_b128 v[100:103], v1 offset:3072
    v_mfma_f32_16x16x32_bf16 v[72:75], v[104:107], v[132:135], v[72:75]
    s_waitcnt lgkmcnt(4)
    v_mfma_f32_16x16x32_bf16 v[40:43], v[108:111], v[128:131], v[40:43]
    ds_read_b128 v[104:107], v1 offset:4096
    v_mfma_f32_16x16x32_bf16 v[76:79], v[108:111], v[132:135], v[76:79]
    s_add_u32 m0, s31, 49152
    s_add_u32 s29, s30, 122880
    buffer_load_dwordx4 v1, s[12:15], s29 offen lds
    v_mfma_f32_16x16x32_bf16 v[44:47], v[112:115], v[128:131], v[44:47]
    ds_read_b128 v[108:111], v1 offset:5120
    v_mfma_f32_16x16x32_bf16 v[80:83], v[112:115], v[132:135], v[80:83]
    v_mfma_f32_16x16x32_bf16 v[48:51], v[116:119], v[128:131], v[48:51]
    ds_read_b128 v[112:115], v1 offset:6144
    v_mfma_f32_16x16x32_bf16 v[84:87], v[116:119], v[132:135], v[84:87]
    s_add_u32 m0, s31, 53248
    s_add_u32 s29, s30, 126976
    buffer_load_dwordx4 v1, s[12:15], s29 offen lds
    s_waitcnt lgkmcnt(4)
    v_mfma_f32_16x16x32_bf16 v[16:19], v[88:91], v[136:139], v[16:19]
    ds_read_b128 v[116:119], v1 offset:7168
    v_mfma_f32_16x16x32_bf16 v[52:55], v[88:91], v[140:143], v[52:55]
    s_add_u32 m0, s31, 57344
    s_add_u32 s29, s30, 131072
    buffer_load_dwordx4 v1, s[12:15], s29 offen lds
    v_mfma_f32_16x16x32_bf16 v[20:23], v[92:95], v[136:139], v[20:23]
    ds_read_b128 v[88:91], v1 offset:8192
    v_mfma_f32_16x16x32_bf16 v[56:59], v[92:95], v[140:143], v[56:59]
    s_add_u32 s29, s28, 26624
    buffer_load_dwordx4 v[128:131], v2, s[8:11], s29 offen offset:0 sc0 sc1
    buffer_load_dwordx4 v[132:135], v2, s[8:11], s29 offen offset:256 sc0 sc1
    v_mfma_f32_16x16x32_bf16 v[24:27], v[96:99], v[136:139], v[24:27]
    ds_read_b128 v[92:95], v1 offset:9216
    v_mfma_f32_16x16x32_bf16 v[60:63], v[96:99], v[140:143], v[60:63]
    s_add_u32 m0, s31, 61440
    s_add_u32 s29, s30, 135168
    buffer_load_dwordx4 v1, s[12:15], s29 offen lds
    s_waitcnt lgkmcnt(4)
    v_mfma_f32_16x16x32_bf16 v[28:31], v[100:103], v[136:139], v[28:31]
    ds_read_b128 v[96:99], v1 offset:10240
    v_mfma_f32_16x16x32_bf16 v[64:67], v[100:103], v[140:143], v[64:67]
    v_mfma_f32_16x16x32_bf16 v[32:35], v[104:107], v[136:139], v[32:35]
    ds_read_b128 v[100:103], v1 offset:11264
    v_mfma_f32_16x16x32_bf16 v[68:71], v[104:107], v[140:143], v[68:71]
    v_mfma_f32_16x16x32_bf16 v[36:39], v[108:111], v[136:139], v[36:39]
    ds_read_b128 v[104:107], v1 offset:12288
    v_mfma_f32_16x16x32_bf16 v[72:75], v[108:111], v[140:143], v[72:75]
    s_waitcnt lgkmcnt(4)
    v_mfma_f32_16x16x32_bf16 v[40:43], v[112:115], v[136:139], v[40:43]
    ds_read_b128 v[108:111], v1 offset:13312
    v_mfma_f32_16x16x32_bf16 v[76:79], v[112:115], v[140:143], v[76:79]
    v_mfma_f32_16x16x32_bf16 v[44:47], v[116:119], v[136:139], v[44:47]
    ds_read_b128 v[112:115], v1 offset:14336
    v_mfma_f32_16x16x32_bf16 v[80:83], v[116:119], v[140:143], v[80:83]
    v_mfma_f32_16x16x32_bf16 v[48:51], v[88:91], v[136:139], v[48:51]
    ds_read_b128 v[116:119], v1 offset:15360
    v_mfma_f32_16x16x32_bf16 v[84:87], v[88:91], v[140:143], v[84:87]
    s_waitcnt vmcnt(18)
    s_waitcnt lgkmcnt(4)
    v_mfma_f32_16x16x32_bf16 v[16:19], v[92:95], v[144:147], v[16:19]
    ds_read_b128 v[88:91], v1 offset:16384
    v_mfma_f32_16x16x32_bf16 v[52:55], v[92:95], v[148:151], v[52:55]
    v_mfma_f32_16x16x32_bf16 v[20:23], v[96:99], v[144:147], v[20:23]
    ds_read_b128 v[92:95], v1 offset:17408
    v_mfma_f32_16x16x32_bf16 v[56:59], v[96:99], v[148:151], v[56:59]
    s_add_u32 s29, s28, 28672
    buffer_load_dwordx4 v[136:139], v2, s[8:11], s29 offen offset:0 sc0 sc1
    buffer_load_dwordx4 v[140:143], v2, s[8:11], s29 offen offset:256 sc0 sc1
    s_waitcnt vmcnt(15)
    s_barrier
    v_mfma_f32_16x16x32_bf16 v[24:27], v[100:103], v[144:147], v[24:27]
    ds_read_b128 v[96:99], v1 offset:18432
    v_mfma_f32_16x16x32_bf16 v[60:63], v[100:103], v[148:151], v[60:63]
    s_add_u32 m0, s31, 65536
    s_add_u32 s29, s30, 139264
    buffer_load_dwordx4 v1, s[12:15], s29 offen lds
    s_waitcnt lgkmcnt(4)
    v_mfma_f32_16x16x32_bf16 v[28:31], v[104:107], v[144:147], v[28:31]
    ds_read_b128 v[100:103], v1 offset:19456
    v_mfma_f32_16x16x32_bf16 v[64:67], v[104:107], v[148:151], v[64:67]
    v_mfma_f32_16x16x32_bf16 v[32:35], v[108:111], v[144:147], v[32:35]
    ds_read_b128 v[104:107], v1 offset:20480
    v_mfma_f32_16x16x32_bf16 v[68:71], v[108:111], v[148:151], v[68:71]
    v_mfma_f32_16x16x32_bf16 v[36:39], v[112:115], v[144:147], v[36:39]
    ds_read_b128 v[108:111], v1 offset:21504
    v_mfma_f32_16x16x32_bf16 v[72:75], v[112:115], v[148:151], v[72:75]
    s_waitcnt lgkmcnt(4)
    v_mfma_f32_16x16x32_bf16 v[40:43], v[116:119], v[144:147], v[40:43]
    ds_read_b128 v[112:115], v1 offset:22528
    v_mfma_f32_16x16x32_bf16 v[76:79], v[116:119], v[148:151], v[76:79]
    s_add_u32 m0, s31, 69632
    s_add_u32 s29, s30, 143360
    buffer_load_dwordx4 v1, s[12:15], s29 offen lds
    v_mfma_f32_16x16x32_bf16 v[44:47], v[88:91], v[144:147], v[44:47]
    ds_read_b128 v[116:119], v1 offset:23552
    v_mfma_f32_16x16x32_bf16 v[80:83], v[88:91], v[148:151], v[80:83]
    v_mfma_f32_16x16x32_bf16 v[48:51], v[92:95], v[144:147], v[48:51]
    ds_read_b128 v[88:91], v1 offset:24576
    v_mfma_f32_16x16x32_bf16 v[84:87], v[92:95], v[148:151], v[84:87]
    s_add_u32 m0, s31, 0
    s_add_u32 s29, s30, 147456
    buffer_load_dwordx4 v1, s[12:15], s29 offen lds
    s_waitcnt lgkmcnt(4)
    v_mfma_f32_16x16x32_bf16 v[16:19], v[96:99], v[152:155], v[16:19]
    ds_read_b128 v[92:95], v1 offset:25600
    v_mfma_f32_16x16x32_bf16 v[52:55], v[96:99], v[156:159], v[52:55]
    s_add_u32 m0, s31, 4096
    s_add_u32 s29, s30, 151552
    buffer_load_dwordx4 v1, s[12:15], s29 offen lds
    v_mfma_f32_16x16x32_bf16 v[20:23], v[100:103], v[152:155], v[20:23]
    ds_read_b128 v[96:99], v1 offset:26624
    v_mfma_f32_16x16x32_bf16 v[56:59], v[100:103], v[156:159], v[56:59]
    s_add_u32 s29, s28, 30720
    buffer_load_dwordx4 v[144:147], v2, s[8:11], s29 offen offset:0 sc0 sc1
    buffer_load_dwordx4 v[148:151], v2, s[8:11], s29 offen offset:256 sc0 sc1
    v_mfma_f32_16x16x32_bf16 v[24:27], v[104:107], v[152:155], v[24:27]
    ds_read_b128 v[100:103], v1 offset:27648
    v_mfma_f32_16x16x32_bf16 v[60:63], v[104:107], v[156:159], v[60:63]
    s_waitcnt lgkmcnt(4)
    v_mfma_f32_16x16x32_bf16 v[28:31], v[108:111], v[152:155], v[28:31]
    ds_read_b128 v[104:107], v1 offset:28672
    v_mfma_f32_16x16x32_bf16 v[64:67], v[108:111], v[156:159], v[64:67]
    v_mfma_f32_16x16x32_bf16 v[32:35], v[112:115], v[152:155], v[32:35]
    ds_read_b128 v[108:111], v1 offset:29696
    v_mfma_f32_16x16x32_bf16 v[68:71], v[112:115], v[156:159], v[68:71]
    v_mfma_f32_16x16x32_bf16 v[36:39], v[116:119], v[152:155], v[36:39]
    ds_read_b128 v[112:115], v1 offset:30720
    v_mfma_f32_16x16x32_bf16 v[72:75], v[116:119], v[156:159], v[72:75]
    s_waitcnt lgkmcnt(4)
    v_mfma_f32_16x16x32_bf16 v[40:43], v[88:91], v[152:155], v[40:43]
    ds_read_b128 v[116:119], v1 offset:31744
    v_mfma_f32_16x16x32_bf16 v[76:79], v[88:91], v[156:159], v[76:79]
    v_mfma_f32_16x16x32_bf16 v[44:47], v[92:95], v[152:155], v[44:47]
    ds_read_b128 v[88:91], v1 offset:32768
    v_mfma_f32_16x16x32_bf16 v[80:83], v[92:95], v[156:159], v[80:83]
    v_mfma_f32_16x16x32_bf16 v[48:51], v[96:99], v[152:155], v[48:51]
    ds_read_b128 v[92:95], v1 offset:33792
    v_mfma_f32_16x16x32_bf16 v[84:87], v[96:99], v[156:159], v[84:87]
    s_waitcnt vmcnt(17)
    s_waitcnt lgkmcnt(4)
    v_mfma_f32_16x16x32_bf16 v[16:19], v[100:103], v[160:163], v[16:19]
    ds_read_b128 v[96:99], v1 offset:34816
    v_mfma_f32_16x16x32_bf16 v[52:55], v[100:103], v[164:167], v[52:55]
    v_mfma_f32_16x16x32_bf16 v[20:23], v[104:107], v[160:163], v[20:23]
    ds_read_b128 v[100:103], v1 offset:35840
    v_mfma_f32_16x16x32_bf16 v[56:59], v[104:107], v[164:167], v[56:59]
    s_add_u32 s29, s28, 32768
    buffer_load_dwordx4 v[152:155], v2, s[8:11], s29 offen offset:0 sc0 sc1
    buffer_load_dwordx4 v[156:159], v2, s[8:11], s29 offen offset:256 sc0 sc1
    s_waitcnt vmcnt(14)
    s_barrier
    v_mfma_f32_16x16x32_bf16 v[24:27], v[108:111], v[160:163], v[24:27]
    ds_read_b128 v[104:107], v1 offset:36864
    v_mfma_f32_16x16x32_bf16 v[60:63], v[108:111], v[164:167], v[60:63]
    s_add_u32 m0, s31, 8192
    s_add_u32 s29, s30, 155648
    buffer_load_dwordx4 v1, s[12:15], s29 offen lds
    s_waitcnt lgkmcnt(4)
    v_mfma_f32_16x16x32_bf16 v[28:31], v[112:115], v[160:163], v[28:31]
    ds_read_b128 v[108:111], v1 offset:37888
    v_mfma_f32_16x16x32_bf16 v[64:67], v[112:115], v[164:167], v[64:67]
    v_mfma_f32_16x16x32_bf16 v[32:35], v[116:119], v[160:163], v[32:35]
    ds_read_b128 v[112:115], v1 offset:38912
    v_mfma_f32_16x16x32_bf16 v[68:71], v[116:119], v[164:167], v[68:71]
    v_mfma_f32_16x16x32_bf16 v[36:39], v[88:91], v[160:163], v[36:39]
    ds_read_b128 v[116:119], v1 offset:39936
    v_mfma_f32_16x16x32_bf16 v[72:75], v[88:91], v[164:167], v[72:75]
    s_waitcnt lgkmcnt(4)
    v_mfma_f32_16x16x32_bf16 v[40:43], v[92:95], v[160:163], v[40:43]
    ds_read_b128 v[88:91], v1 offset:40960
    v_mfma_f32_16x16x32_bf16 v[76:79], v[92:95], v[164:167], v[76:79]
    s_add_u32 m0, s31, 12288
    s_add_u32 s29, s30, 159744
    buffer_load_dwordx4 v1, s[12:15], s29 offen lds
    v_mfma_f32_16x16x32_bf16 v[44:47], v[96:99], v[160:163], v[44:47]
    ds_read_b128 v[92:95], v1 offset:41984
    v_mfma_f32_16x16x32_bf16 v[80:83], v[96:99], v[164:167], v[80:83]
    v_mfma_f32_16x16x32_bf16 v[48:51], v[100:103], v[160:163], v[48:51]
    ds_read_b128 v[96:99], v1 offset:43008
    v_mfma_f32_16x16x32_bf16 v[84:87], v[100:103], v[164:167], v[84:87]
    s_add_u32 m0, s31, 16384
    s_add_u32 s29, s30, 163840
    buffer_load_dwordx4 v1, s[12:15], s29 offen lds
    s_waitcnt lgkmcnt(4)
    v_mfma_f32_16x16x32_bf16 v[16:19], v[104:107], v[120:123], v[16:19]
    ds_read_b128 v[100:103], v1 offset:44032
    v_mfma_f32_16x16x32_bf16 v[52:55], v[104:107], v[124:127], v[52:55]
    s_add_u32 m0, s31, 20480
    s_add_u32 s29, s30, 167936
    buffer_load_dwordx4 v1, s[12:15], s29 offen lds
    v_mfma_f32_16x16x32_bf16 v[20:23], v[108:111], v[120:123], v[20:23]
    ds_read_b128 v[104:107], v1 offset:45056
    v_mfma_f32_16x16x32_bf16 v[56:59], v[108:111], v[124:127], v[56:59]
    s_add_u32 s29, s28, 34816
    buffer_load_dwordx4 v[160:163], v2, s[8:11], s29 offen offset:0 sc0 sc1
    buffer_load_dwordx4 v[164:167], v2, s[8:11], s29 offen offset:256 sc0 sc1
    v_mfma_f32_16x16x32_bf16 v[24:27], v[112:115], v[120:123], v[24:27]
    ds_read_b128 v[108:111], v1 offset:46080
    v_mfma_f32_16x16x32_bf16 v[60:63], v[112:115], v[124:127], v[60:63]
    s_add_u32 m0, s31, 24576
    s_add_u32 s29, s30, 172032
    buffer_load_dwordx4 v1, s[12:15], s29 offen lds
    s_waitcnt lgkmcnt(4)
    v_mfma_f32_16x16x32_bf16 v[28:31], v[116:119], v[120:123], v[28:31]
    ds_read_b128 v[112:115], v1 offset:47104
    v_mfma_f32_16x16x32_bf16 v[64:67], v[116:119], v[124:127], v[64:67]
    v_mfma_f32_16x16x32_bf16 v[32:35], v[88:91], v[120:123], v[32:35]
    ds_read_b128 v[116:119], v1 offset:48128
    v_mfma_f32_16x16x32_bf16 v[68:71], v[88:91], v[124:127], v[68:71]
    v_mfma_f32_16x16x32_bf16 v[36:39], v[92:95], v[120:123], v[36:39]
    ds_read_b128 v[88:91], v1 offset:49152
    v_mfma_f32_16x16x32_bf16 v[72:75], v[92:95], v[124:127], v[72:75]
    s_waitcnt lgkmcnt(4)
    v_mfma_f32_16x16x32_bf16 v[40:43], v[96:99], v[120:123], v[40:43]
    ds_read_b128 v[92:95], v1 offset:50176
    v_mfma_f32_16x16x32_bf16 v[76:79], v[96:99], v[124:127], v[76:79]
    v_mfma_f32_16x16x32_bf16 v[44:47], v[100:103], v[120:123], v[44:47]
    ds_read_b128 v[96:99], v1 offset:51200
    v_mfma_f32_16x16x32_bf16 v[80:83], v[100:103], v[124:127], v[80:83]
    v_mfma_f32_16x16x32_bf16 v[48:51], v[104:107], v[120:123], v[48:51]
    ds_read_b128 v[100:103], v1 offset:52224
    v_mfma_f32_16x16x32_bf16 v[84:87], v[104:107], v[124:127], v[84:87]
    s_waitcnt vmcnt(18)
    s_waitcnt lgkmcnt(4)
    v_mfma_f32_16x16x32_bf16 v[16:19], v[108:111], v[128:131], v[16:19]
    ds_read_b128 v[104:107], v1 offset:53248
    v_mfma_f32_16x16x32_bf16 v[52:55], v[108:111], v[132:135], v[52:55]
    v_mfma_f32_16x16x32_bf16 v[20:23], v[112:115], v[128:131], v[20:23]
    ds_read_b128 v[108:111], v1 offset:54272
    v_mfma_f32_16x16x32_bf16 v[56:59], v[112:115], v[132:135], v[56:59]
    s_add_u32 s29, s28, 36864
    buffer_load_dwordx4 v[120:123], v2, s[8:11], s29 offen offset:0 sc0 sc1
    buffer_load_dwordx4 v[124:127], v2, s[8:11], s29 offen offset:256 sc0 sc1
    s_waitcnt vmcnt(15)
    s_barrier
    v_mfma_f32_16x16x32_bf16 v[24:27], v[116:119], v[128:131], v[24:27]
    ds_read_b128 v[112:115], v1 offset:55296
    v_mfma_f32_16x16x32_bf16 v[60:63], v[116:119], v[132:135], v[60:63]
    s_add_u32 m0, s31, 28672
    s_add_u32 s29, s30, 176128
    buffer_load_dwordx4 v1, s[12:15], s29 offen lds
    s_waitcnt lgkmcnt(4)
    v_mfma_f32_16x16x32_bf16 v[28:31], v[88:91], v[128:131], v[28:31]
    ds_read_b128 v[116:119], v1 offset:56320
    v_mfma_f32_16x16x32_bf16 v[64:67], v[88:91], v[132:135], v[64:67]
    v_mfma_f32_16x16x32_bf16 v[32:35], v[92:95], v[128:131], v[32:35]
    ds_read_b128 v[88:91], v1 offset:57344
    v_mfma_f32_16x16x32_bf16 v[68:71], v[92:95], v[132:135], v[68:71]
    v_mfma_f32_16x16x32_bf16 v[36:39], v[96:99], v[128:131], v[36:39]
    ds_read_b128 v[92:95], v1 offset:58368
    v_mfma_f32_16x16x32_bf16 v[72:75], v[96:99], v[132:135], v[72:75]
    s_waitcnt lgkmcnt(4)
    v_mfma_f32_16x16x32_bf16 v[40:43], v[100:103], v[128:131], v[40:43]
    ds_read_b128 v[96:99], v1 offset:59392
    v_mfma_f32_16x16x32_bf16 v[76:79], v[100:103], v[132:135], v[76:79]
    s_add_u32 m0, s31, 32768
    s_add_u32 s29, s30, 180224
    buffer_load_dwordx4 v1, s[12:15], s29 offen lds
    v_mfma_f32_16x16x32_bf16 v[44:47], v[104:107], v[128:131], v[44:47]
    ds_read_b128 v[100:103], v1 offset:60416
    v_mfma_f32_16x16x32_bf16 v[80:83], v[104:107], v[132:135], v[80:83]
    v_mfma_f32_16x16x32_bf16 v[48:51], v[108:111], v[128:131], v[48:51]
    ds_read_b128 v[104:107], v1 offset:61440
    v_mfma_f32_16x16x32_bf16 v[84:87], v[108:111], v[132:135], v[84:87]
    s_add_u32 m0, s31, 36864
    s_add_u32 s29, s30, 184320
    buffer_load_dwordx4 v1, s[12:15], s29 offen lds
    s_waitcnt lgkmcnt(4)
    v_mfma_f32_16x16x32_bf16 v[16:19], v[112:115], v[136:139], v[16:19]
    ds_read_b128 v[108:111], v1 offset:62464
    v_mfma_f32_16x16x32_bf16 v[52:55], v[112:115], v[140:143], v[52:55]
    s_add_u32 m0, s31, 40960
    s_add_u32 s29, s30, 188416
    buffer_load_dwordx4 v1, s[12:15], s29 offen lds
    v_mfma_f32_16x16x32_bf16 v[20:23], v[116:119], v[136:139], v[20:23]
    ds_read_b128 v[112:115], v1 offset:63488
    v_mfma_f32_16x16x32_bf16 v[56:59], v[116:119], v[140:143], v[56:59]
    s_add_u32 s29, s28, 38912
    buffer_load_dwordx4 v[128:131], v2, s[8:11], s29 offen offset:0 sc0 sc1
    buffer_load_dwordx4 v[132:135], v2, s[8:11], s29 offen offset:256 sc0 sc1
    v_mfma_f32_16x16x32_bf16 v[24:27], v[88:91], v[136:139], v[24:27]
    ds_read_b128 v[116:119], v1 offset:64512
    v_mfma_f32_16x16x32_bf16 v[60:63], v[88:91], v[140:143], v[60:63]
    s_waitcnt lgkmcnt(4)
    v_mfma_f32_16x16x32_bf16 v[28:31], v[92:95], v[136:139], v[28:31]
    ds_read_b128 v[88:91], v3 offset:0
    v_mfma_f32_16x16x32_bf16 v[64:67], v[92:95], v[140:143], v[64:67]
    v_mfma_f32_16x16x32_bf16 v[32:35], v[96:99], v[136:139], v[32:35]
    ds_read_b128 v[92:95], v3 offset:1024
    v_mfma_f32_16x16x32_bf16 v[68:71], v[96:99], v[140:143], v[68:71]
    v_mfma_f32_16x16x32_bf16 v[36:39], v[100:103], v[136:139], v[36:39]
    ds_read_b128 v[96:99], v3 offset:2048
    v_mfma_f32_16x16x32_bf16 v[72:75], v[100:103], v[140:143], v[72:75]
    s_waitcnt lgkmcnt(4)
    v_mfma_f32_16x16x32_bf16 v[40:43], v[104:107], v[136:139], v[40:43]
    ds_read_b128 v[100:103], v3 offset:3072
    v_mfma_f32_16x16x32_bf16 v[76:79], v[104:107], v[140:143], v[76:79]
    v_mfma_f32_16x16x32_bf16 v[44:47], v[108:111], v[136:139], v[44:47]
    ds_read_b128 v[104:107], v3 offset:4096
    v_mfma_f32_16x16x32_bf16 v[80:83], v[108:111], v[140:143], v[80:83]
    v_mfma_f32_16x16x32_bf16 v[48:51], v[112:115], v[136:139], v[48:51]
    ds_read_b128 v[108:111], v3 offset:5120
    v_mfma_f32_16x16x32_bf16 v[84:87], v[112:115], v[140:143], v[84:87]
    s_waitcnt vmcnt(17)
    s_waitcnt lgkmcnt(4)
    v_mfma_f32_16x16x32_bf16 v[16:19], v[116:119], v[144:147], v[16:19]
    ds_read_b128 v[112:115], v3 offset:6144
    v_mfma_f32_16x16x32_bf16 v[52:55], v[116:119], v[148:151], v[52:55]
    v_mfma_f32_16x16x32_bf16 v[20:23], v[88:91], v[144:147], v[20:23]
    ds_read_b128 v[116:119], v3 offset:7168
    v_mfma_f32_16x16x32_bf16 v[56:59], v[88:91], v[148:151], v[56:59]
    s_add_u32 s29, s28, 40960
    buffer_load_dwordx4 v[136:139], v2, s[8:11], s29 offen offset:0 sc0 sc1
    buffer_load_dwordx4 v[140:143], v2, s[8:11], s29 offen offset:256 sc0 sc1
    s_waitcnt vmcnt(14)
    s_barrier
    v_mfma_f32_16x16x32_bf16 v[24:27], v[92:95], v[144:147], v[24:27]
    ds_read_b128 v[88:91], v1 offset:0
    v_mfma_f32_16x16x32_bf16 v[60:63], v[92:95], v[148:151], v[60:63]
    s_add_u32 m0, s31, 45056
    s_add_u32 s29, s30, 192512
    buffer_load_dwordx4 v1, s[12:15], s29 offen lds
    s_waitcnt lgkmcnt(4)
    v_mfma_f32_16x16x32_bf16 v[28:31], v[96:99], v[144:147], v[28:31]
    ds_read_b128 v[92:95], v1 offset:1024
    v_mfma_f32_16x16x32_bf16 v[64:67], v[96:99], v[148:151], v[64:67]
    v_mfma_f32_16x16x32_bf16 v[32:35], v[100:103], v[144:147], v[32:35]
    ds_read_b128 v[96:99], v1 offset:2048
    v_mfma_f32_16x16x32_bf16 v[68:71], v[100:103], v[148:151], v[68:71]
    v_mfma_f32_16x16x32_bf16 v[36:39], v[104:107], v[144:147], v[36:39]
    ds_read_b128 v[100:103], v1 offset:3072
    v_mfma_f32_16x16x32_bf16 v[72:75], v[104:107], v[148:151], v[72:75]
    s_waitcnt lgkmcnt(4)
    v_mfma_f32_16x16x32_bf16 v[40:43], v[108:111], v[144:147], v[40:43]
    ds_read_b128 v[104:107], v1 offset:4096
    v_mfma_f32_16x16x32_bf16 v[76:79], v[108:111], v[148:151], v[76:79]
    s_add_u32 m0, s31, 49152
    s_add_u32 s29, s30, 196608
    buffer_load_dwordx4 v1, s[12:15], s29 offen lds
    v_mfma_f32_16x16x32_bf16 v[44:47], v[112:115], v[144:147], v[44:47]
    ds_read_b128 v[108:111], v1 offset:5120
    v_mfma_f32_16x16x32_bf16 v[80:83], v[112:115], v[148:151], v[80:83]
    v_mfma_f32_16x16x32_bf16 v[48:51], v[116:119], v[144:147], v[48:51]
    ds_read_b128 v[112:115], v1 offset:6144
    v_mfma_f32_16x16x32_bf16 v[84:87], v[116:119], v[148:151], v[84:87]
    s_add_u32 m0, s31, 53248
    s_add_u32 s29, s30, 200704
    buffer_load_dwordx4 v1, s[12:15], s29 offen lds
    s_waitcnt lgkmcnt(4)
    v_mfma_f32_16x16x32_bf16 v[16:19], v[88:91], v[152:155], v[16:19]
    ds_read_b128 v[116:119], v1 offset:7168
    v_mfma_f32_16x16x32_bf16 v[52:55], v[88:91], v[156:159], v[52:55]
    s_add_u32 m0, s31, 57344
    s_add_u32 s29, s30, 204800
    buffer_load_dwordx4 v1, s[12:15], s29 offen lds
    v_mfma_f32_16x16x32_bf16 v[20:23], v[92:95], v[152:155], v[20:23]
    ds_read_b128 v[88:91], v1 offset:8192
    v_mfma_f32_16x16x32_bf16 v[56:59], v[92:95], v[156:159], v[56:59]
    s_add_u32 s29, s28, 43008
    buffer_load_dwordx4 v[144:147], v2, s[8:11], s29 offen offset:0 sc0 sc1
    buffer_load_dwordx4 v[148:151], v2, s[8:11], s29 offen offset:256 sc0 sc1
    v_mfma_f32_16x16x32_bf16 v[24:27], v[96:99], v[152:155], v[24:27]
    ds_read_b128 v[92:95], v1 offset:9216
    v_mfma_f32_16x16x32_bf16 v[60:63], v[96:99], v[156:159], v[60:63]
    s_add_u32 m0, s31, 61440
    s_add_u32 s29, s30, 208896
    buffer_load_dwordx4 v1, s[12:15], s29 offen lds
    s_waitcnt lgkmcnt(4)
    v_mfma_f32_16x16x32_bf16 v[28:31], v[100:103], v[152:155], v[28:31]
    ds_read_b128 v[96:99], v1 offset:10240
    v_mfma_f32_16x16x32_bf16 v[64:67], v[100:103], v[156:159], v[64:67]
    v_mfma_f32_16x16x32_bf16 v[32:35], v[104:107], v[152:155], v[32:35]
    ds_read_b128 v[100:103], v1 offset:11264
    v_mfma_f32_16x16x32_bf16 v[68:71], v[104:107], v[156:159], v[68:71]
    v_mfma_f32_16x16x32_bf16 v[36:39], v[108:111], v[152:155], v[36:39]
    ds_read_b128 v[104:107], v1 offset:12288
    v_mfma_f32_16x16x32_bf16 v[72:75], v[108:111], v[156:159], v[72:75]
    s_waitcnt lgkmcnt(4)
    v_mfma_f32_16x16x32_bf16 v[40:43], v[112:115], v[152:155], v[40:43]
    ds_read_b128 v[108:111], v1 offset:13312
    v_mfma_f32_16x16x32_bf16 v[76:79], v[112:115], v[156:159], v[76:79]
    v_mfma_f32_16x16x32_bf16 v[44:47], v[116:119], v[152:155], v[44:47]
    ds_read_b128 v[112:115], v1 offset:14336
    v_mfma_f32_16x16x32_bf16 v[80:83], v[116:119], v[156:159], v[80:83]
    v_mfma_f32_16x16x32_bf16 v[48:51], v[88:91], v[152:155], v[48:51]
    ds_read_b128 v[116:119], v1 offset:15360
    v_mfma_f32_16x16x32_bf16 v[84:87], v[88:91], v[156:159], v[84:87]
    s_waitcnt vmcnt(18)
    s_waitcnt lgkmcnt(4)
    v_mfma_f32_16x16x32_bf16 v[16:19], v[92:95], v[160:163], v[16:19]
    ds_read_b128 v[88:91], v1 offset:16384
    v_mfma_f32_16x16x32_bf16 v[52:55], v[92:95], v[164:167], v[52:55]
    v_mfma_f32_16x16x32_bf16 v[20:23], v[96:99], v[160:163], v[20:23]
    ds_read_b128 v[92:95], v1 offset:17408
    v_mfma_f32_16x16x32_bf16 v[56:59], v[96:99], v[164:167], v[56:59]
    s_add_u32 s29, s28, 45056
    buffer_load_dwordx4 v[152:155], v2, s[8:11], s29 offen offset:0 sc0 sc1
    buffer_load_dwordx4 v[156:159], v2, s[8:11], s29 offen offset:256 sc0 sc1
    s_waitcnt vmcnt(15)
    s_barrier
    v_mfma_f32_16x16x32_bf16 v[24:27], v[100:103], v[160:163], v[24:27]
    ds_read_b128 v[96:99], v1 offset:18432
    v_mfma_f32_16x16x32_bf16 v[60:63], v[100:103], v[164:167], v[60:63]
    s_add_u32 m0, s31, 65536
    s_add_u32 s29, s30, 212992
    buffer_load_dwordx4 v1, s[12:15], s29 offen lds
    s_waitcnt lgkmcnt(4)
    v_mfma_f32_16x16x32_bf16 v[28:31], v[104:107], v[160:163], v[28:31]
    ds_read_b128 v[100:103], v1 offset:19456
    v_mfma_f32_16x16x32_bf16 v[64:67], v[104:107], v[164:167], v[64:67]
    v_mfma_f32_16x16x32_bf16 v[32:35], v[108:111], v[160:163], v[32:35]
    ds_read_b128 v[104:107], v1 offset:20480
    v_mfma_f32_16x16x32_bf16 v[68:71], v[108:111], v[164:167], v[68:71]
    v_mfma_f32_16x16x32_bf16 v[36:39], v[112:115], v[160:163], v[36:39]
    ds_read_b128 v[108:111], v1 offset:21504
    v_mfma_f32_16x16x32_bf16 v[72:75], v[112:115], v[164:167], v[72:75]
    s_waitcnt lgkmcnt(4)
    v_mfma_f32_16x16x32_bf16 v[40:43], v[116:119], v[160:163], v[40:43]
    ds_read_b128 v[112:115], v1 offset:22528
    v_mfma_f32_16x16x32_bf16 v[76:79], v[116:119], v[164:167], v[76:79]
    s_add_u32 m0, s31, 69632
    s_add_u32 s29, s30, 217088
    buffer_load_dwordx4 v1, s[12:15], s29 offen lds
    v_mfma_f32_16x16x32_bf16 v[44:47], v[88:91], v[160:163], v[44:47]
    ds_read_b128 v[116:119], v1 offset:23552
    v_mfma_f32_16x16x32_bf16 v[80:83], v[88:91], v[164:167], v[80:83]
    v_mfma_f32_16x16x32_bf16 v[48:51], v[92:95], v[160:163], v[48:51]
    ds_read_b128 v[88:91], v1 offset:24576
    v_mfma_f32_16x16x32_bf16 v[84:87], v[92:95], v[164:167], v[84:87]
    s_add_u32 m0, s31, 0
    s_add_u32 s29, s30, 221184
    buffer_load_dwordx4 v1, s[12:15], s29 offen lds
    s_waitcnt lgkmcnt(4)
    v_mfma_f32_16x16x32_bf16 v[16:19], v[96:99], v[120:123], v[16:19]
    ds_read_b128 v[92:95], v1 offset:25600
    v_mfma_f32_16x16x32_bf16 v[52:55], v[96:99], v[124:127], v[52:55]
    s_add_u32 m0, s31, 4096
    s_add_u32 s29, s30, 225280
    buffer_load_dwordx4 v1, s[12:15], s29 offen lds
    v_mfma_f32_16x16x32_bf16 v[20:23], v[100:103], v[120:123], v[20:23]
    ds_read_b128 v[96:99], v1 offset:26624
    v_mfma_f32_16x16x32_bf16 v[56:59], v[100:103], v[124:127], v[56:59]
    s_add_u32 s29, s28, 47104
    buffer_load_dwordx4 v[160:163], v2, s[8:11], s29 offen offset:0 sc0 sc1
    buffer_load_dwordx4 v[164:167], v2, s[8:11], s29 offen offset:256 sc0 sc1
    v_mfma_f32_16x16x32_bf16 v[24:27], v[104:107], v[120:123], v[24:27]
    ds_read_b128 v[100:103], v1 offset:27648
    v_mfma_f32_16x16x32_bf16 v[60:63], v[104:107], v[124:127], v[60:63]
    s_waitcnt lgkmcnt(4)
    v_mfma_f32_16x16x32_bf16 v[28:31], v[108:111], v[120:123], v[28:31]
    ds_read_b128 v[104:107], v1 offset:28672
    v_mfma_f32_16x16x32_bf16 v[64:67], v[108:111], v[124:127], v[64:67]
    v_mfma_f32_16x16x32_bf16 v[32:35], v[112:115], v[120:123], v[32:35]
    ds_read_b128 v[108:111], v1 offset:29696
    v_mfma_f32_16x16x32_bf16 v[68:71], v[112:115], v[124:127], v[68:71]
    v_mfma_f32_16x16x32_bf16 v[36:39], v[116:119], v[120:123], v[36:39]
    ds_read_b128 v[112:115], v1 offset:30720
    v_mfma_f32_16x16x32_bf16 v[72:75], v[116:119], v[124:127], v[72:75]
    s_waitcnt lgkmcnt(4)
    v_mfma_f32_16x16x32_bf16 v[40:43], v[88:91], v[120:123], v[40:43]
    ds_read_b128 v[116:119], v1 offset:31744
    v_mfma_f32_16x16x32_bf16 v[76:79], v[88:91], v[124:127], v[76:79]
    v_mfma_f32_16x16x32_bf16 v[44:47], v[92:95], v[120:123], v[44:47]
    ds_read_b128 v[88:91], v1 offset:32768
    v_mfma_f32_16x16x32_bf16 v[80:83], v[92:95], v[124:127], v[80:83]
    v_mfma_f32_16x16x32_bf16 v[48:51], v[96:99], v[120:123], v[48:51]
    ds_read_b128 v[92:95], v1 offset:33792
    v_mfma_f32_16x16x32_bf16 v[84:87], v[96:99], v[124:127], v[84:87]
    s_waitcnt vmcnt(17)
    s_waitcnt lgkmcnt(4)
    v_mfma_f32_16x16x32_bf16 v[16:19], v[100:103], v[128:131], v[16:19]
    ds_read_b128 v[96:99], v1 offset:34816
    v_mfma_f32_16x16x32_bf16 v[52:55], v[100:103], v[132:135], v[52:55]
    v_mfma_f32_16x16x32_bf16 v[20:23], v[104:107], v[128:131], v[20:23]
    ds_read_b128 v[100:103], v1 offset:35840
    v_mfma_f32_16x16x32_bf16 v[56:59], v[104:107], v[132:135], v[56:59]
    s_add_u32 s29, s28, 49152
    buffer_load_dwordx4 v[120:123], v2, s[8:11], s29 offen offset:0 sc0 sc1
    buffer_load_dwordx4 v[124:127], v2, s[8:11], s29 offen offset:256 sc0 sc1
    s_waitcnt vmcnt(14)
    s_barrier
    v_mfma_f32_16x16x32_bf16 v[24:27], v[108:111], v[128:131], v[24:27]
    ds_read_b128 v[104:107], v1 offset:36864
    v_mfma_f32_16x16x32_bf16 v[60:63], v[108:111], v[132:135], v[60:63]
    s_add_u32 m0, s31, 8192
    s_add_u32 s29, s30, 229376
    buffer_load_dwordx4 v1, s[12:15], s29 offen lds
    s_waitcnt lgkmcnt(4)
    v_mfma_f32_16x16x32_bf16 v[28:31], v[112:115], v[128:131], v[28:31]
    ds_read_b128 v[108:111], v1 offset:37888
    v_mfma_f32_16x16x32_bf16 v[64:67], v[112:115], v[132:135], v[64:67]
    v_mfma_f32_16x16x32_bf16 v[32:35], v[116:119], v[128:131], v[32:35]
    ds_read_b128 v[112:115], v1 offset:38912
    v_mfma_f32_16x16x32_bf16 v[68:71], v[116:119], v[132:135], v[68:71]
    v_mfma_f32_16x16x32_bf16 v[36:39], v[88:91], v[128:131], v[36:39]
    ds_read_b128 v[116:119], v1 offset:39936
    v_mfma_f32_16x16x32_bf16 v[72:75], v[88:91], v[132:135], v[72:75]
    s_waitcnt lgkmcnt(4)
    v_mfma_f32_16x16x32_bf16 v[40:43], v[92:95], v[128:131], v[40:43]
    ds_read_b128 v[88:91], v1 offset:40960
    v_mfma_f32_16x16x32_bf16 v[76:79], v[92:95], v[132:135], v[76:79]
    s_add_u32 m0, s31, 12288
    s_add_u32 s29, s30, 233472
    buffer_load_dwordx4 v1, s[12:15], s29 offen lds
    v_mfma_f32_16x16x32_bf16 v[44:47], v[96:99], v[128:131], v[44:47]
    ds_read_b128 v[92:95], v1 offset:41984
    v_mfma_f32_16x16x32_bf16 v[80:83], v[96:99], v[132:135], v[80:83]
    v_mfma_f32_16x16x32_bf16 v[48:51], v[100:103], v[128:131], v[48:51]
    ds_read_b128 v[96:99], v1 offset:43008
    v_mfma_f32_16x16x32_bf16 v[84:87], v[100:103], v[132:135], v[84:87]
    s_add_u32 m0, s31, 16384
    s_add_u32 s29, s30, 237568
    buffer_load_dwordx4 v1, s[12:15], s29 offen lds
    s_waitcnt lgkmcnt(4)
    v_mfma_f32_16x16x32_bf16 v[16:19], v[104:107], v[136:139], v[16:19]
    ds_read_b128 v[100:103], v1 offset:44032
    v_mfma_f32_16x16x32_bf16 v[52:55], v[104:107], v[140:143], v[52:55]
    s_add_u32 m0, s31, 20480
    s_add_u32 s29, s30, 241664
    buffer_load_dwordx4 v1, s[12:15], s29 offen lds
    v_mfma_f32_16x16x32_bf16 v[20:23], v[108:111], v[136:139], v[20:23]
    ds_read_b128 v[104:107], v1 offset:45056
    v_mfma_f32_16x16x32_bf16 v[56:59], v[108:111], v[140:143], v[56:59]
    s_add_u32 s29, s28, 51200
    buffer_load_dwordx4 v[128:131], v2, s[8:11], s29 offen offset:0 sc0 sc1
    buffer_load_dwordx4 v[132:135], v2, s[8:11], s29 offen offset:256 sc0 sc1
    v_mfma_f32_16x16x32_bf16 v[24:27], v[112:115], v[136:139], v[24:27]
    ds_read_b128 v[108:111], v1 offset:46080
    v_mfma_f32_16x16x32_bf16 v[60:63], v[112:115], v[140:143], v[60:63]
    s_add_u32 m0, s31, 24576
    s_add_u32 s29, s30, 245760
    buffer_load_dwordx4 v1, s[12:15], s29 offen lds
    s_waitcnt lgkmcnt(4)
    v_mfma_f32_16x16x32_bf16 v[28:31], v[116:119], v[136:139], v[28:31]
    ds_read_b128 v[112:115], v1 offset:47104
    v_mfma_f32_16x16x32_bf16 v[64:67], v[116:119], v[140:143], v[64:67]
    v_mfma_f32_16x16x32_bf16 v[32:35], v[88:91], v[136:139], v[32:35]
    ds_read_b128 v[116:119], v1 offset:48128
    v_mfma_f32_16x16x32_bf16 v[68:71], v[88:91], v[140:143], v[68:71]
    v_mfma_f32_16x16x32_bf16 v[36:39], v[92:95], v[136:139], v[36:39]
    ds_read_b128 v[88:91], v1 offset:49152
    v_mfma_f32_16x16x32_bf16 v[72:75], v[92:95], v[140:143], v[72:75]
    s_waitcnt lgkmcnt(4)
    v_mfma_f32_16x16x32_bf16 v[40:43], v[96:99], v[136:139], v[40:43]
    ds_read_b128 v[92:95], v1 offset:50176
    v_mfma_f32_16x16x32_bf16 v[76:79], v[96:99], v[140:143], v[76:79]
    v_mfma_f32_16x16x32_bf16 v[44:47], v[100:103], v[136:139], v[44:47]
    ds_read_b128 v[96:99], v1 offset:51200
    v_mfma_f32_16x16x32_bf16 v[80:83], v[100:103], v[140:143], v[80:83]
    v_mfma_f32_16x16x32_bf16 v[48:51], v[104:107], v[136:139], v[48:51]
    ds_read_b128 v[100:103], v1 offset:52224
    v_mfma_f32_16x16x32_bf16 v[84:87], v[104:107], v[140:143], v[84:87]
    s_waitcnt vmcnt(18)
    s_waitcnt lgkmcnt(4)
    v_mfma_f32_16x16x32_bf16 v[16:19], v[108:111], v[144:147], v[16:19]
    ds_read_b128 v[104:107], v1 offset:53248
    v_mfma_f32_16x16x32_bf16 v[52:55], v[108:111], v[148:151], v[52:55]
    v_mfma_f32_16x16x32_bf16 v[20:23], v[112:115], v[144:147], v[20:23]
    ds_read_b128 v[108:111], v1 offset:54272
    v_mfma_f32_16x16x32_bf16 v[56:59], v[112:115], v[148:151], v[56:59]
    s_add_u32 s29, s28, 53248
    buffer_load_dwordx4 v[136:139], v2, s[8:11], s29 offen offset:0 sc0 sc1
    buffer_load_dwordx4 v[140:143], v2, s[8:11], s29 offen offset:256 sc0 sc1
    s_waitcnt vmcnt(15)
    s_barrier
    v_mfma_f32_16x16x32_bf16 v[24:27], v[116:119], v[144:147], v[24:27]
    ds_read_b128 v[112:115], v1 offset:55296
    v_mfma_f32_16x16x32_bf16 v[60:63], v[116:119], v[148:151], v[60:63]
    s_add_u32 m0, s31, 28672
    s_add_u32 s29, s30, 249856
    buffer_load_dwordx4 v1, s[12:15], s29 offen lds
    s_waitcnt lgkmcnt(4)
    v_mfma_f32_16x16x32_bf16 v[28:31], v[88:91], v[144:147], v[28:31]
    ds_read_b128 v[116:119], v1 offset:56320
    v_mfma_f32_16x16x32_bf16 v[64:67], v[88:91], v[148:151], v[64:67]
    v_mfma_f32_16x16x32_bf16 v[32:35], v[92:95], v[144:147], v[32:35]
    ds_read_b128 v[88:91], v1 offset:57344
    v_mfma_f32_16x16x32_bf16 v[68:71], v[92:95], v[148:151], v[68:71]
    v_mfma_f32_16x16x32_bf16 v[36:39], v[96:99], v[144:147], v[36:39]
    ds_read_b128 v[92:95], v1 offset:58368
    v_mfma_f32_16x16x32_bf16 v[72:75], v[96:99], v[148:151], v[72:75]
    s_waitcnt lgkmcnt(4)
    v_mfma_f32_16x16x32_bf16 v[40:43], v[100:103], v[144:147], v[40:43]
    ds_read_b128 v[96:99], v1 offset:59392
    v_mfma_f32_16x16x32_bf16 v[76:79], v[100:103], v[148:151], v[76:79]
    s_add_u32 m0, s31, 32768
    s_add_u32 s29, s30, 253952
    buffer_load_dwordx4 v1, s[12:15], s29 offen lds
    v_mfma_f32_16x16x32_bf16 v[44:47], v[104:107], v[144:147], v[44:47]
    ds_read_b128 v[100:103], v1 offset:60416
    v_mfma_f32_16x16x32_bf16 v[80:83], v[104:107], v[148:151], v[80:83]
    v_mfma_f32_16x16x32_bf16 v[48:51], v[108:111], v[144:147], v[48:51]
    ds_read_b128 v[104:107], v1 offset:61440
    v_mfma_f32_16x16x32_bf16 v[84:87], v[108:111], v[148:151], v[84:87]
    s_add_u32 m0, s31, 36864
    s_add_u32 s29, s30, 258048
    buffer_load_dwordx4 v1, s[12:15], s29 offen lds
    s_waitcnt lgkmcnt(4)
    v_mfma_f32_16x16x32_bf16 v[16:19], v[112:115], v[152:155], v[16:19]
    ds_read_b128 v[108:111], v1 offset:62464
    v_mfma_f32_16x16x32_bf16 v[52:55], v[112:115], v[156:159], v[52:55]
    s_add_u32 m0, s31, 40960
    s_add_u32 s29, s30, 262144
    buffer_load_dwordx4 v1, s[12:15], s29 offen lds
    v_mfma_f32_16x16x32_bf16 v[20:23], v[116:119], v[152:155], v[20:23]
    ds_read_b128 v[112:115], v1 offset:63488
    v_mfma_f32_16x16x32_bf16 v[56:59], v[116:119], v[156:159], v[56:59]
    s_add_u32 s29, s28, 55296
    buffer_load_dwordx4 v[144:147], v2, s[8:11], s29 offen offset:0 sc0 sc1
    buffer_load_dwordx4 v[148:151], v2, s[8:11], s29 offen offset:256 sc0 sc1
    v_mfma_f32_16x16x32_bf16 v[24:27], v[88:91], v[152:155], v[24:27]
    ds_read_b128 v[116:119], v1 offset:64512
    v_mfma_f32_16x16x32_bf16 v[60:63], v[88:91], v[156:159], v[60:63]
    s_waitcnt lgkmcnt(4)
    v_mfma_f32_16x16x32_bf16 v[28:31], v[92:95], v[152:155], v[28:31]
    ds_read_b128 v[88:91], v3 offset:0
    v_mfma_f32_16x16x32_bf16 v[64:67], v[92:95], v[156:159], v[64:67]
    v_mfma_f32_16x16x32_bf16 v[32:35], v[96:99], v[152:155], v[32:35]
    ds_read_b128 v[92:95], v3 offset:1024
    v_mfma_f32_16x16x32_bf16 v[68:71], v[96:99], v[156:159], v[68:71]
    v_mfma_f32_16x16x32_bf16 v[36:39], v[100:103], v[152:155], v[36:39]
    ds_read_b128 v[96:99], v3 offset:2048
    v_mfma_f32_16x16x32_bf16 v[72:75], v[100:103], v[156:159], v[72:75]
    s_waitcnt lgkmcnt(4)
    v_mfma_f32_16x16x32_bf16 v[40:43], v[104:107], v[152:155], v[40:43]
    ds_read_b128 v[100:103], v3 offset:3072
    v_mfma_f32_16x16x32_bf16 v[76:79], v[104:107], v[156:159], v[76:79]
    v_mfma_f32_16x16x32_bf16 v[44:47], v[108:111], v[152:155], v[44:47]
    ds_read_b128 v[104:107], v3 offset:4096
    v_mfma_f32_16x16x32_bf16 v[80:83], v[108:111], v[156:159], v[80:83]
    v_mfma_f32_16x16x32_bf16 v[48:51], v[112:115], v[152:155], v[48:51]
    ds_read_b128 v[108:111], v3 offset:5120
    v_mfma_f32_16x16x32_bf16 v[84:87], v[112:115], v[156:159], v[84:87]
    s_waitcnt vmcnt(17)
    s_waitcnt lgkmcnt(4)
    v_mfma_f32_16x16x32_bf16 v[16:19], v[116:119], v[160:163], v[16:19]
    ds_read_b128 v[112:115], v3 offset:6144
    v_mfma_f32_16x16x32_bf16 v[52:55], v[116:119], v[164:167], v[52:55]
    v_mfma_f32_16x16x32_bf16 v[20:23], v[88:91], v[160:163], v[20:23]
    ds_read_b128 v[116:119], v3 offset:7168
    v_mfma_f32_16x16x32_bf16 v[56:59], v[88:91], v[164:167], v[56:59]
    s_add_u32 s29, s28, 57344
    buffer_load_dwordx4 v[152:155], v2, s[8:11], s29 offen offset:0 sc0 sc1
    buffer_load_dwordx4 v[156:159], v2, s[8:11], s29 offen offset:256 sc0 sc1
    s_waitcnt vmcnt(14)
    s_barrier
    v_mfma_f32_16x16x32_bf16 v[24:27], v[92:95], v[160:163], v[24:27]
    ds_read_b128 v[88:91], v1 offset:0
    v_mfma_f32_16x16x32_bf16 v[60:63], v[92:95], v[164:167], v[60:63]
    s_add_u32 m0, s31, 45056
    s_add_u32 s29, s30, 266240
    buffer_load_dwordx4 v1, s[12:15], s29 offen lds
    s_waitcnt lgkmcnt(4)
    v_mfma_f32_16x16x32_bf16 v[28:31], v[96:99], v[160:163], v[28:31]
    ds_read_b128 v[92:95], v1 offset:1024
    v_mfma_f32_16x16x32_bf16 v[64:67], v[96:99], v[164:167], v[64:67]
    v_mfma_f32_16x16x32_bf16 v[32:35], v[100:103], v[160:163], v[32:35]
    ds_read_b128 v[96:99], v1 offset:2048
    v_mfma_f32_16x16x32_bf16 v[68:71], v[100:103], v[164:167], v[68:71]
    v_mfma_f32_16x16x32_bf16 v[36:39], v[104:107], v[160:163], v[36:39]
    ds_read_b128 v[100:103], v1 offset:3072
    v_mfma_f32_16x16x32_bf16 v[72:75], v[104:107], v[164:167], v[72:75]
    s_waitcnt lgkmcnt(4)
    v_mfma_f32_16x16x32_bf16 v[40:43], v[108:111], v[160:163], v[40:43]
    ds_read_b128 v[104:107], v1 offset:4096
    v_mfma_f32_16x16x32_bf16 v[76:79], v[108:111], v[164:167], v[76:79]
    s_add_u32 m0, s31, 49152
    s_add_u32 s29, s30, 270336
    buffer_load_dwordx4 v1, s[12:15], s29 offen lds
    v_mfma_f32_16x16x32_bf16 v[44:47], v[112:115], v[160:163], v[44:47]
    ds_read_b128 v[108:111], v1 offset:5120
    v_mfma_f32_16x16x32_bf16 v[80:83], v[112:115], v[164:167], v[80:83]
    v_mfma_f32_16x16x32_bf16 v[48:51], v[116:119], v[160:163], v[48:51]
    ds_read_b128 v[112:115], v1 offset:6144
    v_mfma_f32_16x16x32_bf16 v[84:87], v[116:119], v[164:167], v[84:87]
    s_add_u32 m0, s31, 53248
    s_add_u32 s29, s30, 274432
    buffer_load_dwordx4 v1, s[12:15], s29 offen lds
    s_waitcnt lgkmcnt(4)
    v_mfma_f32_16x16x32_bf16 v[16:19], v[88:91], v[120:123], v[16:19]
    ds_read_b128 v[116:119], v1 offset:7168
    v_mfma_f32_16x16x32_bf16 v[52:55], v[88:91], v[124:127], v[52:55]
    s_add_u32 m0, s31, 57344
    s_add_u32 s29, s30, 278528
    buffer_load_dwordx4 v1, s[12:15], s29 offen lds
    v_mfma_f32_16x16x32_bf16 v[20:23], v[92:95], v[120:123], v[20:23]
    ds_read_b128 v[88:91], v1 offset:8192
    v_mfma_f32_16x16x32_bf16 v[56:59], v[92:95], v[124:127], v[56:59]
    s_add_u32 s29, s28, 59392
    buffer_load_dwordx4 v[160:163], v2, s[8:11], s29 offen offset:0 sc0 sc1
    buffer_load_dwordx4 v[164:167], v2, s[8:11], s29 offen offset:256 sc0 sc1
    v_mfma_f32_16x16x32_bf16 v[24:27], v[96:99], v[120:123], v[24:27]
    ds_read_b128 v[92:95], v1 offset:9216
    v_mfma_f32_16x16x32_bf16 v[60:63], v[96:99], v[124:127], v[60:63]
    s_add_u32 m0, s31, 61440
    s_add_u32 s29, s30, 282624
    buffer_load_dwordx4 v1, s[12:15], s29 offen lds
    s_waitcnt lgkmcnt(4)
    v_mfma_f32_16x16x32_bf16 v[28:31], v[100:103], v[120:123], v[28:31]
    ds_read_b128 v[96:99], v1 offset:10240
    v_mfma_f32_16x16x32_bf16 v[64:67], v[100:103], v[124:127], v[64:67]
    v_mfma_f32_16x16x32_bf16 v[32:35], v[104:107], v[120:123], v[32:35]
    ds_read_b128 v[100:103], v1 offset:11264
    v_mfma_f32_16x16x32_bf16 v[68:71], v[104:107], v[124:127], v[68:71]
    v_mfma_f32_16x16x32_bf16 v[36:39], v[108:111], v[120:123], v[36:39]
    ds_read_b128 v[104:107], v1 offset:12288
    v_mfma_f32_16x16x32_bf16 v[72:75], v[108:111], v[124:127], v[72:75]
    s_waitcnt lgkmcnt(4)
    v_mfma_f32_16x16x32_bf16 v[40:43], v[112:115], v[120:123], v[40:43]
    ds_read_b128 v[108:111], v1 offset:13312
    v_mfma_f32_16x16x32_bf16 v[76:79], v[112:115], v[124:127], v[76:79]
    v_mfma_f32_16x16x32_bf16 v[44:47], v[116:119], v[120:123], v[44:47]
    ds_read_b128 v[112:115], v1 offset:14336
    v_mfma_f32_16x16x32_bf16 v[80:83], v[116:119], v[124:127], v[80:83]
    v_mfma_f32_16x16x32_bf16 v[48:51], v[88:91], v[120:123], v[48:51]
    ds_read_b128 v[116:119], v1 offset:15360
    v_mfma_f32_16x16x32_bf16 v[84:87], v[88:91], v[124:127], v[84:87]
    s_waitcnt vmcnt(18)
    s_waitcnt lgkmcnt(4)
    v_mfma_f32_16x16x32_bf16 v[16:19], v[92:95], v[128:131], v[16:19]
    ds_read_b128 v[88:91], v1 offset:16384
    v_mfma_f32_16x16x32_bf16 v[52:55], v[92:95], v[132:135], v[52:55]
    v_mfma_f32_16x16x32_bf16 v[20:23], v[96:99], v[128:131], v[20:23]
    ds_read_b128 v[92:95], v1 offset:17408
    v_mfma_f32_16x16x32_bf16 v[56:59], v[96:99], v[132:135], v[56:59]
    s_add_u32 s29, s28, 61440
    buffer_load_dwordx4 v[120:123], v2, s[8:11], s29 offen offset:0 sc0 sc1
    buffer_load_dwordx4 v[124:127], v2, s[8:11], s29 offen offset:256 sc0 sc1
    s_waitcnt vmcnt(15)
    s_barrier
    v_mfma_f32_16x16x32_bf16 v[24:27], v[100:103], v[128:131], v[24:27]
    ds_read_b128 v[96:99], v1 offset:18432
    v_mfma_f32_16x16x32_bf16 v[60:63], v[100:103], v[132:135], v[60:63]
    s_add_u32 m0, s31, 65536
    s_add_u32 s29, s30, 286720
    buffer_load_dwordx4 v1, s[12:15], s29 offen lds
    s_waitcnt lgkmcnt(4)
    v_mfma_f32_16x16x32_bf16 v[28:31], v[104:107], v[128:131], v[28:31]
    ds_read_b128 v[100:103], v1 offset:19456
    v_mfma_f32_16x16x32_bf16 v[64:67], v[104:107], v[132:135], v[64:67]
    v_mfma_f32_16x16x32_bf16 v[32:35], v[108:111], v[128:131], v[32:35]
    ds_read_b128 v[104:107], v1 offset:20480
    v_mfma_f32_16x16x32_bf16 v[68:71], v[108:111], v[132:135], v[68:71]
    v_mfma_f32_16x16x32_bf16 v[36:39], v[112:115], v[128:131], v[36:39]
    ds_read_b128 v[108:111], v1 offset:21504
    v_mfma_f32_16x16x32_bf16 v[72:75], v[112:115], v[132:135], v[72:75]
    s_waitcnt lgkmcnt(4)
    v_mfma_f32_16x16x32_bf16 v[40:43], v[116:119], v[128:131], v[40:43]
    ds_read_b128 v[112:115], v1 offset:22528
    v_mfma_f32_16x16x32_bf16 v[76:79], v[116:119], v[132:135], v[76:79]
    s_add_u32 m0, s31, 69632
    s_add_u32 s29, s30, 290816
    buffer_load_dwordx4 v1, s[12:15], s29 offen lds
    v_mfma_f32_16x16x32_bf16 v[44:47], v[88:91], v[128:131], v[44:47]
    ds_read_b128 v[116:119], v1 offset:23552
    v_mfma_f32_16x16x32_bf16 v[80:83], v[88:91], v[132:135], v[80:83]
    v_mfma_f32_16x16x32_bf16 v[48:51], v[92:95], v[128:131], v[48:51]
    ds_read_b128 v[88:91], v1 offset:24576
    v_mfma_f32_16x16x32_bf16 v[84:87], v[92:95], v[132:135], v[84:87]
    s_add_u32 m0, s31, 0
    s_add_u32 s29, s81, 294912
    buffer_load_dwordx4 v1, s[12:15], s29 offen lds
    s_waitcnt lgkmcnt(4)
    v_mfma_f32_16x16x32_bf16 v[16:19], v[96:99], v[136:139], v[16:19]
    ds_read_b128 v[92:95], v1 offset:25600
    v_mfma_f32_16x16x32_bf16 v[52:55], v[96:99], v[140:143], v[52:55]
    s_add_u32 m0, s31, 4096
    s_add_u32 s29, s81, 299008
    buffer_load_dwordx4 v1, s[12:15], s29 offen lds
    v_mfma_f32_16x16x32_bf16 v[20:23], v[100:103], v[136:139], v[20:23]
    ds_read_b128 v[96:99], v1 offset:26624
    v_mfma_f32_16x16x32_bf16 v[56:59], v[100:103], v[140:143], v[56:59]
    s_add_u32 s29, s28, 63488
    buffer_load_dwordx4 v[128:131], v2, s[8:11], s29 offen offset:0 sc0 sc1
    buffer_load_dwordx4 v[132:135], v2, s[8:11], s29 offen offset:256 sc0 sc1
    v_mfma_f32_16x16x32_bf16 v[24:27], v[104:107], v[136:139], v[24:27]
    ds_read_b128 v[100:103], v1 offset:27648
    v_mfma_f32_16x16x32_bf16 v[60:63], v[104:107], v[140:143], v[60:63]
    s_waitcnt lgkmcnt(4)
    v_mfma_f32_16x16x32_bf16 v[28:31], v[108:111], v[136:139], v[28:31]
    ds_read_b128 v[104:107], v1 offset:28672
    v_mfma_f32_16x16x32_bf16 v[64:67], v[108:111], v[140:143], v[64:67]
    v_mfma_f32_16x16x32_bf16 v[32:35], v[112:115], v[136:139], v[32:35]
    ds_read_b128 v[108:111], v1 offset:29696
    v_mfma_f32_16x16x32_bf16 v[68:71], v[112:115], v[140:143], v[68:71]
    v_mfma_f32_16x16x32_bf16 v[36:39], v[116:119], v[136:139], v[36:39]
    ds_read_b128 v[112:115], v1 offset:30720
    v_mfma_f32_16x16x32_bf16 v[72:75], v[116:119], v[140:143], v[72:75]
    s_waitcnt lgkmcnt(4)
    v_mfma_f32_16x16x32_bf16 v[40:43], v[88:91], v[136:139], v[40:43]
    ds_read_b128 v[116:119], v1 offset:31744
    v_mfma_f32_16x16x32_bf16 v[76:79], v[88:91], v[140:143], v[76:79]
    v_mfma_f32_16x16x32_bf16 v[44:47], v[92:95], v[136:139], v[44:47]
    ds_read_b128 v[88:91], v1 offset:32768
    v_mfma_f32_16x16x32_bf16 v[80:83], v[92:95], v[140:143], v[80:83]
    v_mfma_f32_16x16x32_bf16 v[48:51], v[96:99], v[136:139], v[48:51]
    ds_read_b128 v[92:95], v1 offset:33792
    v_mfma_f32_16x16x32_bf16 v[84:87], v[96:99], v[140:143], v[84:87]
    s_waitcnt vmcnt(17)
    s_waitcnt lgkmcnt(4)
    v_mfma_f32_16x16x32_bf16 v[16:19], v[100:103], v[144:147], v[16:19]
    ds_read_b128 v[96:99], v1 offset:34816
    v_mfma_f32_16x16x32_bf16 v[52:55], v[100:103], v[148:151], v[52:55]
    v_mfma_f32_16x16x32_bf16 v[20:23], v[104:107], v[144:147], v[20:23]
    ds_read_b128 v[100:103], v1 offset:35840
    v_mfma_f32_16x16x32_bf16 v[56:59], v[104:107], v[148:151], v[56:59]
    s_add_u32 s29, s80, 65536
    buffer_load_dwordx4 v[136:139], v2, s[8:11], s29 offen offset:0 sc0 sc1
    buffer_load_dwordx4 v[140:143], v2, s[8:11], s29 offen offset:256 sc0 sc1
    s_waitcnt vmcnt(14)
    s_barrier
    v_mfma_f32_16x16x32_bf16 v[24:27], v[108:111], v[144:147], v[24:27]
    ds_read_b128 v[104:107], v1 offset:36864
    v_mfma_f32_16x16x32_bf16 v[60:63], v[108:111], v[148:151], v[60:63]
    s_add_u32 m0, s31, 8192
    s_add_u32 s29, s81, 303104
    buffer_load_dwordx4 v1, s[12:15], s29 offen lds
    s_waitcnt lgkmcnt(4)
    v_mfma_f32_16x16x32_bf16 v[28:31], v[112:115], v[144:147], v[28:31]
    ds_read_b128 v[108:111], v1 offset:37888
    v_mfma_f32_16x16x32_bf16 v[64:67], v[112:115], v[148:151], v[64:67]
    v_mfma_f32_16x16x32_bf16 v[32:35], v[116:119], v[144:147], v[32:35]
    ds_read_b128 v[112:115], v1 offset:38912
    v_mfma_f32_16x16x32_bf16 v[68:71], v[116:119], v[148:151], v[68:71]
    v_mfma_f32_16x16x32_bf16 v[36:39], v[88:91], v[144:147], v[36:39]
    ds_read_b128 v[116:119], v1 offset:39936
    v_mfma_f32_16x16x32_bf16 v[72:75], v[88:91], v[148:151], v[72:75]
    s_waitcnt lgkmcnt(4)
    v_mfma_f32_16x16x32_bf16 v[40:43], v[92:95], v[144:147], v[40:43]
    ds_read_b128 v[88:91], v1 offset:40960
    v_mfma_f32_16x16x32_bf16 v[76:79], v[92:95], v[148:151], v[76:79]
    s_add_u32 m0, s31, 12288
    s_add_u32 s29, s81, 307200
    buffer_load_dwordx4 v1, s[12:15], s29 offen lds
    v_mfma_f32_16x16x32_bf16 v[44:47], v[96:99], v[144:147], v[44:47]
    ds_read_b128 v[92:95], v1 offset:41984
    v_mfma_f32_16x16x32_bf16 v[80:83], v[96:99], v[148:151], v[80:83]
    v_mfma_f32_16x16x32_bf16 v[48:51], v[100:103], v[144:147], v[48:51]
    ds_read_b128 v[96:99], v1 offset:43008
    v_mfma_f32_16x16x32_bf16 v[84:87], v[100:103], v[148:151], v[84:87]
    s_add_u32 m0, s31, 16384
    s_add_u32 s29, s81, 311296
    buffer_load_dwordx4 v1, s[12:15], s29 offen lds
    s_waitcnt lgkmcnt(4)
    v_mfma_f32_16x16x32_bf16 v[16:19], v[104:107], v[152:155], v[16:19]
    ds_read_b128 v[100:103], v1 offset:44032
    v_mfma_f32_16x16x32_bf16 v[52:55], v[104:107], v[156:159], v[52:55]
    s_add_u32 m0, s31, 20480
    s_add_u32 s29, s81, 315392
    buffer_load_dwordx4 v1, s[12:15], s29 offen lds
    v_mfma_f32_16x16x32_bf16 v[20:23], v[108:111], v[152:155], v[20:23]
    ds_read_b128 v[104:107], v1 offset:45056
    v_mfma_f32_16x16x32_bf16 v[56:59], v[108:111], v[156:159], v[56:59]
    s_add_u32 s29, s80, 67584
    buffer_load_dwordx4 v[144:147], v2, s[8:11], s29 offen offset:0 sc0 sc1
    buffer_load_dwordx4 v[148:151], v2, s[8:11], s29 offen offset:256 sc0 sc1
    v_mfma_f32_16x16x32_bf16 v[24:27], v[112:115], v[152:155], v[24:27]
    ds_read_b128 v[108:111], v1 offset:46080
    v_mfma_f32_16x16x32_bf16 v[60:63], v[112:115], v[156:159], v[60:63]
    s_add_u32 m0, s31, 24576
    s_add_u32 s29, s81, 319488
    buffer_load_dwordx4 v1, s[12:15], s29 offen lds
    s_waitcnt lgkmcnt(4)
    v_mfma_f32_16x16x32_bf16 v[28:31], v[116:119], v[152:155], v[28:31]
    ds_read_b128 v[112:115], v1 offset:47104
    v_mfma_f32_16x16x32_bf16 v[64:67], v[116:119], v[156:159], v[64:67]
    v_mfma_f32_16x16x32_bf16 v[32:35], v[88:91], v[152:155], v[32:35]
    ds_read_b128 v[116:119], v1 offset:48128
    v_mfma_f32_16x16x32_bf16 v[68:71], v[88:91], v[156:159], v[68:71]
    v_mfma_f32_16x16x32_bf16 v[36:39], v[92:95], v[152:155], v[36:39]
    ds_read_b128 v[88:91], v1 offset:49152
    v_mfma_f32_16x16x32_bf16 v[72:75], v[92:95], v[156:159], v[72:75]
    s_waitcnt lgkmcnt(4)
    v_mfma_f32_16x16x32_bf16 v[40:43], v[96:99], v[152:155], v[40:43]
    ds_read_b128 v[92:95], v1 offset:50176
    v_mfma_f32_16x16x32_bf16 v[76:79], v[96:99], v[156:159], v[76:79]
    v_mfma_f32_16x16x32_bf16 v[44:47], v[100:103], v[152:155], v[44:47]
    ds_read_b128 v[96:99], v1 offset:51200
    v_mfma_f32_16x16x32_bf16 v[80:83], v[100:103], v[156:159], v[80:83]
    v_mfma_f32_16x16x32_bf16 v[48:51], v[104:107], v[152:155], v[48:51]
    ds_read_b128 v[100:103], v1 offset:52224
    v_mfma_f32_16x16x32_bf16 v[84:87], v[104:107], v[156:159], v[84:87]
    s_waitcnt vmcnt(18)
    s_waitcnt lgkmcnt(4)
    v_mfma_f32_16x16x32_bf16 v[16:19], v[108:111], v[160:163], v[16:19]
    ds_read_b128 v[104:107], v1 offset:53248
    v_mfma_f32_16x16x32_bf16 v[52:55], v[108:111], v[164:167], v[52:55]
    v_mfma_f32_16x16x32_bf16 v[20:23], v[112:115], v[160:163], v[20:23]
    ds_read_b128 v[108:111], v1 offset:54272
    v_mfma_f32_16x16x32_bf16 v[56:59], v[112:115], v[164:167], v[56:59]
    s_add_u32 s29, s80, 69632
    buffer_load_dwordx4 v[152:155], v2, s[8:11], s29 offen offset:0 sc0 sc1
    buffer_load_dwordx4 v[156:159], v2, s[8:11], s29 offen offset:256 sc0 sc1
    s_waitcnt vmcnt(15)
    s_barrier
    v_mfma_f32_16x16x32_bf16 v[24:27], v[116:119], v[160:163], v[24:27]
    ds_read_b128 v[112:115], v1 offset:55296
    v_mfma_f32_16x16x32_bf16 v[60:63], v[116:119], v[164:167], v[60:63]
    s_add_u32 m0, s31, 28672
    s_add_u32 s29, s81, 323584
    buffer_load_dwordx4 v1, s[12:15], s29 offen lds
    s_waitcnt lgkmcnt(4)
    v_mfma_f32_16x16x32_bf16 v[28:31], v[88:91], v[160:163], v[28:31]
    ds_read_b128 v[116:119], v1 offset:56320
    v_mfma_f32_16x16x32_bf16 v[64:67], v[88:91], v[164:167], v[64:67]
    v_mfma_f32_16x16x32_bf16 v[32:35], v[92:95], v[160:163], v[32:35]
    ds_read_b128 v[88:91], v1 offset:57344
    v_mfma_f32_16x16x32_bf16 v[68:71], v[92:95], v[164:167], v[68:71]
    v_mfma_f32_16x16x32_bf16 v[36:39], v[96:99], v[160:163], v[36:39]
    ds_read_b128 v[92:95], v1 offset:58368
    v_mfma_f32_16x16x32_bf16 v[72:75], v[96:99], v[164:167], v[72:75]
    s_waitcnt lgkmcnt(4)
    v_mfma_f32_16x16x32_bf16 v[40:43], v[100:103], v[160:163], v[40:43]
    ds_read_b128 v[96:99], v1 offset:59392
    v_mfma_f32_16x16x32_bf16 v[76:79], v[100:103], v[164:167], v[76:79]
    s_add_u32 m0, s31, 32768
    s_add_u32 s29, s81, 327680
    buffer_load_dwordx4 v1, s[12:15], s29 offen lds
    v_mfma_f32_16x16x32_bf16 v[44:47], v[104:107], v[160:163], v[44:47]
    ds_read_b128 v[100:103], v1 offset:60416
    v_mfma_f32_16x16x32_bf16 v[80:83], v[104:107], v[164:167], v[80:83]
    v_mfma_f32_16x16x32_bf16 v[48:51], v[108:111], v[160:163], v[48:51]
    ds_read_b128 v[104:107], v1 offset:61440
    v_mfma_f32_16x16x32_bf16 v[84:87], v[108:111], v[164:167], v[84:87]
    s_waitcnt lgkmcnt(4)
    v_mfma_f32_16x16x32_bf16 v[16:19], v[112:115], v[120:123], v[16:19]
    ds_read_b128 v[108:111], v1 offset:62464
    v_mfma_f32_16x16x32_bf16 v[52:55], v[112:115], v[124:127], v[52:55]
    v_mfma_f32_16x16x32_bf16 v[20:23], v[116:119], v[120:123], v[20:23]
    ds_read_b128 v[112:115], v1 offset:63488
    v_mfma_f32_16x16x32_bf16 v[56:59], v[116:119], v[124:127], v[56:59]
    s_add_u32 s29, s80, 71680
    buffer_load_dwordx4 v[160:163], v2, s[8:11], s29 offen offset:0 sc0 sc1
    buffer_load_dwordx4 v[164:167], v2, s[8:11], s29 offen offset:256 sc0 sc1
    v_mfma_f32_16x16x32_bf16 v[24:27], v[88:91], v[120:123], v[24:27]
    ds_read_b128 v[116:119], v1 offset:64512
    v_mfma_f32_16x16x32_bf16 v[60:63], v[88:91], v[124:127], v[60:63]
    s_waitcnt lgkmcnt(4)
    v_mfma_f32_16x16x32_bf16 v[28:31], v[92:95], v[120:123], v[28:31]
    ds_read_b128 v[88:91], v3 offset:0
    v_mfma_f32_16x16x32_bf16 v[64:67], v[92:95], v[124:127], v[64:67]
    v_mfma_f32_16x16x32_bf16 v[32:35], v[96:99], v[120:123], v[32:35]
    ds_read_b128 v[92:95], v3 offset:1024
    v_mfma_f32_16x16x32_bf16 v[68:71], v[96:99], v[124:127], v[68:71]
    v_mfma_f32_16x16x32_bf16 v[36:39], v[100:103], v[120:123], v[36:39]
    ds_read_b128 v[96:99], v3 offset:2048
    v_mfma_f32_16x16x32_bf16 v[72:75], v[100:103], v[124:127], v[72:75]
    s_waitcnt lgkmcnt(4)
    v_mfma_f32_16x16x32_bf16 v[40:43], v[104:107], v[120:123], v[40:43]
    ds_read_b128 v[100:103], v3 offset:3072
    v_mfma_f32_16x16x32_bf16 v[76:79], v[104:107], v[124:127], v[76:79]
    v_mfma_f32_16x16x32_bf16 v[44:47], v[108:111], v[120:123], v[44:47]
    ds_read_b128 v[104:107], v3 offset:4096
    v_mfma_f32_16x16x32_bf16 v[80:83], v[108:111], v[124:127], v[80:83]
    v_mfma_f32_16x16x32_bf16 v[48:51], v[112:115], v[120:123], v[48:51]
    ds_read_b128 v[108:111], v3 offset:5120
    v_mfma_f32_16x16x32_bf16 v[84:87], v[112:115], v[124:127], v[84:87]
    s_waitcnt vmcnt(15)
    s_waitcnt lgkmcnt(4)
    v_mfma_f32_16x16x32_bf16 v[16:19], v[116:119], v[128:131], v[16:19]
    ds_read_b128 v[112:115], v3 offset:6144
    v_mfma_f32_16x16x32_bf16 v[52:55], v[116:119], v[132:135], v[52:55]
    v_mfma_f32_16x16x32_bf16 v[20:23], v[88:91], v[128:131], v[20:23]
    ds_read_b128 v[116:119], v3 offset:7168
    v_mfma_f32_16x16x32_bf16 v[56:59], v[88:91], v[132:135], v[56:59]
    s_waitcnt vmcnt(10)
    s_barrier
    v_mfma_f32_16x16x32_bf16 v[24:27], v[92:95], v[128:131], v[24:27]
    ds_read_b128 v[88:91], v1 offset:0
    v_mfma_f32_16x16x32_bf16 v[60:63], v[92:95], v[132:135], v[60:63]
    s_waitcnt lgkmcnt(4)
    v_mfma_f32_16x16x32_bf16 v[28:31], v[96:99], v[128:131], v[28:31]
    ds_read_b128 v[92:95], v1 offset:1024
    v_mfma_f32_16x16x32_bf16 v[64:67], v[96:99], v[132:135], v[64:67]
    v_mfma_f32_16x16x32_bf16 v[32:35], v[100:103], v[128:131], v[32:35]
    ds_read_b128 v[96:99], v1 offset:2048
    v_mfma_f32_16x16x32_bf16 v[68:71], v[100:103], v[132:135], v[68:71]
    v_mfma_f32_16x16x32_bf16 v[36:39], v[104:107], v[128:131], v[36:39]
    ds_read_b128 v[100:103], v1 offset:3072
    v_mfma_f32_16x16x32_bf16 v[72:75], v[104:107], v[132:135], v[72:75]
    s_waitcnt lgkmcnt(4)
    v_mfma_f32_16x16x32_bf16 v[40:43], v[108:111], v[128:131], v[40:43]
    ds_read_b128 v[104:107], v1 offset:4096
    v_mfma_f32_16x16x32_bf16 v[76:79], v[108:111], v[132:135], v[76:79]
    v_mfma_f32_16x16x32_bf16 v[44:47], v[112:115], v[128:131], v[44:47]
    ds_read_b128 v[108:111], v1 offset:5120
    v_mfma_f32_16x16x32_bf16 v[80:83], v[112:115], v[132:135], v[80:83]
    v_mfma_f32_16x16x32_bf16 v[48:51], v[116:119], v[128:131], v[48:51]
    ds_read_b128 v[112:115], v1 offset:6144
    v_mfma_f32_16x16x32_bf16 v[84:87], v[116:119], v[132:135], v[84:87]
    s_waitcnt lgkmcnt(4)
    v_mfma_f32_16x16x32_bf16 v[16:19], v[88:91], v[136:139], v[16:19]
    ds_read_b128 v[116:119], v1 offset:7168
    v_mfma_f32_16x16x32_bf16 v[52:55], v[88:91], v[140:143], v[52:55]
    v_mfma_f32_16x16x32_bf16 v[20:23], v[92:95], v[136:139], v[20:23]
    ds_read_b128 v[88:91], v1 offset:8192
    v_mfma_f32_16x16x32_bf16 v[56:59], v[92:95], v[140:143], v[56:59]
    v_mul_u32_u24 v8, 1152, v4
    v_lshl_add_u32 v8, v5, 3, v8
    v_lshlrev_b32 v9, 4, v5
    s_lshl_b32 s33, s37, 2
    s_add_u32 s33, s33, s36
    s_mul_i32 s33, s33, 36864
    s_mul_i32 s34, s38, 288
    s_add_u32 s33, s33, s34
    s_mul_i32 s34, s38, 576
    s_add_u32 s34, s34, 11520
    s_add_u32 s29, s39, 0
    s_cmp_ge_u32 s29, 9
    s_cselect_b32 s35, 18144, 0
    s_cselect_b32 s32, -9, 0
    s_add_u32 s32, s32, s29
    s_lshl_b32 s29, s29, 5
    s_add_u32 s48, s29, s35
    s_add_u32 s48, s48, s33
    buffer_load_dwordx2 v[168:169], v8, s[16:19], s48 offen sc0 sc1
    s_lshl_b32 s32, s32, 6
    s_add_u32 s32, s32, s34
    buffer_load_dwordx4 v[180:183], v9, s[24:27], s32 offen
    s_add_u32 s29, s39, 4
    s_cmp_ge_u32 s29, 9
    s_cselect_b32 s35, 18144, 0
    s_cselect_b32 s32, -9, 0
    s_add_u32 s32, s32, s29
    s_lshl_b32 s29, s29, 5
    s_add_u32 s49, s29, s35
    s_add_u32 s49, s49, s33
    buffer_load_dwordx2 v[170:171], v8, s[16:19], s49 offen sc0 sc1
    s_lshl_b32 s32, s32, 6
    s_add_u32 s32, s32, s34
    buffer_load_dwordx4 v[184:187], v9, s[24:27], s32 offen
    s_add_u32 s29, s39, 8
    s_cmp_ge_u32 s29, 9
    s_cselect_b32 s35, 18144, 0
    s_cselect_b32 s32, -9, 0
    s_add_u32 s32, s32, s29
    s_lshl_b32 s29, s29, 5
    s_add_u32 s50, s29, s35
    s_add_u32 s50, s50, s33
    buffer_load_dwordx2 v[172:173], v8, s[16:19], s50 offen sc0 sc1
    s_lshl_b32 s32, s32, 6
    s_add_u32 s32, s32, s34
    buffer_load_dwordx4 v[188:191], v9, s[24:27], s32 offen
    s_add_u32 s29, s39, 12
    s_cmp_ge_u32 s29, 9
    s_cselect_b32 s35, 18144, 0
    s_cselect_b32 s32, -9, 0
    s_add_u32 s32, s32, s29
    s_lshl_b32 s29, s29, 5
    s_add_u32 s51, s29, s35
    s_add_u32 s51, s51, s33
    buffer_load_dwordx2 v[174:175], v8, s[16:19], s51 offen sc0 sc1
    s_lshl_b32 s32, s32, 6
    s_add_u32 s32, s32, s34
    buffer_load_dwordx4 v[192:195], v9, s[24:27], s32 offen
    s_add_u32 s29, s39, 16
    s_cmp_ge_u32 s29, 9
    s_cselect_b32 s35, 18144, 0
    s_cselect_b32 s32, -9, 0
    s_add_u32 s32, s32, s29
    s_lshl_b32 s29, s29, 5
    s_add_u32 s52, s29, s35
    s_add_u32 s52, s52, s33
    s_cmp_ge_u32 s39, 2
    s_cselect_b32 s52, 0x7ff00000, s52
    buffer_load_dwordx2 v[176:177], v8, s[16:19], s52 offen sc0 sc1
    s_lshl_b32 s32, s32, 6
    s_add_u32 s32, s32, s34
    buffer_load_dwordx4 v[196:199], v9, s[24:27], s32 offen
    v_mfma_f32_16x16x32_bf16 v[24:27], v[96:99], v[136:139], v[24:27]
    ds_read_b128 v[92:95], v1 offset:9216
    v_mfma_f32_16x16x32_bf16 v[60:63], v[96:99], v[140:143], v[60:63]
    s_waitcnt lgkmcnt(4)
    v_mfma_f32_16x16x32_bf16 v[28:31], v[100:103], v[136:139], v[28:31]
    ds_read_b128 v[96:99], v1 offset:10240
    v_mfma_f32_16x16x32_bf16 v[64:67], v[100:103], v[140:143], v[64:67]
    v_mfma_f32_16x16x32_bf16 v[32:35], v[104:107], v[136:139], v[32:35]
    ds_read_b128 v[100:103], v1 offset:11264
    v_mfma_f32_16x16x32_bf16 v[68:71], v[104:107], v[140:143], v[68:71]
    v_mfma_f32_16x16x32_bf16 v[36:39], v[108:111], v[136:139], v[36:39]
    ds_read_b128 v[104:107], v1 offset:12288
    v_mfma_f32_16x16x32_bf16 v[72:75], v[108:111], v[140:143], v[72:75]
    s_waitcnt lgkmcnt(4)
    v_mfma_f32_16x16x32_bf16 v[40:43], v[112:115], v[136:139], v[40:43]
    ds_read_b128 v[108:111], v1 offset:13312
    v_mfma_f32_16x16x32_bf16 v[76:79], v[112:115], v[140:143], v[76:79]
    v_mfma_f32_16x16x32_bf16 v[44:47], v[116:119], v[136:139], v[44:47]
    ds_read_b128 v[112:115], v1 offset:14336
    v_mfma_f32_16x16x32_bf16 v[80:83], v[116:119], v[140:143], v[80:83]
    v_mfma_f32_16x16x32_bf16 v[48:51], v[88:91], v[136:139], v[48:51]
    ds_read_b128 v[116:119], v1 offset:15360
    v_mfma_f32_16x16x32_bf16 v[84:87], v[88:91], v[140:143], v[84:87]
    s_waitcnt vmcnt(17)
    s_waitcnt lgkmcnt(4)
    v_mfma_f32_16x16x32_bf16 v[16:19], v[92:95], v[144:147], v[16:19]
    ds_read_b128 v[88:91], v1 offset:16384
    v_mfma_f32_16x16x32_bf16 v[52:55], v[92:95], v[148:151], v[52:55]
    v_mfma_f32_16x16x32_bf16 v[20:23], v[96:99], v[144:147], v[20:23]
    ds_read_b128 v[92:95], v1 offset:17408
    v_mfma_f32_16x16x32_bf16 v[56:59], v[96:99], v[148:151], v[56:59]
    s_waitcnt vmcnt(12)
    s_barrier
    v_mfma_f32_16x16x32_bf16 v[24:27], v[100:103], v[144:147], v[24:27]
    ds_read_b128 v[96:99], v1 offset:18432
    v_mfma_f32_16x16x32_bf16 v[60:63], v[100:103], v[148:151], v[60:63]
    s_waitcnt lgkmcnt(4)
    v_mfma_f32_16x16x32_bf16 v[28:31], v[104:107], v[144:147], v[28:31]
    ds_read_b128 v[100:103], v1 offset:19456
    v_mfma_f32_16x16x32_bf16 v[64:67], v[104:107], v[148:151], v[64:67]
    v_mfma_f32_16x16x32_bf16 v[32:35], v[108:111], v[144:147], v[32:35]
    ds_read_b128 v[104:107], v1 offset:20480
    v_mfma_f32_16x16x32_bf16 v[68:71], v[108:111], v[148:151], v[68:71]
    v_mfma_f32_16x16x32_bf16 v[36:39], v[112:115], v[144:147], v[36:39]
    ds_read_b128 v[108:111], v1 offset:21504
    v_mfma_f32_16x16x32_bf16 v[72:75], v[112:115], v[148:151], v[72:75]
    s_waitcnt lgkmcnt(4)
    v_mfma_f32_16x16x32_bf16 v[40:43], v[116:119], v[144:147], v[40:43]
    ds_read_b128 v[112:115], v1 offset:22528
    v_mfma_f32_16x16x32_bf16 v[76:79], v[116:119], v[148:151], v[76:79]
    v_mfma_f32_16x16x32_bf16 v[44:47], v[88:91], v[144:147], v[44:47]
    ds_read_b128 v[116:119], v1 offset:23552
    v_mfma_f32_16x16x32_bf16 v[80:83], v[88:91], v[148:151], v[80:83]
    v_mfma_f32_16x16x32_bf16 v[48:51], v[92:95], v[144:147], v[48:51]
    ds_read_b128 v[88:91], v1 offset:24576
    v_mfma_f32_16x16x32_bf16 v[84:87], v[92:95], v[148:151], v[84:87]
    s_waitcnt lgkmcnt(4)
    v_mfma_f32_16x16x32_bf16 v[16:19], v[96:99], v[152:155], v[16:19]
    ds_read_b128 v[92:95], v1 offset:25600
    v_mfma_f32_16x16x32_bf16 v[52:55], v[96:99], v[156:159], v[52:55]
    v_mfma_f32_16x16x32_bf16 v[20:23], v[100:103], v[152:155], v[20:23]
    ds_read_b128 v[96:99], v1 offset:26624
    v_mfma_f32_16x16x32_bf16 v[56:59], v[100:103], v[156:159], v[56:59]
    v_mfma_f32_16x16x32_bf16 v[24:27], v[104:107], v[152:155], v[24:27]
    ds_read_b128 v[100:103], v1 offset:27648
    v_mfma_f32_16x16x32_bf16 v[60:63], v[104:107], v[156:159], v[60:63]
    s_waitcnt lgkmcnt(4)
    v_mfma_f32_16x16x32_bf16 v[28:31], v[108:111], v[152:155], v[28:31]
    ds_read_b128 v[104:107], v1 offset:28672
    v_mfma_f32_16x16x32_bf16 v[64:67], v[108:111], v[156:159], v[64:67]
    v_mfma_f32_16x16x32_bf16 v[32:35], v[112:115], v[152:155], v[32:35]
    ds_read_b128 v[108:111], v1 offset:29696
    v_mfma_f32_16x16x32_bf16 v[68:71], v[112:115], v[156:159], v[68:71]
    v_mfma_f32_16x16x32_bf16 v[36:39], v[116:119], v[152:155], v[36:39]
    ds_read_b128 v[112:115], v1 offset:30720
    v_mfma_f32_16x16x32_bf16 v[72:75], v[116:119], v[156:159], v[72:75]
    s_waitcnt lgkmcnt(4)
    v_mfma_f32_16x16x32_bf16 v[40:43], v[88:91], v[152:155], v[40:43]
    ds_read_b128 v[116:119], v1 offset:31744
    v_mfma_f32_16x16x32_bf16 v[76:79], v[88:91], v[156:159], v[76:79]
    v_mfma_f32_16x16x32_bf16 v[44:47], v[92:95], v[152:155], v[44:47]
    ds_read_b128 v[88:91], v1 offset:32768
    v_mfma_f32_16x16x32_bf16 v[80:83], v[92:95], v[156:159], v[80:83]
    v_mfma_f32_16x16x32_bf16 v[48:51], v[96:99], v[152:155], v[48:51]
    ds_read_b128 v[92:95], v1 offset:33792
    v_mfma_f32_16x16x32_bf16 v[84:87], v[96:99], v[156:159], v[84:87]
    s_waitcnt vmcnt(10)
    s_waitcnt lgkmcnt(4)
    v_mfma_f32_16x16x32_bf16 v[16:19], v[100:103], v[160:163], v[16:19]
    ds_read_b128 v[96:99], v1 offset:34816
    v_mfma_f32_16x16x32_bf16 v[52:55], v[100:103], v[164:167], v[52:55]
    v_mfma_f32_16x16x32_bf16 v[20:23], v[104:107], v[160:163], v[20:23]
    ds_read_b128 v[100:103], v1 offset:35840
    v_mfma_f32_16x16x32_bf16 v[56:59], v[104:107], v[164:167], v[56:59]
    v_mfma_f32_16x16x32_bf16 v[24:27], v[108:111], v[160:163], v[24:27]
    v_mfma_f32_16x16x32_bf16 v[60:63], v[108:111], v[164:167], v[60:63]
    s_waitcnt lgkmcnt(3)
    v_mfma_f32_16x16x32_bf16 v[28:31], v[112:115], v[160:163], v[28:31]
    v_mfma_f32_16x16x32_bf16 v[64:67], v[112:115], v[164:167], v[64:67]
    v_mfma_f32_16x16x32_bf16 v[32:35], v[116:119], v[160:163], v[32:35]
    v_mfma_f32_16x16x32_bf16 v[68:71], v[116:119], v[164:167], v[68:71]
    v_mfma_f32_16x16x32_bf16 v[36:39], v[88:91], v[160:163], v[36:39]
    v_mfma_f32_16x16x32_bf16 v[72:75], v[88:91], v[164:167], v[72:75]
    s_waitcnt lgkmcnt(0)
    v_mfma_f32_16x16x32_bf16 v[40:43], v[92:95], v[160:163], v[40:43]
    v_mfma_f32_16x16x32_bf16 v[76:79], v[92:95], v[164:167], v[76:79]
    v_mfma_f32_16x16x32_bf16 v[44:47], v[96:99], v[160:163], v[44:47]
    v_mfma_f32_16x16x32_bf16 v[80:83], v[96:99], v[164:167], v[80:83]
    v_mfma_f32_16x16x32_bf16 v[48:51], v[100:103], v[160:163], v[48:51]
    v_mfma_f32_16x16x32_bf16 v[84:87], v[100:103], v[164:167], v[84:87]
    s_lshl_b32 s32, s37, 2
    s_add_u32 s32, s32, s38
    s_cmp_eq_u32 s39, s36
    s_cbranch_scc1 gemm1kernel_own_9
    s_lshl_b32 s29, s32, 2
    s_add_u32 s29, s29, s39
    s_lshl_b32 s29, s29, 2
    s_add_u32 s29, s29, s36
    s_mul_i32 s29, s29, 18432
    buffer_store_dwordx4 v[16:19], v1, s[40:43], s29 offen offset:0 sc0 sc1
    buffer_store_dwordx4 v[20:23], v1, s[40:43], s29 offen offset:1024 sc0 sc1
    buffer_store_dwordx4 v[24:27], v1, s[40:43], s29 offen offset:2048 sc0 sc1
    buffer_store_dwordx4 v[28:31], v1, s[40:43], s29 offen offset:3072 sc0 sc1
    s_add_u32 s29, s29, 4096
    buffer_store_dwordx4 v[32:35], v1, s[40:43], s29 offen offset:0 sc0 sc1
    buffer_store_dwordx4 v[36:39], v1, s[40:43], s29 offen offset:1024 sc0 sc1
    buffer_store_dwordx4 v[40:43], v1, s[40:43], s29 offen offset:2048 sc0 sc1
    buffer_store_dwordx4 v[44:47], v1, s[40:43], s29 offen offset:3072 sc0 sc1
    s_add_u32 s29, s29, 4096
    buffer_store_dwordx4 v[48:51], v1, s[40:43], s29 offen offset:0 sc0 sc1
    buffer_store_dwordx4 v[52:55], v1, s[40:43], s29 offen offset:1024 sc0 sc1
    buffer_store_dwordx4 v[56:59], v1, s[40:43], s29 offen offset:2048 sc0 sc1
    buffer_store_dwordx4 v[60:63], v1, s[40:43], s29 offen offset:3072 sc0 sc1
    s_add_u32 s29, s29, 4096
    buffer_store_dwordx4 v[64:67], v1, s[40:43], s29 offen offset:0 sc0 sc1
    buffer_store_dwordx4 v[68:71], v1, s[40:43], s29 offen offset:1024 sc0 sc1
    buffer_store_dwordx4 v[72:75], v1, s[40:43], s29 offen offset:2048 sc0 sc1
    buffer_store_dwordx4 v[76:79], v1, s[40:43], s29 offen offset:3072 sc0 sc1
    s_add_u32 s29, s29, 4096
    buffer_store_dwordx4 v[80:83], v1, s[40:43], s29 offen offset:0 sc0 sc1
    buffer_store_dwordx4 v[84:87], v1, s[40:43], s29 offen offset:1024 sc0 sc1
    s_branch gemm1kernel_join_10
gemm1kernel_own_9:
    v_add_u32 v3, 73728, v1
    ds_write_b128 v3, v[16:19] offset:0
    ds_write_b128 v3, v[20:23] offset:1024
    ds_write_b128 v3, v[24:27] offset:2048
    ds_write_b128 v3, v[28:31] offset:3072
    ds_write_b128 v3, v[32:35] offset:4096
    ds_write_b128 v3, v[36:39] offset:5120
    ds_write_b128 v3, v[40:43] offset:6144
    ds_write_b128 v3, v[44:47] offset:7168
    ds_write_b128 v3, v[48:51] offset:8192
    ds_write_b128 v3, v[52:55] offset:9216
    ds_write_b128 v3, v[56:59] offset:10240
    ds_write_b128 v3, v[60:63] offset:11264
    ds_write_b128 v3, v[64:67] offset:12288
    ds_write_b128 v3, v[68:71] offset:13312
    ds_write_b128 v3, v[72:75] offset:14336
    ds_write_b128 v3, v[76:79] offset:15360
    ds_write_b128 v3, v[80:83] offset:16384
    ds_write_b128 v3, v[84:87] offset:17408
gemm1kernel_join_10:
    s_waitcnt vmcnt(0) lgkmcnt(0)
    s_barrier
    s_lshl_b32 s29, s32, 11
    s_cmp_lg_u32 s39, 0
    s_cbranch_scc1 gemm1kernel_wait_11
    s_lshl_b32 s35, s36, 7
    s_add_u32 s35, s35, s29
    v_lshlrev_b32 v10, 9, v0
    v_mov_b32 v11, 1
    s_mov_b64 exec, 15
    buffer_store_dword v11, v10, s[44:47], s35 offen sc0 sc1
    s_mov_b64 exec, -1
gemm1kernel_nf2_12:
    s_lshl_b32 s35, s36, 9
    s_add_u32 s35, s35, s29
    v_and_b32 v10, 3, v0
    v_lshlrev_b32 v10, 7, v10
    s_mov_b32 s53, 0
gemm1kernel_poll_13:
    buffer_load_dword v12, v10, s[44:47], s35 offen sc0 sc1
    s_waitcnt vmcnt(0)
    v_cmp_ne_u32 vcc, 1, v12
    s_add_u32 s53, s53, 1
    s_cbranch_vccz gemm1kernel_wait_11
    s_sleep 1
    s_cmp_lt_u32 s53, 0x40000
    s_cbranch_scc1 gemm1kernel_poll_13
gemm1kernel_wait_11:
    s_barrier
    v_add_u32 v3, 73728, v1
    v_add_u32 v3, s31, v3
    s_lshl_b32 s29, s32, 2
    s_add_u32 s29, s29, s36
    s_mul_i32 s29, s29, 73728
    s_add_u32 s29, s29, s31
    s_add_u32 s35, s36, 1
    s_and_b32 s35, s35, 3
    s_mul_i32 s35, s35, 18432
    s_add_u32 s85, s35, s29
    s_add_u32 s35, s36, 2
    s_and_b32 s35, s35, 3
    s_mul_i32 s35, s35, 18432
    s_add_u32 s86, s35, s29
    s_add_u32 s35, s36, 3
    s_and_b32 s35, s35, 3
    s_mul_i32 s35, s35, 18432
    s_add_u32 s87, s35, s29
    buffer_load_dwordx4 v[20:23], v1, s[40:43], s85 offen sc0 sc1
    s_add_u32 s85, s85, 4096
    buffer_load_dwordx4 v[24:27], v1, s[40:43], s86 offen sc0 sc1
    s_add_u32 s86, s86, 4096
    buffer_load_dwordx4 v[28:31], v1, s[40:43], s87 offen sc0 sc1
    s_add_u32 s87, s87, 4096
    ds_read_b128 v[16:19], v3 offset:0
    buffer_load_dwordx4 v[36:39], v1, s[40:43], s85 offen sc0 sc1
    s_add_u32 s85, s85, 4096
    buffer_load_dwordx4 v[40:43], v1, s[40:43], s86 offen sc0 sc1
    s_add_u32 s86, s86, 4096
    buffer_load_dwordx4 v[44:47], v1, s[40:43], s87 offen sc0 sc1
    s_add_u32 s87, s87, 4096
    ds_read_b128 v[32:35], v3 offset:4096
    buffer_load_dwordx4 v[52:55], v1, s[40:43], s85 offen sc0 sc1
    s_add_u32 s85, s85, 4096
    buffer_load_dwordx4 v[56:59], v1, s[40:43], s86 offen sc0 sc1
    s_add_u32 s86, s86, 4096
    buffer_load_dwordx4 v[60:63], v1, s[40:43], s87 offen sc0 sc1
    s_add_u32 s87, s87, 4096
    ds_read_b128 v[48:51], v3 offset:8192
    buffer_load_dwordx4 v[68:71], v1, s[40:43], s85 offen sc0 sc1
    s_add_u32 s85, s85, 4096
    buffer_load_dwordx4 v[72:75], v1, s[40:43], s86 offen sc0 sc1
    s_add_u32 s86, s86, 4096
    buffer_load_dwordx4 v[76:79], v1, s[40:43], s87 offen sc0 sc1
    s_add_u32 s87, s87, 4096
    ds_read_b128 v[64:67], v3 offset:12288
    buffer_load_dwordx4 v[84:87], v1, s[40:43], s85 offen sc0 sc1
    s_add_u32 s85, s85, 4096
    buffer_load_dwordx4 v[88:91], v1, s[40:43], s86 offen sc0 sc1
    s_add_u32 s86, s86, 4096
    buffer_load_dwordx4 v[92:95], v1, s[40:43], s87 offen sc0 sc1
    s_add_u32 s87, s87, 4096
    ds_read_b128 v[80:83], v3 offset:16384
    s_waitcnt lgkmcnt(0)
    s_waitcnt vmcnt(12)
    v_pk_add_f32 v[16:17], v[16:17], v[20:21]
    v_pk_add_f32 v[24:25], v[24:25], v[28:29]
    v_pk_add_f32 v[16:17], v[16:17], v[24:25]
    v_pk_add_f32 v[18:19], v[18:19], v[22:23]
    v_pk_add_f32 v[26:27], v[26:27], v[30:31]
    v_pk_add_f32 v[18:19], v[18:19], v[26:27]
    v_cvt_pk_bf16_f32 v16, 0, v16
    v_mul_f32 v16, v16, v180
    v_cvt_pk_bf16_f32 v16, 0, v16
    v_lshlrev_b32 v20, 16, v168
    v_add_f32 v16, v16, v20
    v_cvt_pk_bf16_f32 v17, 0, v17
    v_mul_f32 v17, v17, v181
    v_cvt_pk_bf16_f32 v17, 0, v17
    v_and_b32 v21, 0xffff0000, v168
    v_add_f32 v17, v17, v21
    v_cvt_pk_bf16_f32 v18, 0, v18
    v_mul_f32 v18, v18, v182
    v_cvt_pk_bf16_f32 v18, 0, v18
    v_lshlrev_b32 v22, 16, v169
    v_add_f32 v18, v18, v22
    v_cvt_pk_bf16_f32 v19, 0, v19
    v_mul_f32 v19, v19, v183
    v_cvt_pk_bf16_f32 v19, 0, v19
    v_and_b32 v23, 0xffff0000, v169
    v_add_f32 v19, v19, v23
    v_cvt_pk_bf16_f32 v24, v16, v17
    v_cvt_pk_bf16_f32 v25, v18, v19
    buffer_store_dwordx2 v[24:25], v8, s[20:23], s48 offen
    s_waitcnt vmcnt(10)
    v_pk_add_f32 v[32:33], v[32:33], v[36:37]
    v_pk_add_f32 v[40:41], v[40:41], v[44:45]
    v_pk_add_f32 v[32:33], v[32:33], v[40:41]
    v_pk_add_f32 v[34:35], v[34:35], v[38:39]
    v_pk_add_f32 v[42:43], v[42:43], v[46:47]
    v_pk_add_f32 v[34:35], v[34:35], v[42:43]
    v_cvt_pk_bf16_f32 v32, 0, v32
    v_mul_f32 v32, v32, v184
    v_cvt_pk_bf16_f32 v32, 0, v32
    v_lshlrev_b32 v36, 16, v170
    v_add_f32 v32, v32, v36
    v_cvt_pk_bf16_f32 v33, 0, v33
    v_mul_f32 v33, v33, v185
    v_cvt_pk_bf16_f32 v33, 0, v33
    v_and_b32 v37, 0xffff0000, v170
    v_add_f32 v33, v33, v37
    v_cvt_pk_bf16_f32 v34, 0, v34
    v_mul_f32 v34, v34, v186
    v_cvt_pk_bf16_f32 v34, 0, v34
    v_lshlrev_b32 v38, 16, v171
    v_add_f32 v34, v34, v38
    v_cvt_pk_bf16_f32 v35, 0, v35
    v_mul_f32 v35, v35, v187
    v_cvt_pk_bf16_f32 v35, 0, v35
    v_and_b32 v39, 0xffff0000, v171
    v_add_f32 v35, v35, v39
    v_cvt_pk_bf16_f32 v40, v32, v33
    v_cvt_pk_bf16_f32 v41, v34, v35
    buffer_store_dwordx2 v[40:41], v8, s[20:23], s49 offen
    s_waitcnt vmcnt(8)
    v_pk_add_f32 v[48:49], v[48:49], v[52:53]
    v_pk_add_f32 v[56:57], v[56:57], v[60:61]
    v_pk_add_f32 v[48:49], v[48:49], v[56:57]
    v_pk_add_f32 v[50:51], v[50:51], v[54:55]
    v_pk_add_f32 v[58:59], v[58:59], v[62:63]
    v_pk_add_f32 v[50:51], v[50:51], v[58:59]
    v_cvt_pk_bf16_f32 v48, 0, v48
    v_mul_f32 v48, v48, v188
    v_cvt_pk_bf16_f32 v48, 0, v48
    v_lshlrev_b32 v52, 16, v172
    v_add_f32 v48, v48, v52
    v_cvt_pk_bf16_f32 v49, 0, v49
    v_mul_f32 v49, v49, v189
    v_cvt_pk_bf16_f32 v49, 0, v49
    v_and_b32 v53, 0xffff0000, v172
    v_add_f32 v49, v49, v53
    v_cvt_pk_bf16_f32 v50, 0, v50
    v_mul_f32 v50, v50, v190
    v_cvt_pk_bf16_f32 v50, 0, v50
    v_lshlrev_b32 v54, 16, v173
    v_add_f32 v50, v50, v54
    v_cvt_pk_bf16_f32 v51, 0, v51
    v_mul_f32 v51, v51, v191
    v_cvt_pk_bf16_f32 v51, 0, v51
    v_and_b32 v55, 0xffff0000, v173
    v_add_f32 v51, v51, v55
    v_cvt_pk_bf16_f32 v56, v48, v49
    v_cvt_pk_bf16_f32 v57, v50, v51
    buffer_store_dwordx2 v[56:57], v8, s[20:23], s50 offen
    s_waitcnt vmcnt(6)
    v_pk_add_f32 v[64:65], v[64:65], v[68:69]
    v_pk_add_f32 v[72:73], v[72:73], v[76:77]
    v_pk_add_f32 v[64:65], v[64:65], v[72:73]
    v_pk_add_f32 v[66:67], v[66:67], v[70:71]
    v_pk_add_f32 v[74:75], v[74:75], v[78:79]
    v_pk_add_f32 v[66:67], v[66:67], v[74:75]
    v_cvt_pk_bf16_f32 v64, 0, v64
    v_mul_f32 v64, v64, v192
    v_cvt_pk_bf16_f32 v64, 0, v64
    v_lshlrev_b32 v68, 16, v174
    v_add_f32 v64, v64, v68
    v_cvt_pk_bf16_f32 v65, 0, v65
    v_mul_f32 v65, v65, v193
    v_cvt_pk_bf16_f32 v65, 0, v65
    v_and_b32 v69, 0xffff0000, v174
    v_add_f32 v65, v65, v69
    v_cvt_pk_bf16_f32 v66, 0, v66
    v_mul_f32 v66, v66, v194
    v_cvt_pk_bf16_f32 v66, 0, v66
    v_lshlrev_b32 v70, 16, v175
    v_add_f32 v66, v66, v70
    v_cvt_pk_bf16_f32 v67, 0, v67
    v_mul_f32 v67, v67, v195
    v_cvt_pk_bf16_f32 v67, 0, v67
    v_and_b32 v71, 0xffff0000, v175
    v_add_f32 v67, v67, v71
    v_cvt_pk_bf16_f32 v72, v64, v65
    v_cvt_pk_bf16_f32 v73, v66, v67
    buffer_store_dwordx2 v[72:73], v8, s[20:23], s51 offen
    s_waitcnt vmcnt(4)
    v_pk_add_f32 v[80:81], v[80:81], v[84:85]
    v_pk_add_f32 v[88:89], v[88:89], v[92:93]
    v_pk_add_f32 v[80:81], v[80:81], v[88:89]
    v_pk_add_f32 v[82:83], v[82:83], v[86:87]
    v_pk_add_f32 v[90:91], v[90:91], v[94:95]
    v_pk_add_f32 v[82:83], v[82:83], v[90:91]
    v_cvt_pk_bf16_f32 v80, 0, v80
    v_mul_f32 v80, v80, v196
    v_cvt_pk_bf16_f32 v80, 0, v80
    v_lshlrev_b32 v84, 16, v176
    v_add_f32 v80, v80, v84
    v_cvt_pk_bf16_f32 v81, 0, v81
    v_mul_f32 v81, v81, v197
    v_cvt_pk_bf16_f32 v81, 0, v81
    v_and_b32 v85, 0xffff0000, v176
    v_add_f32 v81, v81, v85
    v_cvt_pk_bf16_f32 v82, 0, v82
    v_mul_f32 v82, v82, v198
    v_cvt_pk_bf16_f32 v82, 0, v82
    v_lshlrev_b32 v86, 16, v177
    v_add_f32 v82, v82, v86
    v_cvt_pk_bf16_f32 v83, 0, v83
    v_mul_f32 v83, v83, v199
    v_cvt_pk_bf16_f32 v83, 0, v83
    v_and_b32 v87, 0xffff0000, v177
    v_add_f32 v83, v83, v87
    v_cvt_pk_bf16_f32 v88, v80, v81
    v_cvt_pk_bf16_f32 v89, v82, v83
    buffer_store_dwordx2 v[88:89], v8, s[20:23], s52 offen
gemm1kernel_end_1:
    s_endpgm
code_end_label:
.section .rodata,"a"
.p2align 6
.amdhsa_kernel pre_kernel
  .amdhsa_next_free_vgpr 252
  .amdhsa_next_free_sgpr 46
  .amdhsa_accum_offset 252
  .amdhsa_group_segment_fixed_size 0
  .amdhsa_kernarg_size 144
  .amdhsa_user_sgpr_count 2
  .amdhsa_user_sgpr_kernarg_segment_ptr 1
  .amdhsa_system_sgpr_workgroup_id_x 1
.end_amdhsa_kernel
.p2align 6
.amdhsa_kernel conv_kernel
  .amdhsa_next_free_vgpr 168
  .amdhsa_next_free_sgpr 40
  .amdhsa_accum_offset 168
  .amdhsa_group_segment_fixed_size 0
  .amdhsa_kernarg_size 144
  .amdhsa_user_sgpr_count 2
  .amdhsa_user_sgpr_kernarg_segment_ptr 1
  .amdhsa_system_sgpr_workgroup_id_x 1
.end_amdhsa_kernel
.p2align 6
.amdhsa_kernel gemm1_kernel
  .amdhsa_next_free_vgpr 492
  .amdhsa_next_free_sgpr 88
  .amdhsa_accum_offset 252
  .amdhsa_group_segment_fixed_size 0
  .amdhsa_kernarg_size 144
  .amdhsa_user_sgpr_count 2
  .amdhsa_user_sgpr_kernarg_segment_ptr 1
  .amdhsa_system_sgpr_workgroup_id_x 1
.end_amdhsa_kernel
```
